```python
import torch

def _softmax(x, axis=-1):
    return torch.softmax(x, dim=axis)
def _gelu(x):
    return torch.nn.functional.gelu(x, approximate="tanh")
def _silu(x):
    return torch.nn.functional.silu(x)
def _sigmoid(x):
    return torch.sigmoid(x)
def _layernorm(x, axis=-1, eps=1e-5):
    m = x.mean(dim=axis, keepdim=True)
    v = x.var(dim=axis, keepdim=True, unbiased=False)
    return (x - m) / torch.sqrt(v + eps)
def _scatter_add(tgt, idx, src, axis=0):
    return tgt.clone().index_add_(axis, idx, src)
def _segment_sum(src, seg, n):
    out = torch.zeros((n,) + src.shape[1:], dtype=src.dtype)
    return out.index_add_(0, seg, src)
def _pad(x, pw):
    flat = tuple(v for pair in reversed(pw) for v in pair)
    return torch.nn.functional.pad(x, flat)

kernel_name = 'standalone__gqa_block_cached__near_ridge'

def setup_inputs():

    _w = (lambda a: (lambda t: t.to(torch.bfloat16) if t.is_floating_point() else t)(torch.as_tensor(a)))
    B, Sq, D = 16, 144, 512
    Hq, Hkv, Sk, Dh = 32, 32, 512, 128
    assert Hq % Hkv == 0, (Hq, Hkv)
    return {
        "x": _w((lambda *s: torch.randn(*s, dtype=torch.bfloat16) * 0.8)(B, Sq, D)),
        "k_cache": _w((lambda *s: torch.randn(*s, dtype=torch.bfloat16) * 0.8)(B, Hkv, Sk, Dh)),
        "v_cache": _w((lambda *s: torch.randn(*s, dtype=torch.bfloat16) * 0.05)(B, Hkv, Sk, Dh)),
        "wq": _w((lambda *s: torch.randn(*s, dtype=torch.bfloat16) * 0.8)(D, Hq * Dh) * (D ** -0.5)),
        "wo": _w((lambda *s: torch.randn(*s, dtype=torch.bfloat16) * 0.05)(Hq * Dh, D) * ((Hq * Dh) ** -0.5)),
    }

def reference(x, k_cache, v_cache, wq, wo):
    B, Sq, D = x.shape
    Hq, Dh = 32, 128
    Hkv = k_cache.shape[1]
    rep = Hq // Hkv
    q = (lambda x, *d: x.permute(*d))((x @ wq).reshape(B, Sq, Hq, Dh), 0, 2, 1, 3)
    k = (lambda x, n, axis: torch.repeat_interleave(x, n, dim=axis))(k_cache, rep, axis=1)
    v = (lambda x, n, axis: torch.repeat_interleave(x, n, dim=axis))(v_cache, rep, axis=1)
    scores = torch.einsum("bhqd,bhkd->bhqk", q, k) * (Dh ** -0.5)
    p = _softmax(scores, axis=-1)
    o = torch.einsum("bhqk,bhkd->bhqd", p, v)
    return (lambda x, *d: x.permute(*d))(o, 0, 2, 1, 3).reshape(B, Sq, Hq * Dh) @ wo
```

```asm
; @launch grid=(256,1,1) block=(512,1,1) lds=163840
.amdgcn_target "amdgcn-amd-amdhsa--gfx950"
.text
.globl standalone__gqa_block_cached__near_ridge_kernel
.p2align 8
.type standalone__gqa_block_cached__near_ridge_kernel,@function
standalone__gqa_block_cached__near_ridge_kernel:
KSTART:
  s_cmp_ge_u32 s2, 256
  s_cbranch_scc0 K1_go
  s_endpgm
K1_go:
  s_load_dwordx16 s[4:19], s[0:1], 0
  v_lshrrev_b32 v215, 6, v0
  v_and_b32 v216, 63, v0
  v_readfirstlane_b32 s40, v215
  s_lshr_b32 s41, s40, 2
  s_and_b32 s42, s40, 3
  s_lshl_b32 s43, s42, 11
  s_add_u32 s44, s43, 32768
  s_add_u32 s51, s43, 81920
  s_bfe_u32 s63, s2, 0x10002
  s_lshl_b32 s63, s63, 3
  s_bfe_u32 s66, s2, 0x30003
  s_add_u32 s73, s63, s66
  s_and_b32 s63, s2, 3
  s_lshl_b32 s63, s63, 2
  s_lshr_b32 s67, s2, 6
  s_add_u32 s74, s63, s67
  s_lshl_b32 s63, s66, 1
  s_lshl_b32 s67, s67, 2
  s_add_u32 s75, s63, s67
  s_and_b32 s75, s75, 15
  v_lshrrev_b32 v217, 3, v216
  v_and_b32 v218, 7, v216
  v_and_b32 v219, 6, v217
  v_xor_b32 v218, v218, v219
  v_lshlrev_b32 v218, 4, v218
  v_lshl_add_u32 v207, v217, 8, v218
  v_add_u32 v207, s43, v207
  v_and_b32 v218, 7, v216
  v_and_b32 v219, 2, v217
  v_lshlrev_b32 v219, 1, v219
  v_xor_b32 v218, v218, v219
  v_lshlrev_b32 v218, 4, v218
  v_lshl_add_u32 v208, v217, 13, v218
  s_lshl_b32 s63, s42, 16
  v_add_u32 v208, s63, v208
  v_lshrrev_b32 v217, 4, v216
  v_and_b32 v218, 6, v216
  v_xor_b32 v218, v217, v218
  v_lshlrev_b32 v218, 4, v218
  v_and_b32 v219, 7, v216
  v_lshl_add_u32 v218, v219, 7, v218
  v_bfe_u32 v219, v216, 3, 1
  v_lshl_add_u32 v195, v219, 11, v218
  v_xor_b32 v196, 64, v195
  v_bfe_u32 v217, v216, 2, 3
  v_bfe_u32 v218, v216, 1, 1
  v_and_b32 v219, 6, v217
  v_xor_b32 v218, v218, v219
  v_lshlrev_b32 v218, 4, v218
  v_lshl_add_u32 v218, v217, 7, v218
  v_and_b32 v219, 1, v216
  v_lshl_add_u32 v218, v219, 3, v218
  v_lshrrev_b32 v219, 5, v216
  v_lshl_add_u32 v199, v219, 11, v218
  v_xor_b32 v200, 32, v199
  v_xor_b32 v201, 64, v199
  v_xor_b32 v202, 96, v199
  v_bfe_u32 v217, v216, 2, 2
  v_and_b32 v218, 3, v216
  v_and_b32 v219, 2, v217
  v_lshlrev_b32 v219, 1, v219
  v_xor_b32 v218, v218, v219
  v_lshlrev_b32 v218, 4, v218
  v_lshl_add_u32 v218, v217, 7, v218
  v_lshrrev_b32 v219, 4, v216
  v_lshl_add_u32 v209, v219, 11, v218
  v_xor_b32 v210, 64, v209
  v_lshrrev_b32 v217, 3, v216
  v_and_b32 v218, 7, v216
  v_and_b32 v219, 6, v217
  v_xor_b32 v218, v218, v219
  v_lshlrev_b32 v218, 4, v218
  v_lshl_add_u32 v213, v217, 10, v218
  v_lshrrev_b32 v217, 4, v216
  v_and_b32 v218, 6, v216
  v_xor_b32 v218, v217, v218
  v_lshlrev_b32 v218, 4, v218
  v_and_b32 v219, 7, v216
  v_lshl_add_u32 v218, v219, 7, v218
  v_bfe_u32 v219, v216, 3, 1
  v_lshl_add_u32 v168, v219, 10, v218
  s_lshl_b32 s63, s42, 12
  v_add_u32 v168, s63, v168
  v_xor_b32 v169, 64, v168
  v_lshlrev_b32 v214, 4, v216
  s_mov_b32 s3, s63
  s_add_u32 s100, s63, 2048
  s_lshl_b32 s101, s42, 10
  s_add_u32 s101, s101, 16384
  s_sub_u32 s78, 16384, s63
  s_mov_b32 s76, 114688
  s_mov_b32 s77, 114688
  s_lshl_b32 s63, s42, 1
  s_lshl_b32 s45, s63, 14
  s_add_u32 s46, s45, 16384
  s_lshl_b32 s47, s42, 13
  s_add_u32 s47, s47, 131072
  s_lshl_b32 s48, s63, 12
  s_add_u32 s49, s48, 4096
  s_mov_b32 s50, 32768
  s_mov_b32 s64, 0x3e0293ee
  s_mov_b32 s65, 0x3e0293ee
  s_waitcnt lgkmcnt(0)
  s_mul_i32 s63, s73, 147456
  s_add_u32 s20, s4, s63
  s_addc_u32 s21, s5, 0
  s_mov_b32 s22, 147456
  s_mov_b32 s23, 0x20000
  s_lshl_b32 s63, s73, 5
  s_lshl_b32 s66, s74, 1
  s_add_u32 s63, s63, s66
  s_lshl_b32 s67, s63, 17
  s_add_u32 s24, s6, s67
  s_addc_u32 s25, s7, 0
  s_mov_b32 s26, 262144
  s_mov_b32 s27, 0x20000
  s_add_u32 s28, s8, s67
  s_addc_u32 s29, s9, 0
  s_mov_b32 s30, 262144
  s_mov_b32 s31, 0x20000
  s_mov_b32 s71, 0
  s_lshl_b32 s70, s71, 17
  s_xor_b32 s71, s71, s41
  s_add_u32 s63, s63, s71
  s_mul_i32 s67, s63, 36864
  s_add_u32 s67, s67, 1048576
  s_add_u32 s36, s18, s67
  s_addc_u32 s37, s19, 0
  s_mov_b32 s38, 36864
  s_mov_b32 s39, 0x20000
  s_lshr_b32 s71, s70, 17
  s_xor_b32 s71, s71, s41
  s_add_u32 s66, s66, s71
  s_lshl_b32 s71, s71, 1
  s_sub_u32 s71, 1, s71
  s_lshl_b32 s67, s66, 8
  s_add_u32 s32, s10, s67
  s_addc_u32 s33, s11, 0
  s_sub_u32 s34, 4194304, s67
  s_mov_b32 s35, 0x20000
  s_and_b32 s75, s75, 14
  s_lshl_b32 s52, s75, 18
  s_mov_b32 s53, 0
  s_mov_b32 s54, 0
  s_lshl_b32 s55, s75, 6
  v_add_u32 v209, 81920, v209
  v_add_u32 v210, 81920, v210
  v_add_u32 v211, s54, v209
  v_add_u32 v212, s54, v210
  s_mul_i32 s56, s41, -131072
  s_add_u32 s56, s56, 163840
  s_mul_i32 s58, s41, 0
  s_add_u32 s58, s58, 0
  s_mul_i32 s57, s41, -106496
  s_add_u32 s57, s57, 155648
  s_mul_i32 s59, s41, -8192
  s_add_u32 s59, s59, 8192
  s_mul_i32 s60, s41, 0
  s_add_u32 s60, s60, 0
  s_mul_i32 s61, s41, 32768
  s_add_u32 s61, s61, 32768
  v_add_u32 v197, s60, v195
  v_add_u32 v198, s60, v196
  v_add_u32 v203, s61, v199
  v_add_u32 v204, s61, v200
  v_add_u32 v205, s61, v201
  v_add_u32 v206, s61, v202
  s_cmp_eq_u32 s42, 0
  s_cselect_b32 s63, 1, 0
  s_cmp_eq_u32 s42, 3
  s_cselect_b32 s66, 1, 0
  s_cmp_eq_u32 s41, 0
  s_cselect_b32 s63, s63, s66
  s_cmp_eq_u32 s63, 1
  s_cbranch_scc1 K1_T3
  s_cmp_eq_u32 s41, 0
  s_cbranch_scc0 K1T2_g1
  v_mov_b32 v217, 151552
  v_mov_b64 v[218:219], 0
  ds_write_b64 v217, v[218:219]
  s_waitcnt lgkmcnt(0)
  s_add_u32 m0, s53, s51
  s_nop 0
  buffer_load_dwordx4 v208, s[32:35], s52 offen  lds
  s_add_u32 m0, m0, 896
  s_nop 0
  buffer_load_dwordx4 v208, s[32:35], s52 offen offset:128  lds
  s_add_u32 s52, s52, 262144
  s_and_b32 s52, s52, 4194303
  s_add_u32 s53, s53, 8192
  s_and_b32 s53, s53, 32767
  s_add_u32 m0, s53, s51
  s_nop 0
  buffer_load_dwordx4 v208, s[32:35], s52 offen  lds
  s_add_u32 m0, m0, 896
  s_nop 0
  buffer_load_dwordx4 v208, s[32:35], s52 offen offset:128  lds
  s_add_u32 s52, s52, 262144
  s_and_b32 s52, s52, 4194303
  s_add_u32 s53, s53, 8192
  s_and_b32 s53, s53, 32767
  s_add_u32 m0, s53, s51
  s_nop 0
  buffer_load_dwordx4 v208, s[32:35], s52 offen  lds
  s_add_u32 m0, m0, 896
  s_nop 0
  buffer_load_dwordx4 v208, s[32:35], s52 offen offset:128  lds
  s_add_u32 s52, s52, 262144
  s_and_b32 s52, s52, 4194303
  s_add_u32 s53, s53, 8192
  s_and_b32 s53, s53, 32767
  v_mov_b64 v[0:1], 0
  v_mov_b64 v[2:3], 0
  v_mov_b64 v[4:5], 0
  v_mov_b64 v[6:7], 0
  v_mov_b64 v[8:9], 0
  v_mov_b64 v[10:11], 0
  v_mov_b64 v[12:13], 0
  v_mov_b64 v[14:15], 0
  v_mov_b64 v[16:17], 0
  v_mov_b64 v[18:19], 0
  v_mov_b64 v[20:21], 0
  v_mov_b64 v[22:23], 0
  v_mov_b64 v[24:25], 0
  v_mov_b64 v[26:27], 0
  v_mov_b64 v[28:29], 0
  v_mov_b64 v[30:31], 0
  v_mov_b64 v[32:33], 0
  v_mov_b64 v[34:35], 0
  v_mov_b64 v[36:37], 0
  v_mov_b64 v[38:39], 0
  v_mov_b64 v[40:41], 0
  v_mov_b64 v[42:43], 0
  v_mov_b64 v[44:45], 0
  v_mov_b64 v[46:47], 0
  v_mov_b64 v[48:49], 0
  v_mov_b64 v[50:51], 0
  v_mov_b64 v[52:53], 0
  v_mov_b64 v[54:55], 0
  v_mov_b64 v[56:57], 0
  v_mov_b64 v[58:59], 0
  v_mov_b64 v[60:61], 0
  v_mov_b64 v[62:63], 0
  s_waitcnt vmcnt(4)
  s_barrier
  v_add_u32 v170, s77, v168
  v_add_u32 v171, s77, v169
  ds_read_b128 v[144:147], v170 offset:0
  ds_read_b128 v[148:151], v170 offset:2048
  ds_read_b64_tr_b16 a[0:1], v211 offset:0
  ds_read_b64_tr_b16 a[2:3], v211 offset:512
  ds_read_b64_tr_b16 a[4:5], v211 offset:8
  ds_read_b64_tr_b16 a[6:7], v211 offset:520
  ds_read_b64_tr_b16 a[8:9], v212 offset:0
  ds_read_b64_tr_b16 a[10:11], v212 offset:512
  ds_read_b64_tr_b16 a[12:13], v212 offset:8
  ds_read_b64_tr_b16 a[14:15], v212 offset:520
  ds_read_b64_tr_b16 a[16:17], v211 offset:1024
  ds_read_b64_tr_b16 a[18:19], v211 offset:1536
  ds_read_b64_tr_b16 a[20:21], v211 offset:1032
  ds_read_b64_tr_b16 a[22:23], v211 offset:1544
  s_mov_b32 s62, 0
K1T2a_qloop:
  s_waitcnt vmcnt(2)
  s_barrier
  s_waitcnt lgkmcnt(5)
  v_mfma_f32_16x16x32_bf16 v[0:3], a[0:3], v[144:147], v[0:3]
  ds_read_b64_tr_b16 a[24:25], v212 offset:1024
  ds_read_b64_tr_b16 a[26:27], v212 offset:1536
  s_add_u32 m0, s53, s51
  s_nop 0
  buffer_load_dwordx4 v208, s[32:35], s52 offen  lds
  s_waitcnt lgkmcnt(6)
  v_mfma_f32_16x16x32_bf16 v[32:35], a[0:3], v[148:151], v[32:35]
  v_mfma_f32_16x16x32_bf16 v[4:7], a[4:7], v[144:147], v[4:7]
  ds_read_b64_tr_b16 a[28:29], v212 offset:1032
  ds_read_b64_tr_b16 a[30:31], v212 offset:1544
  v_mfma_f32_16x16x32_bf16 v[36:39], a[4:7], v[148:151], v[36:39]
  s_add_u32 s54, s54, 8192
  s_and_b32 s54, s54, 32767
  v_add_u32 v211, s54, v209
  v_add_u32 v212, s54, v210
  s_waitcnt lgkmcnt(8)
  v_mfma_f32_16x16x32_bf16 v[8:11], a[8:11], v[144:147], v[8:11]
  ds_read_b64_tr_b16 a[0:1], v211 offset:0
  ds_read_b64_tr_b16 a[2:3], v211 offset:512
  v_mfma_f32_16x16x32_bf16 v[40:43], a[8:11], v[148:151], v[40:43]
  v_mfma_f32_16x16x32_bf16 v[12:15], a[12:15], v[144:147], v[12:15]
  ds_read_b64_tr_b16 a[4:5], v211 offset:8
  ds_read_b64_tr_b16 a[6:7], v211 offset:520
  s_add_u32 m0, m0, 896
  s_nop 0
  buffer_load_dwordx4 v208, s[32:35], s52 offen offset:128  lds
  s_add_u32 s52, s52, 262144
  s_and_b32 s52, s52, 4194303
  s_add_u32 s53, s53, 8192
  s_and_b32 s53, s53, 32767
  v_mfma_f32_16x16x32_bf16 v[44:47], a[12:15], v[148:151], v[44:47]
  s_waitcnt lgkmcnt(8)
  v_mfma_f32_16x16x32_bf16 v[16:19], a[16:19], v[144:147], v[16:19]
  ds_read_b64_tr_b16 a[8:9], v212 offset:0
  ds_read_b64_tr_b16 a[10:11], v212 offset:512
  v_mfma_f32_16x16x32_bf16 v[48:51], a[16:19], v[148:151], v[48:51]
  v_mfma_f32_16x16x32_bf16 v[20:23], a[20:23], v[144:147], v[20:23]
  ds_read_b64_tr_b16 a[12:13], v212 offset:8
  ds_read_b64_tr_b16 a[14:15], v212 offset:520
  v_mfma_f32_16x16x32_bf16 v[52:55], a[20:23], v[148:151], v[52:55]
  ds_read_b128 v[156:159], v171 offset:0
  ds_read_b128 v[160:163], v171 offset:2048
  s_waitcnt lgkmcnt(10)
  v_mfma_f32_16x16x32_bf16 v[24:27], a[24:27], v[144:147], v[24:27]
  ds_read_b64_tr_b16 a[16:17], v211 offset:1024
  ds_read_b64_tr_b16 a[18:19], v211 offset:1536
  v_mfma_f32_16x16x32_bf16 v[56:59], a[24:27], v[148:151], v[56:59]
  v_mfma_f32_16x16x32_bf16 v[28:31], a[28:31], v[144:147], v[28:31]
  ds_read_b64_tr_b16 a[20:21], v211 offset:1032
  ds_read_b64_tr_b16 a[22:23], v211 offset:1544
  v_mfma_f32_16x16x32_bf16 v[60:63], a[28:31], v[148:151], v[60:63]
  s_waitcnt vmcnt(2)
  s_barrier
  s_waitcnt lgkmcnt(5)
  v_mfma_f32_16x16x32_bf16 v[0:3], a[0:3], v[156:159], v[0:3]
  ds_read_b64_tr_b16 a[24:25], v212 offset:1024
  ds_read_b64_tr_b16 a[26:27], v212 offset:1536
  s_add_u32 m0, s53, s51
  s_nop 0
  buffer_load_dwordx4 v208, s[32:35], s52 offen  lds
  s_waitcnt lgkmcnt(6)
  v_mfma_f32_16x16x32_bf16 v[32:35], a[0:3], v[160:163], v[32:35]
  v_mfma_f32_16x16x32_bf16 v[4:7], a[4:7], v[156:159], v[4:7]
  ds_read_b64_tr_b16 a[28:29], v212 offset:1032
  ds_read_b64_tr_b16 a[30:31], v212 offset:1544
  v_mfma_f32_16x16x32_bf16 v[36:39], a[4:7], v[160:163], v[36:39]
  s_add_u32 s54, s54, 8192
  s_and_b32 s54, s54, 32767
  v_add_u32 v211, s54, v209
  v_add_u32 v212, s54, v210
  v_mfma_f32_16x16x32_bf16 v[8:11], a[8:11], v[156:159], v[8:11]
  ds_read_b64_tr_b16 a[0:1], v211 offset:0
  ds_read_b64_tr_b16 a[2:3], v211 offset:512
  v_mfma_f32_16x16x32_bf16 v[40:43], a[8:11], v[160:163], v[40:43]
  v_mfma_f32_16x16x32_bf16 v[12:15], a[12:15], v[156:159], v[12:15]
  ds_read_b64_tr_b16 a[4:5], v211 offset:8
  ds_read_b64_tr_b16 a[6:7], v211 offset:520
  s_add_u32 m0, m0, 896
  s_nop 0
  buffer_load_dwordx4 v208, s[32:35], s52 offen offset:128  lds
  s_add_u32 s52, s52, 262144
  s_and_b32 s52, s52, 4194303
  s_add_u32 s53, s53, 8192
  s_and_b32 s53, s53, 32767
  v_mfma_f32_16x16x32_bf16 v[44:47], a[12:15], v[160:163], v[44:47]
  s_waitcnt lgkmcnt(8)
  v_mfma_f32_16x16x32_bf16 v[16:19], a[16:19], v[156:159], v[16:19]
  ds_read_b64_tr_b16 a[8:9], v212 offset:0
  ds_read_b64_tr_b16 a[10:11], v212 offset:512
  v_mfma_f32_16x16x32_bf16 v[48:51], a[16:19], v[160:163], v[48:51]
  v_mfma_f32_16x16x32_bf16 v[20:23], a[20:23], v[156:159], v[20:23]
  ds_read_b64_tr_b16 a[12:13], v212 offset:8
  ds_read_b64_tr_b16 a[14:15], v212 offset:520
  v_mfma_f32_16x16x32_bf16 v[52:55], a[20:23], v[160:163], v[52:55]
  s_xor_b32 s77, s77, 247808
  v_add_u32 v170, s77, v168
  v_add_u32 v171, s77, v169
  ds_read_b128 v[144:147], v170 offset:0
  ds_read_b128 v[148:151], v170 offset:2048
  s_waitcnt lgkmcnt(10)
  v_mfma_f32_16x16x32_bf16 v[24:27], a[24:27], v[156:159], v[24:27]
  ds_read_b64_tr_b16 a[16:17], v211 offset:1024
  ds_read_b64_tr_b16 a[18:19], v211 offset:1536
  v_mfma_f32_16x16x32_bf16 v[56:59], a[24:27], v[160:163], v[56:59]
  v_mfma_f32_16x16x32_bf16 v[28:31], a[28:31], v[156:159], v[28:31]
  ds_read_b64_tr_b16 a[20:21], v211 offset:1032
  ds_read_b64_tr_b16 a[22:23], v211 offset:1544
  v_mfma_f32_16x16x32_bf16 v[60:63], a[28:31], v[160:163], v[60:63]
  s_add_u32 s62, s62, 1
  s_cmp_lt_u32 s62, 6
  s_cbranch_scc1 K1T2a_qloop
  s_waitcnt vmcnt(2)
  s_barrier
  s_waitcnt lgkmcnt(5)
  v_mfma_f32_16x16x32_bf16 v[0:3], a[0:3], v[144:147], v[0:3]
  ds_read_b64_tr_b16 a[24:25], v212 offset:1024
  ds_read_b64_tr_b16 a[26:27], v212 offset:1536
  s_add_u32 m0, s53, s51
  s_nop 0
  buffer_load_dwordx4 v208, s[32:35], s52 offen  lds
  s_waitcnt lgkmcnt(6)
  v_mfma_f32_16x16x32_bf16 v[32:35], a[0:3], v[148:151], v[32:35]
  v_mfma_f32_16x16x32_bf16 v[4:7], a[4:7], v[144:147], v[4:7]
  ds_read_b64_tr_b16 a[28:29], v212 offset:1032
  ds_read_b64_tr_b16 a[30:31], v212 offset:1544
  v_mfma_f32_16x16x32_bf16 v[36:39], a[4:7], v[148:151], v[36:39]
  s_add_u32 s54, s54, 8192
  s_and_b32 s54, s54, 32767
  v_add_u32 v211, s54, v209
  v_add_u32 v212, s54, v210
  v_mfma_f32_16x16x32_bf16 v[8:11], a[8:11], v[144:147], v[8:11]
  ds_read_b64_tr_b16 a[0:1], v211 offset:0
  ds_read_b64_tr_b16 a[2:3], v211 offset:512
  v_mfma_f32_16x16x32_bf16 v[40:43], a[8:11], v[148:151], v[40:43]
  v_mfma_f32_16x16x32_bf16 v[12:15], a[12:15], v[144:147], v[12:15]
  ds_read_b64_tr_b16 a[4:5], v211 offset:8
  ds_read_b64_tr_b16 a[6:7], v211 offset:520
  s_add_u32 m0, m0, 896
  s_nop 0
  buffer_load_dwordx4 v208, s[32:35], s52 offen offset:128  lds
  s_add_u32 s52, s52, 262144
  s_and_b32 s52, s52, 4194303
  s_add_u32 s53, s53, 8192
  s_and_b32 s53, s53, 32767
  v_mfma_f32_16x16x32_bf16 v[44:47], a[12:15], v[148:151], v[44:47]
  s_waitcnt lgkmcnt(8)
  v_mfma_f32_16x16x32_bf16 v[16:19], a[16:19], v[144:147], v[16:19]
  ds_read_b64_tr_b16 a[8:9], v212 offset:0
  ds_read_b64_tr_b16 a[10:11], v212 offset:512
  v_mfma_f32_16x16x32_bf16 v[48:51], a[16:19], v[148:151], v[48:51]
  v_mfma_f32_16x16x32_bf16 v[20:23], a[20:23], v[144:147], v[20:23]
  ds_read_b64_tr_b16 a[12:13], v212 offset:8
  ds_read_b64_tr_b16 a[14:15], v212 offset:520
  v_mfma_f32_16x16x32_bf16 v[52:55], a[20:23], v[148:151], v[52:55]
  ds_read_b128 v[156:159], v171 offset:0
  ds_read_b128 v[160:163], v171 offset:2048
  s_waitcnt lgkmcnt(10)
  v_mfma_f32_16x16x32_bf16 v[24:27], a[24:27], v[144:147], v[24:27]
  ds_read_b64_tr_b16 a[16:17], v211 offset:1024
  ds_read_b64_tr_b16 a[18:19], v211 offset:1536
  v_mfma_f32_16x16x32_bf16 v[56:59], a[24:27], v[148:151], v[56:59]
  v_mfma_f32_16x16x32_bf16 v[28:31], a[28:31], v[144:147], v[28:31]
  ds_read_b64_tr_b16 a[20:21], v211 offset:1032
  ds_read_b64_tr_b16 a[22:23], v211 offset:1544
  v_mfma_f32_16x16x32_bf16 v[60:63], a[28:31], v[148:151], v[60:63]
  s_waitcnt vmcnt(2)
  s_barrier
  s_waitcnt lgkmcnt(5)
  v_mfma_f32_16x16x32_bf16 v[0:3], a[0:3], v[156:159], v[0:3]
  ds_read_b64_tr_b16 a[24:25], v212 offset:1024
  ds_read_b64_tr_b16 a[26:27], v212 offset:1536
  s_waitcnt lgkmcnt(6)
  v_mfma_f32_16x16x32_bf16 v[32:35], a[0:3], v[160:163], v[32:35]
  v_mfma_f32_16x16x32_bf16 v[4:7], a[4:7], v[156:159], v[4:7]
  ds_read_b64_tr_b16 a[28:29], v212 offset:1032
  ds_read_b64_tr_b16 a[30:31], v212 offset:1544
  v_mfma_f32_16x16x32_bf16 v[36:39], a[4:7], v[160:163], v[36:39]
  s_add_u32 s54, s54, 8192
  s_and_b32 s54, s54, 32767
  v_add_u32 v211, s54, v209
  v_add_u32 v212, s54, v210
  v_mfma_f32_16x16x32_bf16 v[8:11], a[8:11], v[156:159], v[8:11]
  ds_read_b64_tr_b16 a[0:1], v211 offset:0
  ds_read_b64_tr_b16 a[2:3], v211 offset:512
  v_mfma_f32_16x16x32_bf16 v[40:43], a[8:11], v[160:163], v[40:43]
  v_mfma_f32_16x16x32_bf16 v[12:15], a[12:15], v[156:159], v[12:15]
  ds_read_b64_tr_b16 a[4:5], v211 offset:8
  ds_read_b64_tr_b16 a[6:7], v211 offset:520
  v_mfma_f32_16x16x32_bf16 v[44:47], a[12:15], v[160:163], v[44:47]
  s_waitcnt lgkmcnt(8)
  v_mfma_f32_16x16x32_bf16 v[16:19], a[16:19], v[156:159], v[16:19]
  ds_read_b64_tr_b16 a[8:9], v212 offset:0
  ds_read_b64_tr_b16 a[10:11], v212 offset:512
  v_mfma_f32_16x16x32_bf16 v[48:51], a[16:19], v[160:163], v[48:51]
  v_mfma_f32_16x16x32_bf16 v[20:23], a[20:23], v[156:159], v[20:23]
  ds_read_b64_tr_b16 a[12:13], v212 offset:8
  ds_read_b64_tr_b16 a[14:15], v212 offset:520
  v_mfma_f32_16x16x32_bf16 v[52:55], a[20:23], v[160:163], v[52:55]
  s_xor_b32 s77, s77, 247808
  v_add_u32 v170, s77, v168
  v_add_u32 v171, s77, v169
  ds_read_b128 v[144:147], v170 offset:0
  ds_read_b128 v[148:151], v170 offset:2048
  s_waitcnt lgkmcnt(10)
  v_mfma_f32_16x16x32_bf16 v[24:27], a[24:27], v[156:159], v[24:27]
  ds_read_b64_tr_b16 a[16:17], v211 offset:1024
  ds_read_b64_tr_b16 a[18:19], v211 offset:1536
  v_mfma_f32_16x16x32_bf16 v[56:59], a[24:27], v[160:163], v[56:59]
  v_mfma_f32_16x16x32_bf16 v[28:31], a[28:31], v[156:159], v[28:31]
  ds_read_b64_tr_b16 a[20:21], v211 offset:1032
  ds_read_b64_tr_b16 a[22:23], v211 offset:1544
  v_mfma_f32_16x16x32_bf16 v[60:63], a[28:31], v[160:163], v[60:63]
  s_waitcnt vmcnt(0)
  s_barrier
  s_waitcnt lgkmcnt(5)
  v_mfma_f32_16x16x32_bf16 v[0:3], a[0:3], v[144:147], v[0:3]
  ds_read_b64_tr_b16 a[24:25], v212 offset:1024
  ds_read_b64_tr_b16 a[26:27], v212 offset:1536
  s_waitcnt lgkmcnt(6)
  v_mfma_f32_16x16x32_bf16 v[32:35], a[0:3], v[148:151], v[32:35]
  v_mfma_f32_16x16x32_bf16 v[4:7], a[4:7], v[144:147], v[4:7]
  ds_read_b64_tr_b16 a[28:29], v212 offset:1032
  ds_read_b64_tr_b16 a[30:31], v212 offset:1544
  v_mfma_f32_16x16x32_bf16 v[36:39], a[4:7], v[148:151], v[36:39]
  s_add_u32 s54, s54, 8192
  s_and_b32 s54, s54, 32767
  v_add_u32 v211, s54, v209
  v_add_u32 v212, s54, v210
  v_mfma_f32_16x16x32_bf16 v[8:11], a[8:11], v[144:147], v[8:11]
  ds_read_b64_tr_b16 a[0:1], v211 offset:0
  ds_read_b64_tr_b16 a[2:3], v211 offset:512
  v_mfma_f32_16x16x32_bf16 v[40:43], a[8:11], v[148:151], v[40:43]
  v_mfma_f32_16x16x32_bf16 v[12:15], a[12:15], v[144:147], v[12:15]
  ds_read_b64_tr_b16 a[4:5], v211 offset:8
  ds_read_b64_tr_b16 a[6:7], v211 offset:520
  v_mfma_f32_16x16x32_bf16 v[44:47], a[12:15], v[148:151], v[44:47]
  s_waitcnt lgkmcnt(8)
  v_mfma_f32_16x16x32_bf16 v[16:19], a[16:19], v[144:147], v[16:19]
  ds_read_b64_tr_b16 a[8:9], v212 offset:0
  ds_read_b64_tr_b16 a[10:11], v212 offset:512
  v_mfma_f32_16x16x32_bf16 v[48:51], a[16:19], v[148:151], v[48:51]
  v_mfma_f32_16x16x32_bf16 v[20:23], a[20:23], v[144:147], v[20:23]
  ds_read_b64_tr_b16 a[12:13], v212 offset:8
  ds_read_b64_tr_b16 a[14:15], v212 offset:520
  v_mfma_f32_16x16x32_bf16 v[52:55], a[20:23], v[148:151], v[52:55]
  ds_read_b128 v[156:159], v171 offset:0
  ds_read_b128 v[160:163], v171 offset:2048
  s_waitcnt lgkmcnt(10)
  v_mfma_f32_16x16x32_bf16 v[24:27], a[24:27], v[144:147], v[24:27]
  ds_read_b64_tr_b16 a[16:17], v211 offset:1024
  ds_read_b64_tr_b16 a[18:19], v211 offset:1536
  v_mfma_f32_16x16x32_bf16 v[56:59], a[24:27], v[148:151], v[56:59]
  v_mfma_f32_16x16x32_bf16 v[28:31], a[28:31], v[144:147], v[28:31]
  ds_read_b64_tr_b16 a[20:21], v211 offset:1032
  ds_read_b64_tr_b16 a[22:23], v211 offset:1544
  v_mfma_f32_16x16x32_bf16 v[60:63], a[28:31], v[148:151], v[60:63]
  s_barrier
  s_waitcnt lgkmcnt(5)
  v_mfma_f32_16x16x32_bf16 v[0:3], a[0:3], v[156:159], v[0:3]
  ds_read_b64_tr_b16 a[24:25], v212 offset:1024
  ds_read_b64_tr_b16 a[26:27], v212 offset:1536
  s_waitcnt lgkmcnt(6)
  v_mfma_f32_16x16x32_bf16 v[32:35], a[0:3], v[160:163], v[32:35]
  v_mfma_f32_16x16x32_bf16 v[4:7], a[4:7], v[156:159], v[4:7]
  ds_read_b64_tr_b16 a[28:29], v212 offset:1032
  ds_read_b64_tr_b16 a[30:31], v212 offset:1544
  v_mfma_f32_16x16x32_bf16 v[36:39], a[4:7], v[160:163], v[36:39]
  v_mfma_f32_16x16x32_bf16 v[8:11], a[8:11], v[156:159], v[8:11]
  v_mfma_f32_16x16x32_bf16 v[40:43], a[8:11], v[160:163], v[40:43]
  v_mfma_f32_16x16x32_bf16 v[12:15], a[12:15], v[156:159], v[12:15]
  v_mfma_f32_16x16x32_bf16 v[44:47], a[12:15], v[160:163], v[44:47]
  s_waitcnt lgkmcnt(4)
  v_mfma_f32_16x16x32_bf16 v[16:19], a[16:19], v[156:159], v[16:19]
  v_mfma_f32_16x16x32_bf16 v[48:51], a[16:19], v[160:163], v[48:51]
  v_mfma_f32_16x16x32_bf16 v[20:23], a[20:23], v[156:159], v[20:23]
  v_mfma_f32_16x16x32_bf16 v[52:55], a[20:23], v[160:163], v[52:55]
  s_waitcnt lgkmcnt(0)
  v_mfma_f32_16x16x32_bf16 v[24:27], a[24:27], v[156:159], v[24:27]
  v_mfma_f32_16x16x32_bf16 v[56:59], a[24:27], v[160:163], v[56:59]
  v_mfma_f32_16x16x32_bf16 v[28:31], a[28:31], v[156:159], v[28:31]
  v_mfma_f32_16x16x32_bf16 v[60:63], a[28:31], v[160:163], v[60:63]
  s_nop 7
  v_pk_mul_f32 v[0:1], v[0:1], s[64:65]
  v_pk_mul_f32 v[2:3], v[2:3], s[64:65]
  v_pk_mul_f32 v[4:5], v[4:5], s[64:65]
  v_pk_mul_f32 v[6:7], v[6:7], s[64:65]
  v_cvt_pk_bf16_f32 v96, v0, v1
  v_cvt_pk_bf16_f32 v97, v2, v3
  v_cvt_pk_bf16_f32 v98, v4, v5
  v_cvt_pk_bf16_f32 v99, v6, v7
  v_pk_mul_f32 v[8:9], v[8:9], s[64:65]
  v_pk_mul_f32 v[10:11], v[10:11], s[64:65]
  v_pk_mul_f32 v[12:13], v[12:13], s[64:65]
  v_pk_mul_f32 v[14:15], v[14:15], s[64:65]
  v_cvt_pk_bf16_f32 v100, v8, v9
  v_cvt_pk_bf16_f32 v101, v10, v11
  v_cvt_pk_bf16_f32 v102, v12, v13
  v_cvt_pk_bf16_f32 v103, v14, v15
  v_pk_mul_f32 v[16:17], v[16:17], s[64:65]
  v_pk_mul_f32 v[18:19], v[18:19], s[64:65]
  v_pk_mul_f32 v[20:21], v[20:21], s[64:65]
  v_pk_mul_f32 v[22:23], v[22:23], s[64:65]
  v_cvt_pk_bf16_f32 v104, v16, v17
  v_cvt_pk_bf16_f32 v105, v18, v19
  v_cvt_pk_bf16_f32 v106, v20, v21
  v_cvt_pk_bf16_f32 v107, v22, v23
  v_pk_mul_f32 v[24:25], v[24:25], s[64:65]
  v_pk_mul_f32 v[26:27], v[26:27], s[64:65]
  v_pk_mul_f32 v[28:29], v[28:29], s[64:65]
  v_pk_mul_f32 v[30:31], v[30:31], s[64:65]
  v_cvt_pk_bf16_f32 v108, v24, v25
  v_cvt_pk_bf16_f32 v109, v26, v27
  v_cvt_pk_bf16_f32 v110, v28, v29
  v_cvt_pk_bf16_f32 v111, v30, v31
  v_pk_mul_f32 v[32:33], v[32:33], s[64:65]
  v_pk_mul_f32 v[34:35], v[34:35], s[64:65]
  v_pk_mul_f32 v[36:37], v[36:37], s[64:65]
  v_pk_mul_f32 v[38:39], v[38:39], s[64:65]
  v_cvt_pk_bf16_f32 v112, v32, v33
  v_cvt_pk_bf16_f32 v113, v34, v35
  v_cvt_pk_bf16_f32 v114, v36, v37
  v_cvt_pk_bf16_f32 v115, v38, v39
  v_pk_mul_f32 v[40:41], v[40:41], s[64:65]
  v_pk_mul_f32 v[42:43], v[42:43], s[64:65]
  v_pk_mul_f32 v[44:45], v[44:45], s[64:65]
  v_pk_mul_f32 v[46:47], v[46:47], s[64:65]
  v_cvt_pk_bf16_f32 v116, v40, v41
  v_cvt_pk_bf16_f32 v117, v42, v43
  v_cvt_pk_bf16_f32 v118, v44, v45
  v_cvt_pk_bf16_f32 v119, v46, v47
  v_pk_mul_f32 v[48:49], v[48:49], s[64:65]
  v_pk_mul_f32 v[50:51], v[50:51], s[64:65]
  v_pk_mul_f32 v[52:53], v[52:53], s[64:65]
  v_pk_mul_f32 v[54:55], v[54:55], s[64:65]
  v_cvt_pk_bf16_f32 v120, v48, v49
  v_cvt_pk_bf16_f32 v121, v50, v51
  v_cvt_pk_bf16_f32 v122, v52, v53
  v_cvt_pk_bf16_f32 v123, v54, v55
  v_pk_mul_f32 v[56:57], v[56:57], s[64:65]
  v_pk_mul_f32 v[58:59], v[58:59], s[64:65]
  v_pk_mul_f32 v[60:61], v[60:61], s[64:65]
  v_pk_mul_f32 v[62:63], v[62:63], s[64:65]
  v_cvt_pk_bf16_f32 v124, v56, v57
  v_cvt_pk_bf16_f32 v125, v58, v59
  v_cvt_pk_bf16_f32 v126, v60, v61
  v_cvt_pk_bf16_f32 v127, v62, v63
  s_branch K1T2_mid
K1T2_g1:
  s_add_u32 m0, s76, s3
  s_add_u32 s72, s45, s55
  buffer_load_dwordx4 v213, s[20:23], s72 offen  lds
  s_add_u32 m0, m0, 1024
  s_add_u32 s72, s72, 8192
  buffer_load_dwordx4 v213, s[20:23], s72 offen  lds
  s_add_u32 m0, s76, s100
  s_add_u32 s72, s46, s55
  buffer_load_dwordx4 v213, s[20:23], s72 offen  lds
  s_add_u32 m0, m0, 1024
  s_add_u32 s72, s72, 8192
  buffer_load_dwordx4 v213, s[20:23], s72 offen  lds
  s_cmp_lt_u32 s42, 2
  s_cbranch_scc0 XL1
  s_add_u32 m0, s76, s101
  s_add_u32 s72, s47, s55
  buffer_load_dwordx4 v213, s[20:23], s72 offen  lds
XL1:
  s_add_u32 s55, s55, 128
  s_and_b32 s55, s55, 1023
  s_xor_b32 s76, s76, 247808
  s_add_u32 m0, s76, s3
  s_add_u32 s72, s45, s55
  buffer_load_dwordx4 v213, s[20:23], s72 offen  lds
  s_add_u32 m0, m0, 1024
  s_add_u32 s72, s72, 8192
  buffer_load_dwordx4 v213, s[20:23], s72 offen  lds
  s_add_u32 m0, s76, s100
  s_add_u32 s72, s46, s55
  buffer_load_dwordx4 v213, s[20:23], s72 offen  lds
  s_add_u32 m0, m0, 1024
  s_add_u32 s72, s72, 8192
  buffer_load_dwordx4 v213, s[20:23], s72 offen  lds
  s_cmp_lt_u32 s42, 2
  s_cbranch_scc0 XL2
  s_add_u32 m0, s76, s101
  s_add_u32 s72, s47, s55
  buffer_load_dwordx4 v213, s[20:23], s72 offen  lds
XL2:
  s_add_u32 s55, s55, 128
  s_and_b32 s55, s55, 1023
  s_xor_b32 s76, s76, 247808
  s_waitcnt vmcnt(4)
  s_barrier
  s_barrier
  s_mov_b32 s67, 0
  s_xor_b32 s72, 0, s70
  s_add_u32 m0, s67, s43
  s_nop 0
  buffer_load_dwordx4 v207, s[24:27], s72 offen nt lds
  s_add_u32 m0, m0, 896
  s_nop 0
  buffer_load_dwordx4 v207, s[24:27], s72 offen offset:128 nt lds
  s_waitcnt vmcnt(2)
  s_barrier
  s_add_u32 m0, s76, s3
  s_add_u32 s72, s45, s55
  buffer_load_dwordx4 v213, s[20:23], s72 offen  lds
  s_add_u32 m0, m0, 1024
  s_add_u32 s72, s72, 8192
  buffer_load_dwordx4 v213, s[20:23], s72 offen  lds
  s_add_u32 m0, s76, s100
  s_add_u32 s72, s46, s55
  buffer_load_dwordx4 v213, s[20:23], s72 offen  lds
  s_add_u32 m0, m0, 1024
  s_add_u32 s72, s72, 8192
  buffer_load_dwordx4 v213, s[20:23], s72 offen  lds
  s_cmp_lt_u32 s42, 2
  s_cbranch_scc0 XL3
  s_add_u32 m0, s76, s101
  s_add_u32 s72, s47, s55
  buffer_load_dwordx4 v213, s[20:23], s72 offen  lds
XL3:
  s_add_u32 s55, s55, 128
  s_and_b32 s55, s55, 1023
  s_xor_b32 s76, s76, 247808
  s_barrier
  s_mov_b32 s67, 8192
  s_xor_b32 s72, 8192, s70
  s_add_u32 m0, s67, s43
  s_nop 0
  buffer_load_dwordx4 v207, s[24:27], s72 offen nt lds
  s_add_u32 m0, m0, 896
  s_nop 0
  buffer_load_dwordx4 v207, s[24:27], s72 offen offset:128 nt lds
  s_waitcnt vmcnt(2)
  s_barrier
  s_add_u32 m0, s76, s3
  s_add_u32 s72, s45, s55
  buffer_load_dwordx4 v213, s[20:23], s72 offen  lds
  s_add_u32 m0, m0, 1024
  s_add_u32 s72, s72, 8192
  buffer_load_dwordx4 v213, s[20:23], s72 offen  lds
  s_add_u32 m0, s76, s100
  s_add_u32 s72, s46, s55
  buffer_load_dwordx4 v213, s[20:23], s72 offen  lds
  s_add_u32 m0, m0, 1024
  s_add_u32 s72, s72, 8192
  buffer_load_dwordx4 v213, s[20:23], s72 offen  lds
  s_cmp_lt_u32 s42, 2
  s_cbranch_scc0 XL4
  s_add_u32 m0, s76, s101
  s_add_u32 s72, s47, s55
  buffer_load_dwordx4 v213, s[20:23], s72 offen  lds
XL4:
  s_add_u32 s55, s55, 128
  s_and_b32 s55, s55, 1023
  s_xor_b32 s76, s76, 247808
  s_barrier
  s_mov_b32 s67, 32768
  s_xor_b32 s72, 0, s70
  s_add_u32 m0, s67, s43
  s_nop 0
  buffer_load_dwordx4 v207, s[28:31], s72 offen nt lds
  s_add_u32 m0, m0, 896
  s_nop 0
  buffer_load_dwordx4 v207, s[28:31], s72 offen offset:128 nt lds
  s_waitcnt vmcnt(2)
  s_barrier
  s_add_u32 m0, s76, s3
  s_add_u32 s72, s45, s55
  buffer_load_dwordx4 v213, s[20:23], s72 offen  lds
  s_add_u32 m0, m0, 1024
  s_add_u32 s72, s72, 8192
  buffer_load_dwordx4 v213, s[20:23], s72 offen  lds
  s_add_u32 m0, s76, s100
  s_add_u32 s72, s46, s55
  buffer_load_dwordx4 v213, s[20:23], s72 offen  lds
  s_add_u32 m0, m0, 1024
  s_add_u32 s72, s72, 8192
  buffer_load_dwordx4 v213, s[20:23], s72 offen  lds
  s_cmp_lt_u32 s42, 2
  s_cbranch_scc0 XL5
  s_add_u32 m0, s76, s101
  s_add_u32 s72, s47, s55
  buffer_load_dwordx4 v213, s[20:23], s72 offen  lds
XL5:
  s_add_u32 s55, s55, 128
  s_and_b32 s55, s55, 1023
  s_xor_b32 s76, s76, 247808
  s_mov_b32 s67, 16384
  s_xor_b32 s72, 16384, s70
  s_add_u32 m0, s67, s43
  s_nop 0
  buffer_load_dwordx4 v207, s[24:27], s72 offen nt lds
  s_add_u32 m0, m0, 896
  s_nop 0
  buffer_load_dwordx4 v207, s[24:27], s72 offen offset:128 nt lds
  s_barrier
  s_waitcnt vmcnt(2)
  s_barrier
  s_add_u32 m0, s76, s3
  s_add_u32 s72, s45, s55
  buffer_load_dwordx4 v213, s[20:23], s72 offen  lds
  s_add_u32 m0, m0, 1024
  s_add_u32 s72, s72, 8192
  buffer_load_dwordx4 v213, s[20:23], s72 offen  lds
  s_add_u32 m0, s76, s100
  s_add_u32 s72, s46, s55
  buffer_load_dwordx4 v213, s[20:23], s72 offen  lds
  s_add_u32 m0, m0, 1024
  s_add_u32 s72, s72, 8192
  buffer_load_dwordx4 v213, s[20:23], s72 offen  lds
  s_cmp_lt_u32 s42, 2
  s_cbranch_scc0 XL6
  s_add_u32 m0, s76, s101
  s_add_u32 s72, s47, s55
  buffer_load_dwordx4 v213, s[20:23], s72 offen  lds
XL6:
  s_add_u32 s55, s55, 128
  s_and_b32 s55, s55, 1023
  s_xor_b32 s76, s76, 247808
  s_mov_b32 s67, 40960
  s_xor_b32 s72, 8192, s70
  s_add_u32 m0, s67, s43
  s_nop 0
  buffer_load_dwordx4 v207, s[28:31], s72 offen nt lds
  s_add_u32 m0, m0, 896
  s_nop 0
  buffer_load_dwordx4 v207, s[28:31], s72 offen offset:128 nt lds
  s_barrier
  s_mov_b32 s67, 24576
  s_xor_b32 s72, 24576, s70
  s_add_u32 m0, s67, s43
  s_nop 0
  buffer_load_dwordx4 v207, s[24:27], s72 offen nt lds
  s_add_u32 m0, m0, 896
  s_nop 0
  buffer_load_dwordx4 v207, s[24:27], s72 offen offset:128 nt lds
  v_mov_b64 v[0:1], 0
  v_mov_b64 v[2:3], 0
  v_mov_b64 v[4:5], 0
  v_mov_b64 v[6:7], 0
  v_mov_b64 v[8:9], 0
  v_mov_b64 v[10:11], 0
  v_mov_b64 v[12:13], 0
  v_mov_b64 v[14:15], 0
  v_mov_b64 v[16:17], 0
  v_mov_b64 v[18:19], 0
  v_mov_b64 v[20:21], 0
  v_mov_b64 v[22:23], 0
  v_mov_b64 v[24:25], 0
  v_mov_b64 v[26:27], 0
  v_mov_b64 v[28:29], 0
  v_mov_b64 v[30:31], 0
  v_mov_b64 v[32:33], 0
  v_mov_b64 v[34:35], 0
  v_mov_b64 v[36:37], 0
  v_mov_b64 v[38:39], 0
  v_mov_b64 v[40:41], 0
  v_mov_b64 v[42:43], 0
  v_mov_b64 v[44:45], 0
  v_mov_b64 v[46:47], 0
  v_mov_b64 v[48:49], 0
  v_mov_b64 v[50:51], 0
  v_mov_b64 v[52:53], 0
  v_mov_b64 v[54:55], 0
  v_mov_b64 v[56:57], 0
  v_mov_b64 v[58:59], 0
  v_mov_b64 v[60:61], 0
  v_mov_b64 v[62:63], 0
  s_waitcnt vmcnt(4)
  s_barrier
  s_add_u32 m0, s76, s3
  s_add_u32 s72, s45, s55
  buffer_load_dwordx4 v213, s[20:23], s72 offen  lds
  s_add_u32 m0, m0, 1024
  s_add_u32 s72, s72, 8192
  buffer_load_dwordx4 v213, s[20:23], s72 offen  lds
  s_add_u32 m0, s76, s100
  s_add_u32 s72, s46, s55
  buffer_load_dwordx4 v213, s[20:23], s72 offen  lds
  s_add_u32 m0, m0, 1024
  s_add_u32 s72, s72, 8192
  buffer_load_dwordx4 v213, s[20:23], s72 offen  lds
  s_cmp_lt_u32 s42, 2
  s_cbranch_scc0 XL7
  s_add_u32 m0, s76, s101
  s_add_u32 s72, s47, s55
  buffer_load_dwordx4 v213, s[20:23], s72 offen  lds
XL7:
  s_add_u32 s55, s55, 128
  s_and_b32 s55, s55, 1023
  s_xor_b32 s76, s76, 247808
  s_barrier
  s_mov_b32 s67, 49152
  s_xor_b32 s72, 16384, s70
  s_add_u32 m0, s67, s43
  s_nop 0
  buffer_load_dwordx4 v207, s[28:31], s72 offen nt lds
  s_add_u32 m0, m0, 896
  s_nop 0
  buffer_load_dwordx4 v207, s[28:31], s72 offen offset:128 nt lds
  s_waitcnt vmcnt(2)
  s_barrier
  s_add_u32 m0, s76, s3
  s_add_u32 s72, s45, s55
  buffer_load_dwordx4 v213, s[20:23], s72 offen  lds
  s_add_u32 m0, m0, 1024
  s_add_u32 s72, s72, 8192
  buffer_load_dwordx4 v213, s[20:23], s72 offen  lds
  s_add_u32 m0, s76, s100
  s_add_u32 s72, s46, s55
  buffer_load_dwordx4 v213, s[20:23], s72 offen  lds
  s_add_u32 m0, m0, 1024
  s_add_u32 s72, s72, 8192
  buffer_load_dwordx4 v213, s[20:23], s72 offen  lds
  s_cmp_lt_u32 s42, 2
  s_cbranch_scc0 XL8
  s_add_u32 m0, s76, s101
  s_add_u32 s72, s47, s55
  buffer_load_dwordx4 v213, s[20:23], s72 offen  lds
XL8:
  s_add_u32 s55, s55, 128
  s_and_b32 s55, s55, 1023
  s_xor_b32 s76, s76, 247808
  s_barrier
  s_mov_b32 s67, 57344
  s_xor_b32 s72, 24576, s70
  s_add_u32 m0, s67, s43
  s_nop 0
  buffer_load_dwordx4 v207, s[28:31], s72 offen nt lds
  s_add_u32 m0, m0, 896
  s_nop 0
  buffer_load_dwordx4 v207, s[28:31], s72 offen offset:128 nt lds
  s_waitcnt vmcnt(2)
  s_barrier
  s_add_u32 m0, s53, s51
  s_nop 0
  buffer_load_dwordx4 v208, s[32:35], s52 offen  lds
  s_add_u32 m0, m0, 896
  s_nop 0
  buffer_load_dwordx4 v208, s[32:35], s52 offen offset:128  lds
  s_add_u32 s52, s52, 262144
  s_and_b32 s52, s52, 4194303
  s_add_u32 s53, s53, 8192
  s_and_b32 s53, s53, 32767
  s_add_u32 m0, s76, s3
  s_add_u32 s72, s45, s55
  buffer_load_dwordx4 v213, s[20:23], s72 offen  lds
  s_add_u32 m0, m0, 1024
  s_add_u32 s72, s72, 8192
  buffer_load_dwordx4 v213, s[20:23], s72 offen  lds
  s_add_u32 m0, s76, s100
  s_add_u32 s72, s46, s55
  buffer_load_dwordx4 v213, s[20:23], s72 offen  lds
  s_add_u32 m0, m0, 1024
  s_add_u32 s72, s72, 8192
  buffer_load_dwordx4 v213, s[20:23], s72 offen  lds
  s_cmp_lt_u32 s42, 2
  s_cbranch_scc0 XL9
  s_add_u32 m0, s76, s101
  s_add_u32 s72, s47, s55
  buffer_load_dwordx4 v213, s[20:23], s72 offen  lds
XL9:
  s_add_u32 s55, s55, 128
  s_and_b32 s55, s55, 1023
  s_xor_b32 s76, s76, 247808
  s_mov_b32 s67, 65536
  s_xor_b32 s72, 32768, s70
  s_add_u32 m0, s67, s43
  s_nop 0
  buffer_load_dwordx4 v207, s[28:31], s72 offen nt lds
  s_add_u32 m0, m0, 896
  s_nop 0
  buffer_load_dwordx4 v207, s[28:31], s72 offen offset:128 nt lds
  s_barrier
  s_add_u32 m0, s53, s51
  s_nop 0
  buffer_load_dwordx4 v208, s[32:35], s52 offen  lds
  s_add_u32 m0, m0, 896
  s_nop 0
  buffer_load_dwordx4 v208, s[32:35], s52 offen offset:128  lds
  s_add_u32 s52, s52, 262144
  s_and_b32 s52, s52, 4194303
  s_add_u32 s53, s53, 8192
  s_and_b32 s53, s53, 32767
  s_barrier
  s_add_u32 m0, s53, s51
  s_nop 0
  buffer_load_dwordx4 v208, s[32:35], s52 offen  lds
  s_add_u32 m0, m0, 896
  s_nop 0
  buffer_load_dwordx4 v208, s[32:35], s52 offen offset:128  lds
  s_add_u32 s52, s52, 262144
  s_and_b32 s52, s52, 4194303
  s_add_u32 s53, s53, 8192
  s_and_b32 s53, s53, 32767
  s_add_u32 m0, s76, s3
  s_add_u32 s72, s45, s55
  buffer_load_dwordx4 v213, s[20:23], s72 offen  lds
  s_add_u32 m0, m0, 1024
  s_add_u32 s72, s72, 8192
  buffer_load_dwordx4 v213, s[20:23], s72 offen  lds
  s_add_u32 m0, s76, s100
  s_add_u32 s72, s46, s55
  buffer_load_dwordx4 v213, s[20:23], s72 offen  lds
  s_add_u32 m0, m0, 1024
  s_add_u32 s72, s72, 8192
  buffer_load_dwordx4 v213, s[20:23], s72 offen  lds
  s_cmp_lt_u32 s42, 2
  s_cbranch_scc0 XL10
  s_add_u32 m0, s76, s101
  s_add_u32 s72, s47, s55
  buffer_load_dwordx4 v213, s[20:23], s72 offen  lds
XL10:
  s_add_u32 s55, s55, 128
  s_and_b32 s55, s55, 1023
  s_xor_b32 s76, s76, 247808
  s_mov_b32 s67, 73728
  s_xor_b32 s72, 40960, s70
  s_add_u32 m0, s67, s43
  s_nop 0
  buffer_load_dwordx4 v207, s[28:31], s72 offen nt lds
  s_add_u32 m0, m0, 896
  s_nop 0
  buffer_load_dwordx4 v207, s[28:31], s72 offen offset:128 nt lds
  s_waitcnt vmcnt(12)
  s_barrier
  v_add_u32 v170, s77, v168
  v_add_u32 v171, s77, v169
  ds_read_b128 v[144:147], v170 offset:0
  ds_read_b128 v[148:151], v170 offset:2048
  ds_read_b64_tr_b16 a[0:1], v211 offset:0
  ds_read_b64_tr_b16 a[2:3], v211 offset:512
  ds_read_b64_tr_b16 a[4:5], v211 offset:8
  ds_read_b64_tr_b16 a[6:7], v211 offset:520
  ds_read_b64_tr_b16 a[8:9], v212 offset:0
  ds_read_b64_tr_b16 a[10:11], v212 offset:512
  ds_read_b64_tr_b16 a[12:13], v212 offset:8
  ds_read_b64_tr_b16 a[14:15], v212 offset:520
  ds_read_b64_tr_b16 a[16:17], v211 offset:1024
  ds_read_b64_tr_b16 a[18:19], v211 offset:1536
  ds_read_b64_tr_b16 a[20:21], v211 offset:1032
  ds_read_b64_tr_b16 a[22:23], v211 offset:1544
  s_mov_b32 s62, 0
K1T2b_qloop:
  s_waitcnt vmcnt(8)
  s_barrier
  s_waitcnt lgkmcnt(5)
  v_mfma_f32_16x16x32_bf16 v[0:3], a[0:3], v[144:147], v[0:3]
  ds_read_b64_tr_b16 a[24:25], v212 offset:1024
  ds_read_b64_tr_b16 a[26:27], v212 offset:1536
  s_cmp_eq_u32 s62, 0
  s_cbranch_scc1 VL11
  s_xor_b32 s72, s57, s70
  s_add_u32 m0, s59, s44
  s_nop 0
  buffer_load_dwordx4 v207, s[28:31], s72 offen nt lds
  s_add_u32 m0, m0, 896
  s_nop 0
  buffer_load_dwordx4 v207, s[28:31], s72 offen offset:128 nt lds
  s_add_u32 s57, s57, 8192
  s_add_u32 s59, s59, 8192
  s_cmp_eq_u32 s59, 49152
  s_cselect_b32 s59, 0, s59
VL11:
  s_waitcnt lgkmcnt(6)
  v_mfma_f32_16x16x32_bf16 v[32:35], a[0:3], v[148:151], v[32:35]
  v_mfma_f32_16x16x32_bf16 v[4:7], a[4:7], v[144:147], v[4:7]
  ds_read_b64_tr_b16 a[28:29], v212 offset:1032
  ds_read_b64_tr_b16 a[30:31], v212 offset:1544
  s_xor_b32 s72, s56, s70
  s_add_u32 m0, s58, s43
  s_nop 0
  buffer_load_dwordx4 v207, s[24:27], s72 offen nt lds
  v_mfma_f32_16x16x32_bf16 v[36:39], a[4:7], v[148:151], v[36:39]
  s_add_u32 s54, s54, 8192
  s_and_b32 s54, s54, 32767
  v_add_u32 v211, s54, v209
  v_add_u32 v212, s54, v210
  s_waitcnt lgkmcnt(8)
  v_mfma_f32_16x16x32_bf16 v[8:11], a[8:11], v[144:147], v[8:11]
  ds_read_b64_tr_b16 a[0:1], v211 offset:0
  ds_read_b64_tr_b16 a[2:3], v211 offset:512
  s_add_u32 m0, m0, 896
  s_nop 0
  buffer_load_dwordx4 v207, s[24:27], s72 offen offset:128 nt lds
  v_mfma_f32_16x16x32_bf16 v[40:43], a[8:11], v[148:151], v[40:43]
  v_mfma_f32_16x16x32_bf16 v[12:15], a[12:15], v[144:147], v[12:15]
  ds_read_b64_tr_b16 a[4:5], v211 offset:8
  ds_read_b64_tr_b16 a[6:7], v211 offset:520
  v_mfma_f32_16x16x32_bf16 v[44:47], a[12:15], v[148:151], v[44:47]
  s_add_u32 s56, s56, 8192
  s_add_u32 s58, s58, 8192
  s_and_b32 s58, s58, 32767
  s_add_u32 m0, s53, s51
  s_nop 0
  buffer_load_dwordx4 v208, s[32:35], s52 offen  lds
  s_waitcnt lgkmcnt(8)
  v_mfma_f32_16x16x32_bf16 v[16:19], a[16:19], v[144:147], v[16:19]
  ds_read_b64_tr_b16 a[8:9], v212 offset:0
  ds_read_b64_tr_b16 a[10:11], v212 offset:512
  v_mfma_f32_16x16x32_bf16 v[48:51], a[16:19], v[148:151], v[48:51]
  s_add_u32 m0, m0, 896
  s_nop 0
  buffer_load_dwordx4 v208, s[32:35], s52 offen offset:128  lds
  s_add_u32 s52, s52, 262144
  s_and_b32 s52, s52, 4194303
  s_add_u32 s53, s53, 8192
  s_and_b32 s53, s53, 32767
  v_mfma_f32_16x16x32_bf16 v[20:23], a[20:23], v[144:147], v[20:23]
  ds_read_b64_tr_b16 a[12:13], v212 offset:8
  ds_read_b64_tr_b16 a[14:15], v212 offset:520
  v_mfma_f32_16x16x32_bf16 v[52:55], a[20:23], v[148:151], v[52:55]
  ds_read_b128 v[156:159], v171 offset:0
  ds_read_b128 v[160:163], v171 offset:2048
  s_waitcnt lgkmcnt(10)
  v_mfma_f32_16x16x32_bf16 v[24:27], a[24:27], v[144:147], v[24:27]
  ds_read_b64_tr_b16 a[16:17], v211 offset:1024
  ds_read_b64_tr_b16 a[18:19], v211 offset:1536
  v_mfma_f32_16x16x32_bf16 v[56:59], a[24:27], v[148:151], v[56:59]
  v_mfma_f32_16x16x32_bf16 v[28:31], a[28:31], v[144:147], v[28:31]
  ds_read_b64_tr_b16 a[20:21], v211 offset:1032
  ds_read_b64_tr_b16 a[22:23], v211 offset:1544
  v_mfma_f32_16x16x32_bf16 v[60:63], a[28:31], v[148:151], v[60:63]
  s_waitcnt vmcnt(6)
  s_barrier
  s_waitcnt lgkmcnt(5)
  v_mfma_f32_16x16x32_bf16 v[0:3], a[0:3], v[156:159], v[0:3]
  ds_read_b64_tr_b16 a[24:25], v212 offset:1024
  ds_read_b64_tr_b16 a[26:27], v212 offset:1536
  s_cmp_eq_u32 s62, 0
  s_cbranch_scc1 VL12
  s_xor_b32 s72, s57, s70
  s_add_u32 m0, s59, s44
  s_nop 0
  buffer_load_dwordx4 v207, s[28:31], s72 offen nt lds
  s_add_u32 m0, m0, 896
  s_nop 0
  buffer_load_dwordx4 v207, s[28:31], s72 offen offset:128 nt lds
  s_add_u32 s57, s57, 8192
  s_add_u32 s59, s59, 8192
  s_cmp_eq_u32 s59, 49152
  s_cselect_b32 s59, 0, s59
VL12:
  s_waitcnt lgkmcnt(6)
  v_mfma_f32_16x16x32_bf16 v[32:35], a[0:3], v[160:163], v[32:35]
  s_xor_b32 s72, s56, s70
  s_add_u32 m0, s58, s43
  s_nop 0
  buffer_load_dwordx4 v207, s[24:27], s72 offen nt lds
  v_mfma_f32_16x16x32_bf16 v[4:7], a[4:7], v[156:159], v[4:7]
  ds_read_b64_tr_b16 a[28:29], v212 offset:1032
  ds_read_b64_tr_b16 a[30:31], v212 offset:1544
  s_add_u32 m0, m0, 896
  s_nop 0
  buffer_load_dwordx4 v207, s[24:27], s72 offen offset:128 nt lds
  v_mfma_f32_16x16x32_bf16 v[36:39], a[4:7], v[160:163], v[36:39]
  s_add_u32 s54, s54, 8192
  s_and_b32 s54, s54, 32767
  v_add_u32 v211, s54, v209
  v_add_u32 v212, s54, v210
  s_add_u32 s56, s56, 8192
  s_add_u32 s58, s58, 8192
  s_and_b32 s58, s58, 32767
  s_add_u32 m0, s53, s51
  s_nop 0
  buffer_load_dwordx4 v208, s[32:35], s52 offen  lds
  v_mfma_f32_16x16x32_bf16 v[8:11], a[8:11], v[156:159], v[8:11]
  ds_read_b64_tr_b16 a[0:1], v211 offset:0
  ds_read_b64_tr_b16 a[2:3], v211 offset:512
  s_add_u32 m0, m0, 896
  s_nop 0
  buffer_load_dwordx4 v208, s[32:35], s52 offen offset:128  lds
  v_mfma_f32_16x16x32_bf16 v[40:43], a[8:11], v[160:163], v[40:43]
  v_mfma_f32_16x16x32_bf16 v[12:15], a[12:15], v[156:159], v[12:15]
  ds_read_b64_tr_b16 a[4:5], v211 offset:8
  ds_read_b64_tr_b16 a[6:7], v211 offset:520
  s_add_u32 s52, s52, 262144
  s_and_b32 s52, s52, 4194303
  s_add_u32 s53, s53, 8192
  s_and_b32 s53, s53, 32767
  s_add_u32 m0, s76, s3
  s_add_u32 s72, s45, s55
  buffer_load_dwordx4 v213, s[20:23], s72 offen  lds
  v_mfma_f32_16x16x32_bf16 v[44:47], a[12:15], v[160:163], v[44:47]
  s_add_u32 m0, m0, 1024
  s_add_u32 s72, s72, 8192
  buffer_load_dwordx4 v213, s[20:23], s72 offen  lds
  s_waitcnt lgkmcnt(8)
  v_mfma_f32_16x16x32_bf16 v[16:19], a[16:19], v[156:159], v[16:19]
  ds_read_b64_tr_b16 a[8:9], v212 offset:0
  ds_read_b64_tr_b16 a[10:11], v212 offset:512
  s_add_u32 m0, s76, s100
  s_add_u32 s72, s46, s55
  buffer_load_dwordx4 v213, s[20:23], s72 offen  lds
  v_mfma_f32_16x16x32_bf16 v[48:51], a[16:19], v[160:163], v[48:51]
  s_add_u32 m0, m0, 1024
  s_add_u32 s72, s72, 8192
  buffer_load_dwordx4 v213, s[20:23], s72 offen  lds
  v_mfma_f32_16x16x32_bf16 v[20:23], a[20:23], v[156:159], v[20:23]
  ds_read_b64_tr_b16 a[12:13], v212 offset:8
  ds_read_b64_tr_b16 a[14:15], v212 offset:520
  s_cmp_lt_u32 s42, 2
  s_cbranch_scc0 XL13
  s_add_u32 m0, s76, s101
  s_add_u32 s72, s47, s55
  buffer_load_dwordx4 v213, s[20:23], s72 offen  lds
XL13:
  s_add_u32 s55, s55, 128
  s_and_b32 s55, s55, 1023
  s_xor_b32 s76, s76, 247808
  v_mfma_f32_16x16x32_bf16 v[52:55], a[20:23], v[160:163], v[52:55]
  s_xor_b32 s77, s77, 247808
  v_add_u32 v170, s77, v168
  v_add_u32 v171, s77, v169
  ds_read_b128 v[144:147], v170 offset:0
  ds_read_b128 v[148:151], v170 offset:2048
  s_waitcnt lgkmcnt(10)
  v_mfma_f32_16x16x32_bf16 v[24:27], a[24:27], v[156:159], v[24:27]
  ds_read_b64_tr_b16 a[16:17], v211 offset:1024
  ds_read_b64_tr_b16 a[18:19], v211 offset:1536
  v_mfma_f32_16x16x32_bf16 v[56:59], a[24:27], v[160:163], v[56:59]
  v_mfma_f32_16x16x32_bf16 v[28:31], a[28:31], v[156:159], v[28:31]
  ds_read_b64_tr_b16 a[20:21], v211 offset:1032
  ds_read_b64_tr_b16 a[22:23], v211 offset:1544
  v_mfma_f32_16x16x32_bf16 v[60:63], a[28:31], v[160:163], v[60:63]
  s_add_u32 s62, s62, 1
  s_cmp_lt_u32 s62, 6
  s_cbranch_scc1 K1T2b_qloop
  s_waitcnt vmcnt(10)
  s_barrier
  s_waitcnt lgkmcnt(5)
  v_mfma_f32_16x16x32_bf16 v[0:3], a[0:3], v[144:147], v[0:3]
  ds_read_b64_tr_b16 a[24:25], v212 offset:1024
  ds_read_b64_tr_b16 a[26:27], v212 offset:1536
  s_xor_b32 s72, s57, s70
  s_add_u32 m0, s59, s44
  s_nop 0
  buffer_load_dwordx4 v207, s[28:31], s72 offen nt lds
  s_waitcnt lgkmcnt(6)
  v_mfma_f32_16x16x32_bf16 v[32:35], a[0:3], v[148:151], v[32:35]
  v_mfma_f32_16x16x32_bf16 v[4:7], a[4:7], v[144:147], v[4:7]
  ds_read_b64_tr_b16 a[28:29], v212 offset:1032
  ds_read_b64_tr_b16 a[30:31], v212 offset:1544
  s_add_u32 m0, m0, 896
  s_nop 0
  buffer_load_dwordx4 v207, s[28:31], s72 offen offset:128 nt lds
  v_mfma_f32_16x16x32_bf16 v[36:39], a[4:7], v[148:151], v[36:39]
  s_add_u32 s54, s54, 8192
  s_and_b32 s54, s54, 32767
  v_add_u32 v211, s54, v209
  v_add_u32 v212, s54, v210
  v_mfma_f32_16x16x32_bf16 v[8:11], a[8:11], v[144:147], v[8:11]
  ds_read_b64_tr_b16 a[0:1], v211 offset:0
  ds_read_b64_tr_b16 a[2:3], v211 offset:512
  s_add_u32 s57, s57, 8192
  s_add_u32 s59, s59, 8192
  s_cmp_eq_u32 s59, 49152
  s_cselect_b32 s59, 0, s59
  s_xor_b32 s72, s56, s70
  s_add_u32 m0, s58, s43
  s_nop 0
  buffer_load_dwordx4 v207, s[24:27], s72 offen nt lds
  v_mfma_f32_16x16x32_bf16 v[40:43], a[8:11], v[148:151], v[40:43]
  v_mfma_f32_16x16x32_bf16 v[12:15], a[12:15], v[144:147], v[12:15]
  ds_read_b64_tr_b16 a[4:5], v211 offset:8
  ds_read_b64_tr_b16 a[6:7], v211 offset:520
  s_add_u32 m0, m0, 896
  s_nop 0
  buffer_load_dwordx4 v207, s[24:27], s72 offen offset:128 nt lds
  v_mfma_f32_16x16x32_bf16 v[44:47], a[12:15], v[148:151], v[44:47]
  s_waitcnt lgkmcnt(8)
  v_mfma_f32_16x16x32_bf16 v[16:19], a[16:19], v[144:147], v[16:19]
  ds_read_b64_tr_b16 a[8:9], v212 offset:0
  ds_read_b64_tr_b16 a[10:11], v212 offset:512
  s_add_u32 s56, s56, 8192
  s_add_u32 s58, s58, 8192
  s_and_b32 s58, s58, 32767
  s_add_u32 m0, s53, s51
  s_nop 0
  buffer_load_dwordx4 v208, s[32:35], s52 offen  lds
  v_mfma_f32_16x16x32_bf16 v[48:51], a[16:19], v[148:151], v[48:51]
  v_mfma_f32_16x16x32_bf16 v[20:23], a[20:23], v[144:147], v[20:23]
  ds_read_b64_tr_b16 a[12:13], v212 offset:8
  ds_read_b64_tr_b16 a[14:15], v212 offset:520
  s_add_u32 m0, m0, 896
  s_nop 0
  buffer_load_dwordx4 v208, s[32:35], s52 offen offset:128  lds
  s_add_u32 s52, s52, 262144
  s_and_b32 s52, s52, 4194303
  s_add_u32 s53, s53, 8192
  s_and_b32 s53, s53, 32767
  v_mfma_f32_16x16x32_bf16 v[52:55], a[20:23], v[148:151], v[52:55]
  ds_read_b128 v[156:159], v171 offset:0
  ds_read_b128 v[160:163], v171 offset:2048
  s_waitcnt lgkmcnt(10)
  v_mfma_f32_16x16x32_bf16 v[24:27], a[24:27], v[144:147], v[24:27]
  ds_read_b64_tr_b16 a[16:17], v211 offset:1024
  ds_read_b64_tr_b16 a[18:19], v211 offset:1536
  v_mfma_f32_16x16x32_bf16 v[56:59], a[24:27], v[148:151], v[56:59]
  v_mfma_f32_16x16x32_bf16 v[28:31], a[28:31], v[144:147], v[28:31]
  ds_read_b64_tr_b16 a[20:21], v211 offset:1032
  ds_read_b64_tr_b16 a[22:23], v211 offset:1544
  v_mfma_f32_16x16x32_bf16 v[60:63], a[28:31], v[148:151], v[60:63]
  s_waitcnt vmcnt(6)
  s_barrier
  s_waitcnt lgkmcnt(5)
  v_mfma_f32_16x16x32_bf16 v[0:3], a[0:3], v[156:159], v[0:3]
  ds_read_b64_tr_b16 a[24:25], v212 offset:1024
  ds_read_b64_tr_b16 a[26:27], v212 offset:1536
  s_xor_b32 s72, s57, s70
  s_add_u32 m0, s59, s44
  s_nop 0
  buffer_load_dwordx4 v207, s[28:31], s72 offen nt lds
  s_waitcnt lgkmcnt(6)
  v_mfma_f32_16x16x32_bf16 v[32:35], a[0:3], v[160:163], v[32:35]
  v_mfma_f32_16x16x32_bf16 v[4:7], a[4:7], v[156:159], v[4:7]
  ds_read_b64_tr_b16 a[28:29], v212 offset:1032
  ds_read_b64_tr_b16 a[30:31], v212 offset:1544
  v_mfma_f32_16x16x32_bf16 v[36:39], a[4:7], v[160:163], v[36:39]
  s_add_u32 s54, s54, 8192
  s_and_b32 s54, s54, 32767
  v_add_u32 v211, s54, v209
  v_add_u32 v212, s54, v210
  s_add_u32 m0, m0, 896
  s_nop 0
  buffer_load_dwordx4 v207, s[28:31], s72 offen offset:128 nt lds
  v_mfma_f32_16x16x32_bf16 v[8:11], a[8:11], v[156:159], v[8:11]
  ds_read_b64_tr_b16 a[0:1], v211 offset:0
  ds_read_b64_tr_b16 a[2:3], v211 offset:512
  v_mfma_f32_16x16x32_bf16 v[40:43], a[8:11], v[160:163], v[40:43]
  v_mfma_f32_16x16x32_bf16 v[12:15], a[12:15], v[156:159], v[12:15]
  ds_read_b64_tr_b16 a[4:5], v211 offset:8
  ds_read_b64_tr_b16 a[6:7], v211 offset:520
  s_add_u32 s57, s57, 8192
  s_add_u32 s59, s59, 8192
  s_cmp_eq_u32 s59, 49152
  s_cselect_b32 s59, 0, s59
  s_xor_b32 s72, s56, s70
  s_add_u32 m0, s58, s43
  s_nop 0
  buffer_load_dwordx4 v207, s[24:27], s72 offen nt lds
  v_mfma_f32_16x16x32_bf16 v[44:47], a[12:15], v[160:163], v[44:47]
  s_waitcnt lgkmcnt(8)
  v_mfma_f32_16x16x32_bf16 v[16:19], a[16:19], v[156:159], v[16:19]
  ds_read_b64_tr_b16 a[8:9], v212 offset:0
  ds_read_b64_tr_b16 a[10:11], v212 offset:512
  v_mfma_f32_16x16x32_bf16 v[48:51], a[16:19], v[160:163], v[48:51]
  s_add_u32 m0, m0, 896
  s_nop 0
  buffer_load_dwordx4 v207, s[24:27], s72 offen offset:128 nt lds
  s_add_u32 s56, s56, 8192
  s_add_u32 s58, s58, 8192
  s_and_b32 s58, s58, 32767
  v_mfma_f32_16x16x32_bf16 v[20:23], a[20:23], v[156:159], v[20:23]
  ds_read_b64_tr_b16 a[12:13], v212 offset:8
  ds_read_b64_tr_b16 a[14:15], v212 offset:520
  v_mfma_f32_16x16x32_bf16 v[52:55], a[20:23], v[160:163], v[52:55]
  s_xor_b32 s77, s77, 247808
  v_add_u32 v170, s77, v168
  v_add_u32 v171, s77, v169
  ds_read_b128 v[144:147], v170 offset:0
  ds_read_b128 v[148:151], v170 offset:2048
  s_waitcnt lgkmcnt(10)
  v_mfma_f32_16x16x32_bf16 v[24:27], a[24:27], v[156:159], v[24:27]
  ds_read_b64_tr_b16 a[16:17], v211 offset:1024
  ds_read_b64_tr_b16 a[18:19], v211 offset:1536
  v_mfma_f32_16x16x32_bf16 v[56:59], a[24:27], v[160:163], v[56:59]
  v_mfma_f32_16x16x32_bf16 v[28:31], a[28:31], v[156:159], v[28:31]
  ds_read_b64_tr_b16 a[20:21], v211 offset:1032
  ds_read_b64_tr_b16 a[22:23], v211 offset:1544
  v_mfma_f32_16x16x32_bf16 v[60:63], a[28:31], v[160:163], v[60:63]
  s_waitcnt vmcnt(4)
  s_barrier
  s_waitcnt lgkmcnt(5)
  v_mfma_f32_16x16x32_bf16 v[0:3], a[0:3], v[144:147], v[0:3]
  ds_read_b64_tr_b16 a[24:25], v212 offset:1024
  ds_read_b64_tr_b16 a[26:27], v212 offset:1536
  s_xor_b32 s72, s57, s70
  s_add_u32 m0, s59, s44
  s_nop 0
  buffer_load_dwordx4 v207, s[28:31], s72 offen nt lds
  s_waitcnt lgkmcnt(6)
  v_mfma_f32_16x16x32_bf16 v[32:35], a[0:3], v[148:151], v[32:35]
  v_mfma_f32_16x16x32_bf16 v[4:7], a[4:7], v[144:147], v[4:7]
  ds_read_b64_tr_b16 a[28:29], v212 offset:1032
  ds_read_b64_tr_b16 a[30:31], v212 offset:1544
  v_mfma_f32_16x16x32_bf16 v[36:39], a[4:7], v[148:151], v[36:39]
  s_add_u32 s54, s54, 8192
  s_and_b32 s54, s54, 32767
  v_add_u32 v211, s54, v209
  v_add_u32 v212, s54, v210
  s_add_u32 m0, m0, 896
  s_nop 0
  buffer_load_dwordx4 v207, s[28:31], s72 offen offset:128 nt lds
  v_mfma_f32_16x16x32_bf16 v[8:11], a[8:11], v[144:147], v[8:11]
  ds_read_b64_tr_b16 a[0:1], v211 offset:0
  ds_read_b64_tr_b16 a[2:3], v211 offset:512
  v_mfma_f32_16x16x32_bf16 v[40:43], a[8:11], v[148:151], v[40:43]
  v_mfma_f32_16x16x32_bf16 v[12:15], a[12:15], v[144:147], v[12:15]
  ds_read_b64_tr_b16 a[4:5], v211 offset:8
  ds_read_b64_tr_b16 a[6:7], v211 offset:520
  s_add_u32 s57, s57, 8192
  s_add_u32 s59, s59, 8192
  s_cmp_eq_u32 s59, 49152
  s_cselect_b32 s59, 0, s59
  s_xor_b32 s72, s56, s70
  s_add_u32 m0, s58, s43
  s_nop 0
  buffer_load_dwordx4 v207, s[24:27], s72 offen nt lds
  v_mfma_f32_16x16x32_bf16 v[44:47], a[12:15], v[148:151], v[44:47]
  s_waitcnt lgkmcnt(8)
  v_mfma_f32_16x16x32_bf16 v[16:19], a[16:19], v[144:147], v[16:19]
  ds_read_b64_tr_b16 a[8:9], v212 offset:0
  ds_read_b64_tr_b16 a[10:11], v212 offset:512
  v_mfma_f32_16x16x32_bf16 v[48:51], a[16:19], v[148:151], v[48:51]
  s_add_u32 m0, m0, 896
  s_nop 0
  buffer_load_dwordx4 v207, s[24:27], s72 offen offset:128 nt lds
  s_add_u32 s56, s56, 8192
  s_add_u32 s58, s58, 8192
  s_and_b32 s58, s58, 32767
  v_mfma_f32_16x16x32_bf16 v[20:23], a[20:23], v[144:147], v[20:23]
  ds_read_b64_tr_b16 a[12:13], v212 offset:8
  ds_read_b64_tr_b16 a[14:15], v212 offset:520
  v_mfma_f32_16x16x32_bf16 v[52:55], a[20:23], v[148:151], v[52:55]
  ds_read_b128 v[156:159], v171 offset:0
  ds_read_b128 v[160:163], v171 offset:2048
  s_waitcnt lgkmcnt(10)
  v_mfma_f32_16x16x32_bf16 v[24:27], a[24:27], v[144:147], v[24:27]
  ds_read_b64_tr_b16 a[16:17], v211 offset:1024
  ds_read_b64_tr_b16 a[18:19], v211 offset:1536
  v_mfma_f32_16x16x32_bf16 v[56:59], a[24:27], v[148:151], v[56:59]
  v_mfma_f32_16x16x32_bf16 v[28:31], a[28:31], v[144:147], v[28:31]
  ds_read_b64_tr_b16 a[20:21], v211 offset:1032
  ds_read_b64_tr_b16 a[22:23], v211 offset:1544
  v_mfma_f32_16x16x32_bf16 v[60:63], a[28:31], v[148:151], v[60:63]
  s_barrier
  s_waitcnt lgkmcnt(5)
  v_mfma_f32_16x16x32_bf16 v[0:3], a[0:3], v[156:159], v[0:3]
  ds_read_b64_tr_b16 a[24:25], v212 offset:1024
  ds_read_b64_tr_b16 a[26:27], v212 offset:1536
  s_xor_b32 s72, s56, s70
  s_add_u32 m0, s58, s43
  s_nop 0
  buffer_load_dwordx4 v207, s[24:27], s72 offen nt lds
  s_waitcnt lgkmcnt(6)
  v_mfma_f32_16x16x32_bf16 v[32:35], a[0:3], v[160:163], v[32:35]
  v_mfma_f32_16x16x32_bf16 v[4:7], a[4:7], v[156:159], v[4:7]
  ds_read_b64_tr_b16 a[28:29], v212 offset:1032
  ds_read_b64_tr_b16 a[30:31], v212 offset:1544
  v_mfma_f32_16x16x32_bf16 v[36:39], a[4:7], v[160:163], v[36:39]
  v_mfma_f32_16x16x32_bf16 v[8:11], a[8:11], v[156:159], v[8:11]
  v_mfma_f32_16x16x32_bf16 v[40:43], a[8:11], v[160:163], v[40:43]
  v_mfma_f32_16x16x32_bf16 v[12:15], a[12:15], v[156:159], v[12:15]
  s_add_u32 m0, m0, 896
  s_nop 0
  buffer_load_dwordx4 v207, s[24:27], s72 offen offset:128 nt lds
  s_add_u32 s56, s56, 8192
  s_add_u32 s58, s58, 8192
  s_and_b32 s58, s58, 32767
  v_mfma_f32_16x16x32_bf16 v[44:47], a[12:15], v[160:163], v[44:47]
  s_waitcnt lgkmcnt(4)
  v_mfma_f32_16x16x32_bf16 v[16:19], a[16:19], v[156:159], v[16:19]
  v_mfma_f32_16x16x32_bf16 v[48:51], a[16:19], v[160:163], v[48:51]
  v_mfma_f32_16x16x32_bf16 v[20:23], a[20:23], v[156:159], v[20:23]
  v_mfma_f32_16x16x32_bf16 v[52:55], a[20:23], v[160:163], v[52:55]
  s_waitcnt lgkmcnt(0)
  v_mfma_f32_16x16x32_bf16 v[24:27], a[24:27], v[156:159], v[24:27]
  v_mfma_f32_16x16x32_bf16 v[56:59], a[24:27], v[160:163], v[56:59]
  v_mfma_f32_16x16x32_bf16 v[28:31], a[28:31], v[156:159], v[28:31]
  v_mfma_f32_16x16x32_bf16 v[60:63], a[28:31], v[160:163], v[60:63]
  s_barrier
  s_nop 7
  v_mul_f32 v0, s64, v0
  v_mul_f32 v1, s64, v1
  v_mul_f32 v2, s64, v2
  v_mul_f32 v3, s64, v3
  v_mul_f32 v4, s64, v4
  v_mul_f32 v5, s64, v5
  v_mul_f32 v6, s64, v6
  v_mul_f32 v7, s64, v7
  v_cvt_pk_bf16_f32 v96, v0, v1
  v_cvt_pk_bf16_f32 v97, v2, v3
  v_cvt_pk_bf16_f32 v98, v4, v5
  v_cvt_pk_bf16_f32 v99, v6, v7
  v_mul_f32 v8, s64, v8
  v_mul_f32 v9, s64, v9
  v_mul_f32 v10, s64, v10
  v_mul_f32 v11, s64, v11
  v_mul_f32 v12, s64, v12
  v_mul_f32 v13, s64, v13
  v_mul_f32 v14, s64, v14
  v_mul_f32 v15, s64, v15
  v_cvt_pk_bf16_f32 v100, v8, v9
  v_cvt_pk_bf16_f32 v101, v10, v11
  v_cvt_pk_bf16_f32 v102, v12, v13
  v_cvt_pk_bf16_f32 v103, v14, v15
  v_mul_f32 v16, s64, v16
  v_mul_f32 v17, s64, v17
  v_mul_f32 v18, s64, v18
  v_mul_f32 v19, s64, v19
  v_mul_f32 v20, s64, v20
  v_mul_f32 v21, s64, v21
  v_mul_f32 v22, s64, v22
  v_mul_f32 v23, s64, v23
  v_cvt_pk_bf16_f32 v104, v16, v17
  v_cvt_pk_bf16_f32 v105, v18, v19
  v_cvt_pk_bf16_f32 v106, v20, v21
  v_cvt_pk_bf16_f32 v107, v22, v23
  v_mul_f32 v24, s64, v24
  v_mul_f32 v25, s64, v25
  v_mul_f32 v26, s64, v26
  v_mul_f32 v27, s64, v27
  v_mul_f32 v28, s64, v28
  v_mul_f32 v29, s64, v29
  v_mul_f32 v30, s64, v30
  v_mul_f32 v31, s64, v31
  v_cvt_pk_bf16_f32 v108, v24, v25
  v_cvt_pk_bf16_f32 v109, v26, v27
  v_cvt_pk_bf16_f32 v110, v28, v29
  v_cvt_pk_bf16_f32 v111, v30, v31
  v_mul_f32 v32, s64, v32
  v_mul_f32 v33, s64, v33
  v_mul_f32 v34, s64, v34
  v_mul_f32 v35, s64, v35
  v_mul_f32 v36, s64, v36
  v_mul_f32 v37, s64, v37
  v_mul_f32 v38, s64, v38
  v_mul_f32 v39, s64, v39
  v_cvt_pk_bf16_f32 v112, v32, v33
  v_cvt_pk_bf16_f32 v113, v34, v35
  v_cvt_pk_bf16_f32 v114, v36, v37
  v_cvt_pk_bf16_f32 v115, v38, v39
  v_mul_f32 v40, s64, v40
  v_mul_f32 v41, s64, v41
  v_mul_f32 v42, s64, v42
  v_mul_f32 v43, s64, v43
  v_mul_f32 v44, s64, v44
  v_mul_f32 v45, s64, v45
  v_mul_f32 v46, s64, v46
  v_mul_f32 v47, s64, v47
  v_cvt_pk_bf16_f32 v116, v40, v41
  v_cvt_pk_bf16_f32 v117, v42, v43
  v_cvt_pk_bf16_f32 v118, v44, v45
  v_cvt_pk_bf16_f32 v119, v46, v47
  v_mul_f32 v48, s64, v48
  v_mul_f32 v49, s64, v49
  v_mul_f32 v50, s64, v50
  v_mul_f32 v51, s64, v51
  v_mul_f32 v52, s64, v52
  v_mul_f32 v53, s64, v53
  v_mul_f32 v54, s64, v54
  v_mul_f32 v55, s64, v55
  v_cvt_pk_bf16_f32 v120, v48, v49
  v_cvt_pk_bf16_f32 v121, v50, v51
  v_cvt_pk_bf16_f32 v122, v52, v53
  v_cvt_pk_bf16_f32 v123, v54, v55
  v_mul_f32 v56, s64, v56
  v_mul_f32 v57, s64, v57
  v_mul_f32 v58, s64, v58
  v_mul_f32 v59, s64, v59
  v_mul_f32 v60, s64, v60
  v_mul_f32 v61, s64, v61
  v_mul_f32 v62, s64, v62
  v_mul_f32 v63, s64, v63
  v_cvt_pk_bf16_f32 v124, v56, v57
  v_cvt_pk_bf16_f32 v125, v58, v59
  v_cvt_pk_bf16_f32 v126, v60, v61
  v_cvt_pk_bf16_f32 v127, v62, v63
K1T2_mid:
  s_setprio 1
  s_waitcnt vmcnt(6)
  s_barrier
  v_mov_b32 v215, 151552
  ds_read_b32 v216, v215
  ds_read_b128 a[0:3], v197 offset:0
  ds_read_b128 a[4:7], v198 offset:0
  ds_read_b128 a[8:11], v197 offset:1024
  ds_read_b128 a[12:15], v198 offset:1024
  ds_read_b128 a[16:19], v197 offset:4096
  ds_read_b128 a[20:23], v198 offset:4096
  s_waitcnt lgkmcnt(6)
  v_readfirstlane_b32 s63, v216
  s_cmp_eq_u32 s63, 0
  s_cbranch_scc1 K1T2_hA_ok
  s_mov_b32 s63, 0
K1T2_hA_loop:
  s_barrier
  s_add_u32 s63, s63, 1
  s_cmp_lt_u32 s63, 64
  s_cbranch_scc1 K1T2_hA_loop
K1T2_hA_ok:
  s_waitcnt lgkmcnt(4)
  v_mfma_f32_16x16x32_bf16 v[144:147], a[0:3], v[96:99], 0
  ds_read_b128 a[24:27], v197 offset:5120
  v_mov_b64 v[0:1], 0
  v_mov_b64 v[2:3], 0
  v_mfma_f32_16x16x32_bf16 v[152:155], a[0:3], v[112:115], 0
  v_mov_b64 v[4:5], 0
  v_mov_b64 v[6:7], 0
  v_mfma_f32_16x16x32_bf16 v[144:147], a[4:7], v[100:103], v[144:147]
  ds_read_b128 a[28:31], v198 offset:5120
  v_mov_b64 v[8:9], 0
  v_mov_b64 v[10:11], 0
  v_mfma_f32_16x16x32_bf16 v[152:155], a[4:7], v[116:119], v[152:155]
  v_mov_b64 v[12:13], 0
  v_mov_b64 v[14:15], 0
  v_mov_b64 v[16:17], 0
  s_waitcnt lgkmcnt(4)
  v_mfma_f32_16x16x32_bf16 v[144:147], a[8:11], v[104:107], v[144:147]
  ds_read_b128 a[0:3], v197 offset:8192
  v_mov_b64 v[18:19], 0
  v_mov_b64 v[20:21], 0
  v_mfma_f32_16x16x32_bf16 v[152:155], a[8:11], v[120:123], v[152:155]
  v_mov_b64 v[22:23], 0
  v_mov_b64 v[24:25], 0
  v_mfma_f32_16x16x32_bf16 v[144:147], a[12:15], v[108:111], v[144:147]
  ds_read_b128 a[4:7], v198 offset:8192
  v_mov_b64 v[26:27], 0
  v_mov_b64 v[28:29], 0
  v_mfma_f32_16x16x32_bf16 v[152:155], a[12:15], v[124:127], v[152:155]
  v_mov_b64 v[30:31], 0
  v_mov_b64 v[32:33], 0
  s_waitcnt lgkmcnt(4)
  v_mfma_f32_16x16x32_bf16 v[148:151], a[16:19], v[96:99], 0
  ds_read_b128 a[8:11], v197 offset:9216
  v_mov_b64 v[34:35], 0
  v_mov_b64 v[36:37], 0
  v_mfma_f32_16x16x32_bf16 v[156:159], a[16:19], v[112:115], 0
  v_mov_b64 v[38:39], 0
  v_mov_b64 v[40:41], 0
  v_mfma_f32_16x16x32_bf16 v[148:151], a[20:23], v[100:103], v[148:151]
  ds_read_b128 a[12:15], v198 offset:9216
  v_mov_b64 v[42:43], 0
  v_mov_b64 v[44:45], 0
  v_mfma_f32_16x16x32_bf16 v[156:159], a[20:23], v[116:119], v[156:159]
  v_mov_b64 v[46:47], 0
  v_mov_b64 v[48:49], 0
  v_mov_b64 v[50:51], 0
  s_waitcnt lgkmcnt(4)
  v_mfma_f32_16x16x32_bf16 v[148:151], a[24:27], v[104:107], v[148:151]
  ds_read_b128 a[16:19], v197 offset:12288
  v_mov_b64 v[52:53], 0
  v_mov_b64 v[54:55], 0
  v_mfma_f32_16x16x32_bf16 v[156:159], a[24:27], v[120:123], v[156:159]
  v_mov_b64 v[56:57], 0
  v_mov_b64 v[58:59], 0
  v_mfma_f32_16x16x32_bf16 v[148:151], a[28:31], v[108:111], v[148:151]
  ds_read_b128 a[20:23], v198 offset:12288
  v_mov_b64 v[60:61], 0
  v_mov_b64 v[62:63], 0
  v_mfma_f32_16x16x32_bf16 v[156:159], a[28:31], v[124:127], v[156:159]
  v_mov_b32 v192, 0
  v_mov_b32 v193, 0
  s_barrier
  s_waitcnt lgkmcnt(4)
  v_mfma_f32_16x16x32_bf16 v[168:171], a[0:3], v[96:99], 0
  ds_read_b128 a[24:27], v197 offset:13312
  v_exp_f32 v144, v144
  v_exp_f32 v145, v145
  v_mfma_f32_16x16x32_bf16 v[176:179], a[0:3], v[112:115], 0
  v_add_f32 v192, v192, v144
  v_exp_f32 v146, v146
  v_mfma_f32_16x16x32_bf16 v[168:171], a[4:7], v[100:103], v[168:171]
  ds_read_b128 a[28:31], v198 offset:13312
  v_add_f32 v192, v192, v145
  v_cvt_pk_bf16_f32 v144, v144, v145
  v_exp_f32 v147, v147
  v_mfma_f32_16x16x32_bf16 v[176:179], a[4:7], v[116:119], v[176:179]
  v_add_f32 v192, v192, v146
  v_exp_f32 v148, v148
  s_waitcnt lgkmcnt(4)
  v_mfma_f32_16x16x32_bf16 v[168:171], a[8:11], v[104:107], v[168:171]
  ds_read_b64_tr_b16 a[0:1], v203 offset:0
  ds_read_b64_tr_b16 a[2:3], v203 offset:4096
  v_add_f32 v192, v192, v147
  v_cvt_pk_bf16_f32 v145, v146, v147
  v_exp_f32 v149, v149
  v_mfma_f32_16x16x32_bf16 v[176:179], a[8:11], v[120:123], v[176:179]
  v_xor_b32 v197, 16384, v197
  v_xor_b32 v198, 16384, v198
  v_add_f32 v192, v192, v148
  v_exp_f32 v150, v150
  v_mfma_f32_16x16x32_bf16 v[168:171], a[12:15], v[108:111], v[168:171]
  ds_read_b64_tr_b16 a[4:5], v204 offset:0
  ds_read_b64_tr_b16 a[6:7], v204 offset:4096
  v_add_f32 v192, v192, v149
  v_cvt_pk_bf16_f32 v146, v148, v149
  v_exp_f32 v151, v151
  v_mfma_f32_16x16x32_bf16 v[176:179], a[12:15], v[124:127], v[176:179]
  v_add_f32 v192, v192, v150
  v_add_f32 v192, v192, v151
  v_cvt_pk_bf16_f32 v147, v150, v151
  s_waitcnt lgkmcnt(6)
  v_mfma_f32_16x16x32_bf16 v[172:175], a[16:19], v[96:99], 0
  ds_read_b64_tr_b16 a[8:9], v205 offset:0
  ds_read_b64_tr_b16 a[10:11], v205 offset:4096
  v_exp_f32 v152, v152
  v_exp_f32 v153, v153
  v_mfma_f32_16x16x32_bf16 v[180:183], a[16:19], v[112:115], 0
  v_add_f32 v193, v193, v152
  v_exp_f32 v154, v154
  v_mfma_f32_16x16x32_bf16 v[172:175], a[20:23], v[100:103], v[172:175]
  ds_read_b64_tr_b16 a[12:13], v206 offset:0
  ds_read_b64_tr_b16 a[14:15], v206 offset:4096
  v_add_f32 v193, v193, v153
  v_cvt_pk_bf16_f32 v152, v152, v153
  v_exp_f32 v155, v155
  v_mfma_f32_16x16x32_bf16 v[180:183], a[20:23], v[116:119], v[180:183]
  v_add_f32 v193, v193, v154
  v_exp_f32 v156, v156
  s_waitcnt lgkmcnt(8)
  v_mfma_f32_16x16x32_bf16 v[172:175], a[24:27], v[104:107], v[172:175]
  ds_read_b64_tr_b16 a[16:17], v203 offset:1024
  ds_read_b64_tr_b16 a[18:19], v203 offset:5120
  v_add_f32 v193, v193, v155
  v_cvt_pk_bf16_f32 v153, v154, v155
  v_exp_f32 v157, v157
  v_mfma_f32_16x16x32_bf16 v[180:183], a[24:27], v[120:123], v[180:183]
  v_add_f32 v193, v193, v156
  v_exp_f32 v158, v158
  v_mfma_f32_16x16x32_bf16 v[172:175], a[28:31], v[108:111], v[172:175]
  ds_read_b64_tr_b16 a[20:21], v204 offset:1024
  ds_read_b64_tr_b16 a[22:23], v204 offset:5120
  v_add_f32 v193, v193, v157
  v_cvt_pk_bf16_f32 v154, v156, v157
  v_exp_f32 v159, v159
  v_mfma_f32_16x16x32_bf16 v[180:183], a[28:31], v[124:127], v[180:183]
  v_add_f32 v193, v193, v158
  v_add_f32 v193, v193, v159
  v_cvt_pk_bf16_f32 v155, v158, v159
  s_mov_b32 s62, 0
K1T2_attloop:
  s_waitcnt vmcnt(2)
  s_barrier
  s_waitcnt lgkmcnt(8)
  v_mfma_f32_16x16x32_bf16 v[0:3], a[0:3], v[144:147], v[0:3]
  ds_read_b64_tr_b16 a[24:25], v205 offset:1024
  ds_read_b64_tr_b16 a[26:27], v205 offset:5120
  v_exp_f32 v168, v168
  v_mfma_f32_16x16x32_bf16 v[32:35], a[0:3], v[152:155], v[32:35]
  v_exp_f32 v169, v169
  v_mfma_f32_16x16x32_bf16 v[4:7], a[4:7], v[144:147], v[4:7]
  ds_read_b64_tr_b16 a[28:29], v206 offset:1024
  ds_read_b64_tr_b16 a[30:31], v206 offset:5120
  v_add_f32 v192, v192, v168
  v_mfma_f32_16x16x32_bf16 v[36:39], a[4:7], v[152:155], v[36:39]
  v_exp_f32 v170, v170
  s_waitcnt lgkmcnt(8)
  v_mfma_f32_16x16x32_bf16 v[8:11], a[8:11], v[144:147], v[8:11]
  ds_read_b128 a[0:3], v197 offset:0
  v_add_f32 v192, v192, v169
  v_cvt_pk_bf16_f32 v168, v168, v169
  v_mfma_f32_16x16x32_bf16 v[40:43], a[8:11], v[152:155], v[40:43]
  v_exp_f32 v171, v171
  v_mfma_f32_16x16x32_bf16 v[12:15], a[12:15], v[144:147], v[12:15]
  ds_read_b128 a[4:7], v198 offset:0
  v_add_f32 v192, v192, v170
  v_mfma_f32_16x16x32_bf16 v[44:47], a[12:15], v[152:155], v[44:47]
  v_exp_f32 v172, v172
  s_waitcnt lgkmcnt(6)
  v_mfma_f32_16x16x32_bf16 v[16:19], a[16:19], v[144:147], v[16:19]
  ds_read_b128 a[8:11], v197 offset:1024
  v_add_f32 v192, v192, v171
  v_cvt_pk_bf16_f32 v169, v170, v171
  v_mfma_f32_16x16x32_bf16 v[48:51], a[16:19], v[152:155], v[48:51]
  v_exp_f32 v173, v173
  v_mfma_f32_16x16x32_bf16 v[20:23], a[20:23], v[144:147], v[20:23]
  ds_read_b128 a[12:15], v198 offset:1024
  v_add_f32 v192, v192, v172
  v_mfma_f32_16x16x32_bf16 v[52:55], a[20:23], v[152:155], v[52:55]
  v_exp_f32 v174, v174
  s_waitcnt lgkmcnt(4)
  v_mfma_f32_16x16x32_bf16 v[24:27], a[24:27], v[144:147], v[24:27]
  ds_read_b128 a[16:19], v197 offset:4096
  v_add_f32 v192, v192, v173
  v_cvt_pk_bf16_f32 v170, v172, v173
  v_mfma_f32_16x16x32_bf16 v[56:59], a[24:27], v[152:155], v[56:59]
  v_exp_f32 v175, v175
  v_mfma_f32_16x16x32_bf16 v[28:31], a[28:31], v[144:147], v[28:31]
  ds_read_b128 a[20:23], v198 offset:4096
  v_add_f32 v192, v192, v174
  v_mfma_f32_16x16x32_bf16 v[60:63], a[28:31], v[152:155], v[60:63]
  v_add_f32 v192, v192, v175
  v_cvt_pk_bf16_f32 v171, v174, v175
  s_waitcnt lgkmcnt(4)
  v_mfma_f32_16x16x32_bf16 v[144:147], a[0:3], v[96:99], 0
  ds_read_b128 a[24:27], v197 offset:5120
  v_exp_f32 v176, v176
  v_mfma_f32_16x16x32_bf16 v[152:155], a[0:3], v[112:115], 0
  v_exp_f32 v177, v177
  v_mfma_f32_16x16x32_bf16 v[144:147], a[4:7], v[100:103], v[144:147]
  ds_read_b128 a[28:31], v198 offset:5120
  v_add_f32 v193, v193, v176
  v_mfma_f32_16x16x32_bf16 v[152:155], a[4:7], v[116:119], v[152:155]
  v_exp_f32 v178, v178
  s_waitcnt lgkmcnt(4)
  v_mfma_f32_16x16x32_bf16 v[144:147], a[8:11], v[104:107], v[144:147]
  ds_read_b64_tr_b16 a[0:1], v203 offset:8192
  ds_read_b64_tr_b16 a[2:3], v203 offset:12288
  v_add_f32 v193, v193, v177
  v_cvt_pk_bf16_f32 v176, v176, v177
  v_mfma_f32_16x16x32_bf16 v[152:155], a[8:11], v[120:123], v[152:155]
  v_exp_f32 v179, v179
  v_mfma_f32_16x16x32_bf16 v[144:147], a[12:15], v[108:111], v[144:147]
  ds_read_b64_tr_b16 a[4:5], v204 offset:8192
  ds_read_b64_tr_b16 a[6:7], v204 offset:12288
  v_add_f32 v193, v193, v178
  v_mfma_f32_16x16x32_bf16 v[152:155], a[12:15], v[124:127], v[152:155]
  v_exp_f32 v180, v180
  s_waitcnt lgkmcnt(6)
  v_mfma_f32_16x16x32_bf16 v[148:151], a[16:19], v[96:99], 0
  ds_read_b64_tr_b16 a[8:9], v205 offset:8192
  ds_read_b64_tr_b16 a[10:11], v205 offset:12288
  v_add_f32 v193, v193, v179
  v_cvt_pk_bf16_f32 v177, v178, v179
  v_mfma_f32_16x16x32_bf16 v[156:159], a[16:19], v[112:115], 0
  v_exp_f32 v181, v181
  v_mfma_f32_16x16x32_bf16 v[148:151], a[20:23], v[100:103], v[148:151]
  ds_read_b64_tr_b16 a[12:13], v206 offset:8192
  ds_read_b64_tr_b16 a[14:15], v206 offset:12288
  v_add_f32 v193, v193, v180
  v_mfma_f32_16x16x32_bf16 v[156:159], a[20:23], v[116:119], v[156:159]
  v_exp_f32 v182, v182
  s_waitcnt lgkmcnt(8)
  v_mfma_f32_16x16x32_bf16 v[148:151], a[24:27], v[104:107], v[148:151]
  ds_read_b64_tr_b16 a[16:17], v203 offset:9216
  ds_read_b64_tr_b16 a[18:19], v203 offset:13312
  v_add_f32 v193, v193, v181
  v_cvt_pk_bf16_f32 v178, v180, v181
  v_mfma_f32_16x16x32_bf16 v[156:159], a[24:27], v[120:123], v[156:159]
  v_exp_f32 v183, v183
  v_mfma_f32_16x16x32_bf16 v[148:151], a[28:31], v[108:111], v[148:151]
  ds_read_b64_tr_b16 a[20:21], v204 offset:9216
  ds_read_b64_tr_b16 a[22:23], v204 offset:13312
  v_add_f32 v193, v193, v182
  v_mfma_f32_16x16x32_bf16 v[156:159], a[28:31], v[124:127], v[156:159]
  v_add_f32 v193, v193, v183
  v_cvt_pk_bf16_f32 v179, v182, v183
  s_waitcnt vmcnt(0)
  s_barrier
  s_waitcnt lgkmcnt(8)
  v_mfma_f32_16x16x32_bf16 v[0:3], a[0:3], v[168:171], v[0:3]
  ds_read_b64_tr_b16 a[24:25], v205 offset:9216
  ds_read_b64_tr_b16 a[26:27], v205 offset:13312
  v_exp_f32 v144, v144
  v_mfma_f32_16x16x32_bf16 v[32:35], a[0:3], v[176:179], v[32:35]
  v_exp_f32 v145, v145
  v_mfma_f32_16x16x32_bf16 v[4:7], a[4:7], v[168:171], v[4:7]
  ds_read_b64_tr_b16 a[28:29], v206 offset:9216
  ds_read_b64_tr_b16 a[30:31], v206 offset:13312
  v_add_f32 v192, v192, v144
  v_mfma_f32_16x16x32_bf16 v[36:39], a[4:7], v[176:179], v[36:39]
  v_exp_f32 v146, v146
  s_waitcnt lgkmcnt(8)
  v_mfma_f32_16x16x32_bf16 v[8:11], a[8:11], v[168:171], v[8:11]
  ds_read_b128 a[0:3], v197 offset:8192
  v_add_f32 v192, v192, v145
  v_cvt_pk_bf16_f32 v144, v144, v145
  v_mfma_f32_16x16x32_bf16 v[40:43], a[8:11], v[176:179], v[40:43]
  s_add_u32 s61, s61, 16384
  s_cmp_eq_u32 s61, 81920
  s_cselect_b32 s61, 32768, s61
  v_add_u32 v203, s61, v199
  v_add_u32 v204, s61, v200
  v_add_u32 v205, s61, v201
  v_add_u32 v206, s61, v202
  v_exp_f32 v147, v147
  v_mfma_f32_16x16x32_bf16 v[12:15], a[12:15], v[168:171], v[12:15]
  ds_read_b128 a[4:7], v198 offset:8192
  v_add_f32 v192, v192, v146
  v_mfma_f32_16x16x32_bf16 v[44:47], a[12:15], v[176:179], v[44:47]
  v_exp_f32 v148, v148
  s_waitcnt lgkmcnt(6)
  v_mfma_f32_16x16x32_bf16 v[16:19], a[16:19], v[168:171], v[16:19]
  ds_read_b128 a[8:11], v197 offset:9216
  v_add_f32 v192, v192, v147
  v_cvt_pk_bf16_f32 v145, v146, v147
  v_mfma_f32_16x16x32_bf16 v[48:51], a[16:19], v[176:179], v[48:51]
  v_exp_f32 v149, v149
  v_mfma_f32_16x16x32_bf16 v[20:23], a[20:23], v[168:171], v[20:23]
  ds_read_b128 a[12:15], v198 offset:9216
  v_add_f32 v192, v192, v148
  v_mfma_f32_16x16x32_bf16 v[52:55], a[20:23], v[176:179], v[52:55]
  v_exp_f32 v150, v150
  s_waitcnt lgkmcnt(4)
  v_mfma_f32_16x16x32_bf16 v[24:27], a[24:27], v[168:171], v[24:27]
  ds_read_b128 a[16:19], v197 offset:12288
  v_add_f32 v192, v192, v149
  v_cvt_pk_bf16_f32 v146, v148, v149
  v_mfma_f32_16x16x32_bf16 v[56:59], a[24:27], v[176:179], v[56:59]
  v_exp_f32 v151, v151
  v_mfma_f32_16x16x32_bf16 v[28:31], a[28:31], v[168:171], v[28:31]
  ds_read_b128 a[20:23], v198 offset:12288
  v_add_f32 v192, v192, v150
  v_mfma_f32_16x16x32_bf16 v[60:63], a[28:31], v[176:179], v[60:63]
  v_add_f32 v192, v192, v151
  v_cvt_pk_bf16_f32 v147, v150, v151
  s_waitcnt lgkmcnt(4)
  v_mfma_f32_16x16x32_bf16 v[168:171], a[0:3], v[96:99], 0
  ds_read_b128 a[24:27], v197 offset:13312
  v_exp_f32 v152, v152
  v_mfma_f32_16x16x32_bf16 v[176:179], a[0:3], v[112:115], 0
  v_exp_f32 v153, v153
  v_mfma_f32_16x16x32_bf16 v[168:171], a[4:7], v[100:103], v[168:171]
  ds_read_b128 a[28:31], v198 offset:13312
  v_add_f32 v193, v193, v152
  v_mfma_f32_16x16x32_bf16 v[176:179], a[4:7], v[116:119], v[176:179]
  v_exp_f32 v154, v154
  s_waitcnt lgkmcnt(4)
  v_mfma_f32_16x16x32_bf16 v[168:171], a[8:11], v[104:107], v[168:171]
  ds_read_b64_tr_b16 a[0:1], v203 offset:0
  ds_read_b64_tr_b16 a[2:3], v203 offset:4096
  v_add_f32 v193, v193, v153
  v_cvt_pk_bf16_f32 v152, v152, v153
  v_mfma_f32_16x16x32_bf16 v[176:179], a[8:11], v[120:123], v[176:179]
  v_xor_b32 v197, 16384, v197
  v_xor_b32 v198, 16384, v198
  v_exp_f32 v155, v155
  v_mfma_f32_16x16x32_bf16 v[168:171], a[12:15], v[108:111], v[168:171]
  ds_read_b64_tr_b16 a[4:5], v204 offset:0
  ds_read_b64_tr_b16 a[6:7], v204 offset:4096
  v_add_f32 v193, v193, v154
  v_mfma_f32_16x16x32_bf16 v[176:179], a[12:15], v[124:127], v[176:179]
  v_exp_f32 v156, v156
  s_waitcnt lgkmcnt(6)
  v_mfma_f32_16x16x32_bf16 v[172:175], a[16:19], v[96:99], 0
  ds_read_b64_tr_b16 a[8:9], v205 offset:0
  ds_read_b64_tr_b16 a[10:11], v205 offset:4096
  v_add_f32 v193, v193, v155
  v_cvt_pk_bf16_f32 v153, v154, v155
  v_mfma_f32_16x16x32_bf16 v[180:183], a[16:19], v[112:115], 0
  v_exp_f32 v157, v157
  v_mfma_f32_16x16x32_bf16 v[172:175], a[20:23], v[100:103], v[172:175]
  ds_read_b64_tr_b16 a[12:13], v206 offset:0
  ds_read_b64_tr_b16 a[14:15], v206 offset:4096
  v_add_f32 v193, v193, v156
  v_mfma_f32_16x16x32_bf16 v[180:183], a[20:23], v[116:119], v[180:183]
  v_exp_f32 v158, v158
  s_waitcnt lgkmcnt(8)
  v_mfma_f32_16x16x32_bf16 v[172:175], a[24:27], v[104:107], v[172:175]
  ds_read_b64_tr_b16 a[16:17], v203 offset:1024
  ds_read_b64_tr_b16 a[18:19], v203 offset:5120
  v_add_f32 v193, v193, v157
  v_cvt_pk_bf16_f32 v154, v156, v157
  v_mfma_f32_16x16x32_bf16 v[180:183], a[24:27], v[120:123], v[180:183]
  v_exp_f32 v159, v159
  v_mfma_f32_16x16x32_bf16 v[172:175], a[28:31], v[108:111], v[172:175]
  ds_read_b64_tr_b16 a[20:21], v204 offset:1024
  ds_read_b64_tr_b16 a[22:23], v204 offset:5120
  v_add_f32 v193, v193, v158
  v_mfma_f32_16x16x32_bf16 v[180:183], a[28:31], v[124:127], v[180:183]
  v_add_f32 v193, v193, v159
  v_cvt_pk_bf16_f32 v155, v158, v159
  s_add_u32 s62, s62, 1
  s_cmp_lt_u32 s62, 7
  s_cbranch_scc1 K1T2_attloop
  s_barrier
  s_waitcnt lgkmcnt(8)
  v_mfma_f32_16x16x32_bf16 v[0:3], a[0:3], v[144:147], v[0:3]
  ds_read_b64_tr_b16 a[24:25], v205 offset:1024
  ds_read_b64_tr_b16 a[26:27], v205 offset:5120
  v_exp_f32 v168, v168
  v_exp_f32 v169, v169
  v_mfma_f32_16x16x32_bf16 v[32:35], a[0:3], v[152:155], v[32:35]
  v_add_f32 v192, v192, v168
  v_exp_f32 v170, v170
  v_mfma_f32_16x16x32_bf16 v[4:7], a[4:7], v[144:147], v[4:7]
  ds_read_b64_tr_b16 a[28:29], v206 offset:1024
  ds_read_b64_tr_b16 a[30:31], v206 offset:5120
  v_add_f32 v192, v192, v169
  v_cvt_pk_bf16_f32 v168, v168, v169
  v_exp_f32 v171, v171
  v_mfma_f32_16x16x32_bf16 v[36:39], a[4:7], v[152:155], v[36:39]
  v_add_f32 v192, v192, v170
  v_exp_f32 v172, v172
  s_waitcnt lgkmcnt(8)
  v_mfma_f32_16x16x32_bf16 v[8:11], a[8:11], v[144:147], v[8:11]
  ds_read_b64_tr_b16 a[0:1], v203 offset:8192
  ds_read_b64_tr_b16 a[2:3], v203 offset:12288
  v_add_f32 v192, v192, v171
  v_cvt_pk_bf16_f32 v169, v170, v171
  v_exp_f32 v173, v173
  v_mfma_f32_16x16x32_bf16 v[40:43], a[8:11], v[152:155], v[40:43]
  v_add_f32 v192, v192, v172
  v_exp_f32 v174, v174
  v_mfma_f32_16x16x32_bf16 v[12:15], a[12:15], v[144:147], v[12:15]
  ds_read_b64_tr_b16 a[4:5], v204 offset:8192
  ds_read_b64_tr_b16 a[6:7], v204 offset:12288
  v_add_f32 v192, v192, v173
  v_cvt_pk_bf16_f32 v170, v172, v173
  v_exp_f32 v175, v175
  v_mfma_f32_16x16x32_bf16 v[44:47], a[12:15], v[152:155], v[44:47]
  v_add_f32 v192, v192, v174
  v_add_f32 v192, v192, v175
  v_cvt_pk_bf16_f32 v171, v174, v175
  s_waitcnt lgkmcnt(8)
  v_mfma_f32_16x16x32_bf16 v[16:19], a[16:19], v[144:147], v[16:19]
  ds_read_b64_tr_b16 a[8:9], v205 offset:8192
  ds_read_b64_tr_b16 a[10:11], v205 offset:12288
  v_exp_f32 v176, v176
  v_exp_f32 v177, v177
  v_mfma_f32_16x16x32_bf16 v[48:51], a[16:19], v[152:155], v[48:51]
  v_add_f32 v193, v193, v176
  v_exp_f32 v178, v178
  v_mfma_f32_16x16x32_bf16 v[20:23], a[20:23], v[144:147], v[20:23]
  ds_read_b64_tr_b16 a[12:13], v206 offset:8192
  ds_read_b64_tr_b16 a[14:15], v206 offset:12288
  v_add_f32 v193, v193, v177
  v_cvt_pk_bf16_f32 v176, v176, v177
  v_exp_f32 v179, v179
  v_mfma_f32_16x16x32_bf16 v[52:55], a[20:23], v[152:155], v[52:55]
  v_add_f32 v193, v193, v178
  v_exp_f32 v180, v180
  s_waitcnt lgkmcnt(8)
  v_mfma_f32_16x16x32_bf16 v[24:27], a[24:27], v[144:147], v[24:27]
  ds_read_b64_tr_b16 a[16:17], v203 offset:9216
  ds_read_b64_tr_b16 a[18:19], v203 offset:13312
  v_add_f32 v193, v193, v179
  v_cvt_pk_bf16_f32 v177, v178, v179
  v_exp_f32 v181, v181
  v_mfma_f32_16x16x32_bf16 v[56:59], a[24:27], v[152:155], v[56:59]
  v_add_f32 v193, v193, v180
  v_exp_f32 v182, v182
  v_mfma_f32_16x16x32_bf16 v[28:31], a[28:31], v[144:147], v[28:31]
  ds_read_b64_tr_b16 a[20:21], v204 offset:9216
  ds_read_b64_tr_b16 a[22:23], v204 offset:13312
  v_add_f32 v193, v193, v181
  v_cvt_pk_bf16_f32 v178, v180, v181
  v_exp_f32 v183, v183
  v_mfma_f32_16x16x32_bf16 v[60:63], a[28:31], v[152:155], v[60:63]
  v_add_f32 v193, v193, v182
  v_add_f32 v193, v193, v183
  v_cvt_pk_bf16_f32 v179, v182, v183
  s_barrier
  s_waitcnt lgkmcnt(8)
  v_mfma_f32_16x16x32_bf16 v[0:3], a[0:3], v[168:171], v[0:3]
  ds_read_b64_tr_b16 a[24:25], v205 offset:9216
  ds_read_b64_tr_b16 a[26:27], v205 offset:13312
  v_mfma_f32_16x16x32_bf16 v[32:35], a[0:3], v[176:179], v[32:35]
  v_mfma_f32_16x16x32_bf16 v[4:7], a[4:7], v[168:171], v[4:7]
  ds_read_b64_tr_b16 a[28:29], v206 offset:9216
  ds_read_b64_tr_b16 a[30:31], v206 offset:13312
  v_mfma_f32_16x16x32_bf16 v[36:39], a[4:7], v[176:179], v[36:39]
  s_waitcnt lgkmcnt(8)
  v_mfma_f32_16x16x32_bf16 v[8:11], a[8:11], v[168:171], v[8:11]
  v_mfma_f32_16x16x32_bf16 v[40:43], a[8:11], v[176:179], v[40:43]
  v_mfma_f32_16x16x32_bf16 v[12:15], a[12:15], v[168:171], v[12:15]
  v_mfma_f32_16x16x32_bf16 v[44:47], a[12:15], v[176:179], v[44:47]
  s_waitcnt lgkmcnt(4)
  v_mfma_f32_16x16x32_bf16 v[16:19], a[16:19], v[168:171], v[16:19]
  v_mfma_f32_16x16x32_bf16 v[48:51], a[16:19], v[176:179], v[48:51]
  v_mfma_f32_16x16x32_bf16 v[20:23], a[20:23], v[168:171], v[20:23]
  v_mfma_f32_16x16x32_bf16 v[52:55], a[20:23], v[176:179], v[52:55]
  s_waitcnt lgkmcnt(0)
  v_mfma_f32_16x16x32_bf16 v[24:27], a[24:27], v[168:171], v[24:27]
  v_mfma_f32_16x16x32_bf16 v[56:59], a[24:27], v[176:179], v[56:59]
  v_mfma_f32_16x16x32_bf16 v[28:31], a[28:31], v[168:171], v[28:31]
  v_mfma_f32_16x16x32_bf16 v[60:63], a[28:31], v[176:179], v[60:63]
  s_setprio 0
  s_nop 7
  v_mov_b32 v215, v192
  v_mov_b32 v216, v192
  s_nop 1
  v_permlane16_swap_b32 v215, v216
  v_add_f32 v192, v215, v216
  v_mov_b32 v215, v192
  v_mov_b32 v216, v192
  s_nop 1
  v_permlane32_swap_b32 v215, v216
  v_add_f32 v192, v215, v216
  v_mov_b32 v215, v193
  v_mov_b32 v216, v193
  s_nop 1
  v_permlane16_swap_b32 v215, v216
  v_add_f32 v193, v215, v216
  v_mov_b32 v215, v193
  v_mov_b32 v216, v193
  s_nop 1
  v_permlane32_swap_b32 v215, v216
  v_add_f32 v193, v215, v216
  s_mov_b32 s63, 0x33800000
  s_mov_b32 s66, 0x4b800000
  s_mov_b64 s[96:97], -1
  v_cmp_le_f32 vcc, s63, v192
  s_nop 0
  s_and_b64 s[96:97], s[96:97], vcc
  v_cmp_ge_f32 vcc, s66, v192
  s_nop 0
  s_and_b64 s[96:97], s[96:97], vcc
  v_cmp_le_f32 vcc, s63, v193
  s_nop 0
  s_and_b64 s[96:97], s[96:97], vcc
  v_cmp_ge_f32 vcc, s66, v193
  s_nop 0
  s_and_b64 s[96:97], s[96:97], vcc
  s_lshl_b32 s67, s41, 2
  s_add_u32 s67, s67, 151552
  v_mov_b32 v215, s67
  s_cmp_eq_u64 s[96:97], -1
  s_cbranch_scc1 K1T2_rowsok
  v_mov_b32 v216, 1
  ds_write_b32 v215, v216
  s_waitcnt lgkmcnt(0)
K1T2_rowsok:
  s_barrier
  ds_read_b32 v216, v215
  s_waitcnt lgkmcnt(0)
  v_readfirstlane_b32 s63, v216
  s_cmp_eq_u32 s63, 0
  s_cbranch_scc1 K1T2_noslow
  s_cmp_eq_u32 s41, 0
  s_cselect_b32 s67, 81920, 0
  v_add_u32 v197, s67, v195
  v_add_u32 v198, s67, v196
  s_add_u32 s66, s67, 8192
  v_add_u32 v203, s66, v199
  v_add_u32 v204, s66, v200
  v_add_u32 v205, s66, v201
  v_add_u32 v206, s66, v202
  v_mov_b32 v168, 0xff800000
  v_mov_b32 v169, 0xff800000
  s_lshl_b32 s60, s41, 17
  s_mov_b32 s61, 0
K1T2_slow_p0:
  s_add_u32 m0, s67, s43
  s_xor_b32 s72, s60, s70
  buffer_load_dwordx4 v207, s[24:27], s72 offen lds
  s_add_u32 m0, m0, 896
  s_nop 0
  buffer_load_dwordx4 v207, s[24:27], s72 offen offset:128 lds
  s_waitcnt vmcnt(0)
  s_barrier
  ds_read_b128 a[0:3], v197 offset:0
  ds_read_b128 a[4:7], v198 offset:0
  ds_read_b128 a[8:11], v197 offset:1024
  ds_read_b128 a[12:15], v198 offset:1024
  ds_read_b128 a[16:19], v197 offset:4096
  ds_read_b128 a[20:23], v198 offset:4096
  ds_read_b128 a[24:27], v197 offset:5120
  ds_read_b128 a[28:31], v198 offset:5120
  s_waitcnt lgkmcnt(0)
  v_mfma_f32_16x16x32_bf16 v[144:147], a[0:3], v[96:99], 0
  v_mfma_f32_16x16x32_bf16 v[152:155], a[0:3], v[112:115], 0
  v_mfma_f32_16x16x32_bf16 v[144:147], a[4:7], v[100:103], v[144:147]
  v_mfma_f32_16x16x32_bf16 v[152:155], a[4:7], v[116:119], v[152:155]
  v_mfma_f32_16x16x32_bf16 v[144:147], a[8:11], v[104:107], v[144:147]
  v_mfma_f32_16x16x32_bf16 v[152:155], a[8:11], v[120:123], v[152:155]
  v_mfma_f32_16x16x32_bf16 v[144:147], a[12:15], v[108:111], v[144:147]
  v_mfma_f32_16x16x32_bf16 v[152:155], a[12:15], v[124:127], v[152:155]
  v_mfma_f32_16x16x32_bf16 v[148:151], a[16:19], v[96:99], 0
  v_mfma_f32_16x16x32_bf16 v[156:159], a[16:19], v[112:115], 0
  v_mfma_f32_16x16x32_bf16 v[148:151], a[20:23], v[100:103], v[148:151]
  v_mfma_f32_16x16x32_bf16 v[156:159], a[20:23], v[116:119], v[156:159]
  v_mfma_f32_16x16x32_bf16 v[148:151], a[24:27], v[104:107], v[148:151]
  v_mfma_f32_16x16x32_bf16 v[156:159], a[24:27], v[120:123], v[156:159]
  v_mfma_f32_16x16x32_bf16 v[148:151], a[28:31], v[108:111], v[148:151]
  v_mfma_f32_16x16x32_bf16 v[156:159], a[28:31], v[124:127], v[156:159]
  s_nop 7
  s_nop 7
  v_max3_f32 v168, v168, v144, v145
  v_max3_f32 v168, v168, v146, v147
  v_max3_f32 v168, v168, v148, v149
  v_max3_f32 v168, v168, v150, v151
  v_max3_f32 v169, v169, v152, v153
  v_max3_f32 v169, v169, v154, v155
  v_max3_f32 v169, v169, v156, v157
  v_max3_f32 v169, v169, v158, v159
  s_barrier
  s_add_u32 s60, s60, 8192
  s_add_u32 s61, s61, 1
  s_cmp_lt_u32 s61, 16
  s_cbranch_scc1 K1T2_slow_p0
  v_mov_b32 v215, v168
  v_mov_b32 v216, v168
  s_nop 1
  v_permlane16_swap_b32 v215, v216
  v_max_f32 v168, v215, v216
  v_mov_b32 v215, v168
  v_mov_b32 v216, v168
  s_nop 1
  v_permlane32_swap_b32 v215, v216
  v_max_f32 v168, v215, v216
  v_mov_b32 v215, v169
  v_mov_b32 v216, v169
  s_nop 1
  v_permlane16_swap_b32 v215, v216
  v_max_f32 v169, v215, v216
  v_mov_b32 v215, v169
  v_mov_b32 v216, v169
  s_nop 1
  v_permlane32_swap_b32 v215, v216
  v_max_f32 v169, v215, v216
  v_sub_f32 v172, 0, v168
  v_sub_f32 v173, 0, v168
  v_sub_f32 v174, 0, v168
  v_sub_f32 v175, 0, v168
  v_sub_f32 v176, 0, v169
  v_sub_f32 v177, 0, v169
  v_sub_f32 v178, 0, v169
  v_sub_f32 v179, 0, v169
  v_mov_b64 v[0:1], 0
  v_mov_b64 v[2:3], 0
  v_mov_b64 v[4:5], 0
  v_mov_b64 v[6:7], 0
  v_mov_b64 v[8:9], 0
  v_mov_b64 v[10:11], 0
  v_mov_b64 v[12:13], 0
  v_mov_b64 v[14:15], 0
  v_mov_b64 v[16:17], 0
  v_mov_b64 v[18:19], 0
  v_mov_b64 v[20:21], 0
  v_mov_b64 v[22:23], 0
  v_mov_b64 v[24:25], 0
  v_mov_b64 v[26:27], 0
  v_mov_b64 v[28:29], 0
  v_mov_b64 v[30:31], 0
  v_mov_b64 v[32:33], 0
  v_mov_b64 v[34:35], 0
  v_mov_b64 v[36:37], 0
  v_mov_b64 v[38:39], 0
  v_mov_b64 v[40:41], 0
  v_mov_b64 v[42:43], 0
  v_mov_b64 v[44:45], 0
  v_mov_b64 v[46:47], 0
  v_mov_b64 v[48:49], 0
  v_mov_b64 v[50:51], 0
  v_mov_b64 v[52:53], 0
  v_mov_b64 v[54:55], 0
  v_mov_b64 v[56:57], 0
  v_mov_b64 v[58:59], 0
  v_mov_b64 v[60:61], 0
  v_mov_b64 v[62:63], 0
  v_mov_b32 v192, 0
  v_mov_b32 v193, 0
  s_lshl_b32 s60, s41, 17
  s_mov_b32 s61, 0
K1T2_slow_p1:
  s_add_u32 m0, s67, s43
  s_xor_b32 s72, s60, s70
  buffer_load_dwordx4 v207, s[24:27], s72 offen lds
  s_add_u32 m0, m0, 896
  s_nop 0
  buffer_load_dwordx4 v207, s[24:27], s72 offen offset:128 lds
  s_add_u32 m0, s67, s43
  s_add_u32 m0, m0, 8192
  s_xor_b32 s72, s60, s70
  buffer_load_dwordx4 v207, s[28:31], s72 offen lds
  s_add_u32 m0, m0, 896
  s_nop 0
  buffer_load_dwordx4 v207, s[28:31], s72 offen offset:128 lds
  s_waitcnt vmcnt(0)
  s_barrier
  ds_read_b128 a[0:3], v197 offset:0
  ds_read_b128 a[4:7], v198 offset:0
  ds_read_b128 a[8:11], v197 offset:1024
  ds_read_b128 a[12:15], v198 offset:1024
  ds_read_b128 a[16:19], v197 offset:4096
  ds_read_b128 a[20:23], v198 offset:4096
  ds_read_b128 a[24:27], v197 offset:5120
  ds_read_b128 a[28:31], v198 offset:5120
  s_waitcnt lgkmcnt(0)
  v_mfma_f32_16x16x32_bf16 v[144:147], a[0:3], v[96:99], v[172:175]
  v_mfma_f32_16x16x32_bf16 v[152:155], a[0:3], v[112:115], v[176:179]
  v_mfma_f32_16x16x32_bf16 v[144:147], a[4:7], v[100:103], v[144:147]
  v_mfma_f32_16x16x32_bf16 v[152:155], a[4:7], v[116:119], v[152:155]
  v_mfma_f32_16x16x32_bf16 v[144:147], a[8:11], v[104:107], v[144:147]
  v_mfma_f32_16x16x32_bf16 v[152:155], a[8:11], v[120:123], v[152:155]
  v_mfma_f32_16x16x32_bf16 v[144:147], a[12:15], v[108:111], v[144:147]
  v_mfma_f32_16x16x32_bf16 v[152:155], a[12:15], v[124:127], v[152:155]
  v_mfma_f32_16x16x32_bf16 v[148:151], a[16:19], v[96:99], v[172:175]
  v_mfma_f32_16x16x32_bf16 v[156:159], a[16:19], v[112:115], v[176:179]
  v_mfma_f32_16x16x32_bf16 v[148:151], a[20:23], v[100:103], v[148:151]
  v_mfma_f32_16x16x32_bf16 v[156:159], a[20:23], v[116:119], v[156:159]
  v_mfma_f32_16x16x32_bf16 v[148:151], a[24:27], v[104:107], v[148:151]
  v_mfma_f32_16x16x32_bf16 v[156:159], a[24:27], v[120:123], v[156:159]
  v_mfma_f32_16x16x32_bf16 v[148:151], a[28:31], v[108:111], v[148:151]
  v_mfma_f32_16x16x32_bf16 v[156:159], a[28:31], v[124:127], v[156:159]
  s_nop 7
  s_nop 7
  v_exp_f32 v144, v144
  v_exp_f32 v145, v145
  v_exp_f32 v146, v146
  v_exp_f32 v147, v147
  v_exp_f32 v148, v148
  v_exp_f32 v149, v149
  v_exp_f32 v150, v150
  v_exp_f32 v151, v151
  s_nop 0
  v_add_f32 v192, v192, v144
  v_add_f32 v192, v192, v145
  v_add_f32 v192, v192, v146
  v_add_f32 v192, v192, v147
  v_add_f32 v192, v192, v148
  v_add_f32 v192, v192, v149
  v_add_f32 v192, v192, v150
  v_add_f32 v192, v192, v151
  v_cvt_pk_bf16_f32 v144, v144, v145
  v_cvt_pk_bf16_f32 v145, v146, v147
  v_cvt_pk_bf16_f32 v146, v148, v149
  v_cvt_pk_bf16_f32 v147, v150, v151
  v_exp_f32 v152, v152
  v_exp_f32 v153, v153
  v_exp_f32 v154, v154
  v_exp_f32 v155, v155
  v_exp_f32 v156, v156
  v_exp_f32 v157, v157
  v_exp_f32 v158, v158
  v_exp_f32 v159, v159
  s_nop 0
  v_add_f32 v193, v193, v152
  v_add_f32 v193, v193, v153
  v_add_f32 v193, v193, v154
  v_add_f32 v193, v193, v155
  v_add_f32 v193, v193, v156
  v_add_f32 v193, v193, v157
  v_add_f32 v193, v193, v158
  v_add_f32 v193, v193, v159
  v_cvt_pk_bf16_f32 v152, v152, v153
  v_cvt_pk_bf16_f32 v153, v154, v155
  v_cvt_pk_bf16_f32 v154, v156, v157
  v_cvt_pk_bf16_f32 v155, v158, v159
  ds_read_b64_tr_b16 a[0:1], v203 offset:0
  ds_read_b64_tr_b16 a[2:3], v203 offset:4096
  ds_read_b64_tr_b16 a[4:5], v204 offset:0
  ds_read_b64_tr_b16 a[6:7], v204 offset:4096
  ds_read_b64_tr_b16 a[8:9], v205 offset:0
  ds_read_b64_tr_b16 a[10:11], v205 offset:4096
  ds_read_b64_tr_b16 a[12:13], v206 offset:0
  ds_read_b64_tr_b16 a[14:15], v206 offset:4096
  ds_read_b64_tr_b16 a[16:17], v203 offset:1024
  ds_read_b64_tr_b16 a[18:19], v203 offset:5120
  ds_read_b64_tr_b16 a[20:21], v204 offset:1024
  ds_read_b64_tr_b16 a[22:23], v204 offset:5120
  ds_read_b64_tr_b16 a[24:25], v205 offset:1024
  ds_read_b64_tr_b16 a[26:27], v205 offset:5120
  ds_read_b64_tr_b16 a[28:29], v206 offset:1024
  ds_read_b64_tr_b16 a[30:31], v206 offset:5120
  s_waitcnt lgkmcnt(0)
  v_mfma_f32_16x16x32_bf16 v[0:3], a[0:3], v[144:147], v[0:3]
  v_mfma_f32_16x16x32_bf16 v[32:35], a[0:3], v[152:155], v[32:35]
  v_mfma_f32_16x16x32_bf16 v[4:7], a[4:7], v[144:147], v[4:7]
  v_mfma_f32_16x16x32_bf16 v[36:39], a[4:7], v[152:155], v[36:39]
  v_mfma_f32_16x16x32_bf16 v[8:11], a[8:11], v[144:147], v[8:11]
  v_mfma_f32_16x16x32_bf16 v[40:43], a[8:11], v[152:155], v[40:43]
  v_mfma_f32_16x16x32_bf16 v[12:15], a[12:15], v[144:147], v[12:15]
  v_mfma_f32_16x16x32_bf16 v[44:47], a[12:15], v[152:155], v[44:47]
  v_mfma_f32_16x16x32_bf16 v[16:19], a[16:19], v[144:147], v[16:19]
  v_mfma_f32_16x16x32_bf16 v[48:51], a[16:19], v[152:155], v[48:51]
  v_mfma_f32_16x16x32_bf16 v[20:23], a[20:23], v[144:147], v[20:23]
  v_mfma_f32_16x16x32_bf16 v[52:55], a[20:23], v[152:155], v[52:55]
  v_mfma_f32_16x16x32_bf16 v[24:27], a[24:27], v[144:147], v[24:27]
  v_mfma_f32_16x16x32_bf16 v[56:59], a[24:27], v[152:155], v[56:59]
  v_mfma_f32_16x16x32_bf16 v[28:31], a[28:31], v[144:147], v[28:31]
  v_mfma_f32_16x16x32_bf16 v[60:63], a[28:31], v[152:155], v[60:63]
  s_nop 7
  s_nop 7
  s_barrier
  s_add_u32 s60, s60, 8192
  s_add_u32 s61, s61, 1
  s_cmp_lt_u32 s61, 16
  s_cbranch_scc1 K1T2_slow_p1
  v_mov_b32 v215, v192
  v_mov_b32 v216, v192
  s_nop 1
  v_permlane16_swap_b32 v215, v216
  v_add_f32 v192, v215, v216
  v_mov_b32 v215, v192
  v_mov_b32 v216, v192
  s_nop 1
  v_permlane32_swap_b32 v215, v216
  v_add_f32 v192, v215, v216
  v_mov_b32 v215, v193
  v_mov_b32 v216, v193
  s_nop 1
  v_permlane16_swap_b32 v215, v216
  v_add_f32 v193, v215, v216
  v_mov_b32 v215, v193
  v_mov_b32 v216, v193
  s_nop 1
  v_permlane32_swap_b32 v215, v216
  v_add_f32 v193, v215, v216
K1T2_noslow:
  s_cmp_eq_u32 s41, 0
  s_cbranch_scc0 K1T2_j1
  s_xor_b32 s72, s57, s70
  s_add_u32 m0, s59, s44
  s_nop 0
  buffer_load_dwordx4 v207, s[28:31], s72 offen nt lds
  s_add_u32 m0, m0, 896
  s_nop 0
  buffer_load_dwordx4 v207, s[28:31], s72 offen offset:128 nt lds
  s_add_u32 s57, s57, 8192
  s_add_u32 s59, s59, 8192
  s_cmp_eq_u32 s59, 49152
  s_cselect_b32 s59, 0, s59
  s_barrier
  s_xor_b32 s72, s57, s70
  s_add_u32 m0, s59, s44
  s_nop 0
  buffer_load_dwordx4 v207, s[28:31], s72 offen nt lds
  s_add_u32 m0, m0, 896
  s_nop 0
  buffer_load_dwordx4 v207, s[28:31], s72 offen offset:128 nt lds
  s_add_u32 s57, s57, 8192
  s_add_u32 s59, s59, 8192
  s_cmp_eq_u32 s59, 49152
  s_cselect_b32 s59, 0, s59
  s_xor_b32 s72, s56, s70
  s_add_u32 m0, s58, s43
  s_nop 0
  buffer_load_dwordx4 v207, s[24:27], s72 offen nt lds
  s_add_u32 m0, m0, 896
  s_nop 0
  buffer_load_dwordx4 v207, s[24:27], s72 offen offset:128 nt lds
  s_add_u32 s56, s56, 8192
  s_add_u32 s58, s58, 8192
  s_and_b32 s58, s58, 32767
  v_rcp_f32 v216, v192
  s_nop 0
  v_mul_f32 v0, v0, v216
  v_mul_f32 v1, v1, v216
  v_mul_f32 v2, v2, v216
  v_mul_f32 v3, v3, v216
  v_mul_f32 v4, v4, v216
  v_mul_f32 v5, v5, v216
  v_mul_f32 v6, v6, v216
  v_mul_f32 v7, v7, v216
  v_cvt_pk_bf16_f32 v96, v0, v1
  v_cvt_pk_bf16_f32 v97, v2, v3
  v_cvt_pk_bf16_f32 v98, v4, v5
  v_cvt_pk_bf16_f32 v99, v6, v7
  s_barrier
  s_xor_b32 s72, s57, s70
  s_add_u32 m0, s59, s44
  s_nop 0
  buffer_load_dwordx4 v207, s[28:31], s72 offen nt lds
  s_add_u32 m0, m0, 896
  s_nop 0
  buffer_load_dwordx4 v207, s[28:31], s72 offen offset:128 nt lds
  s_add_u32 s57, s57, 8192
  s_add_u32 s59, s59, 8192
  s_cmp_eq_u32 s59, 49152
  s_cselect_b32 s59, 0, s59
  s_xor_b32 s72, s56, s70
  s_add_u32 m0, s58, s43
  s_nop 0
  buffer_load_dwordx4 v207, s[24:27], s72 offen nt lds
  s_add_u32 m0, m0, 896
  s_nop 0
  buffer_load_dwordx4 v207, s[24:27], s72 offen offset:128 nt lds
  s_add_u32 s56, s56, 8192
  s_add_u32 s58, s58, 8192
  s_and_b32 s58, s58, 32767
  v_mul_f32 v8, v8, v216
  v_mul_f32 v9, v9, v216
  v_mul_f32 v10, v10, v216
  v_mul_f32 v11, v11, v216
  v_mul_f32 v12, v12, v216
  v_mul_f32 v13, v13, v216
  v_mul_f32 v14, v14, v216
  v_mul_f32 v15, v15, v216
  v_cvt_pk_bf16_f32 v100, v8, v9
  v_cvt_pk_bf16_f32 v101, v10, v11
  v_cvt_pk_bf16_f32 v102, v12, v13
  v_cvt_pk_bf16_f32 v103, v14, v15
  s_barrier
  s_xor_b32 s72, s57, s70
  s_add_u32 m0, s59, s44
  s_nop 0
  buffer_load_dwordx4 v207, s[28:31], s72 offen nt lds
  s_add_u32 m0, m0, 896
  s_nop 0
  buffer_load_dwordx4 v207, s[28:31], s72 offen offset:128 nt lds
  s_add_u32 s57, s57, 8192
  s_add_u32 s59, s59, 8192
  s_cmp_eq_u32 s59, 49152
  s_cselect_b32 s59, 0, s59
  s_xor_b32 s72, s56, s70
  s_add_u32 m0, s58, s43
  s_nop 0
  buffer_load_dwordx4 v207, s[24:27], s72 offen nt lds
  s_add_u32 m0, m0, 896
  s_nop 0
  buffer_load_dwordx4 v207, s[24:27], s72 offen offset:128 nt lds
  s_add_u32 s56, s56, 8192
  s_add_u32 s58, s58, 8192
  s_and_b32 s58, s58, 32767
  v_mul_f32 v16, v16, v216
  v_mul_f32 v17, v17, v216
  v_mul_f32 v18, v18, v216
  v_mul_f32 v19, v19, v216
  v_mul_f32 v20, v20, v216
  v_mul_f32 v21, v21, v216
  v_mul_f32 v22, v22, v216
  v_mul_f32 v23, v23, v216
  v_cvt_pk_bf16_f32 v104, v16, v17
  v_cvt_pk_bf16_f32 v105, v18, v19
  v_cvt_pk_bf16_f32 v106, v20, v21
  v_cvt_pk_bf16_f32 v107, v22, v23
  s_waitcnt vmcnt(8)
  s_barrier
  s_xor_b32 s72, s57, s70
  s_add_u32 m0, s59, s44
  s_nop 0
  buffer_load_dwordx4 v207, s[28:31], s72 offen nt lds
  s_add_u32 m0, m0, 896
  s_nop 0
  buffer_load_dwordx4 v207, s[28:31], s72 offen offset:128 nt lds
  s_add_u32 s57, s57, 8192
  s_add_u32 s59, s59, 8192
  s_cmp_eq_u32 s59, 49152
  s_cselect_b32 s59, 0, s59
  s_xor_b32 s72, s56, s70
  s_add_u32 m0, s58, s43
  s_nop 0
  buffer_load_dwordx4 v207, s[24:27], s72 offen nt lds
  s_add_u32 m0, m0, 896
  s_nop 0
  buffer_load_dwordx4 v207, s[24:27], s72 offen offset:128 nt lds
  s_add_u32 s56, s56, 8192
  s_add_u32 s58, s58, 8192
  s_and_b32 s58, s58, 32767
  v_mul_f32 v24, v24, v216
  v_mul_f32 v25, v25, v216
  v_mul_f32 v26, v26, v216
  v_mul_f32 v27, v27, v216
  v_mul_f32 v28, v28, v216
  v_mul_f32 v29, v29, v216
  v_mul_f32 v30, v30, v216
  v_mul_f32 v31, v31, v216
  v_cvt_pk_bf16_f32 v108, v24, v25
  v_cvt_pk_bf16_f32 v109, v26, v27
  v_cvt_pk_bf16_f32 v110, v28, v29
  v_cvt_pk_bf16_f32 v111, v30, v31
  s_waitcnt vmcnt(8)
  s_barrier
  s_xor_b32 s72, s57, s70
  s_add_u32 m0, s59, s44
  s_nop 0
  buffer_load_dwordx4 v207, s[28:31], s72 offen nt lds
  s_add_u32 m0, m0, 896
  s_nop 0
  buffer_load_dwordx4 v207, s[28:31], s72 offen offset:128 nt lds
  s_add_u32 s57, s57, 8192
  s_add_u32 s59, s59, 8192
  s_cmp_eq_u32 s59, 49152
  s_cselect_b32 s59, 0, s59
  s_xor_b32 s72, s56, s70
  s_add_u32 m0, s58, s43
  s_nop 0
  buffer_load_dwordx4 v207, s[24:27], s72 offen nt lds
  s_add_u32 m0, m0, 896
  s_nop 0
  buffer_load_dwordx4 v207, s[24:27], s72 offen offset:128 nt lds
  s_add_u32 s56, s56, 8192
  s_add_u32 s58, s58, 8192
  s_and_b32 s58, s58, 32767
  v_rcp_f32 v216, v193
  s_nop 0
  v_mul_f32 v32, v32, v216
  v_mul_f32 v33, v33, v216
  v_mul_f32 v34, v34, v216
  v_mul_f32 v35, v35, v216
  v_mul_f32 v36, v36, v216
  v_mul_f32 v37, v37, v216
  v_mul_f32 v38, v38, v216
  v_mul_f32 v39, v39, v216
  v_cvt_pk_bf16_f32 v112, v32, v33
  v_cvt_pk_bf16_f32 v113, v34, v35
  v_cvt_pk_bf16_f32 v114, v36, v37
  v_cvt_pk_bf16_f32 v115, v38, v39
  s_waitcnt vmcnt(8)
  s_barrier
  s_xor_b32 s72, s57, s70
  s_add_u32 m0, s59, s44
  s_nop 0
  buffer_load_dwordx4 v207, s[28:31], s72 offen nt lds
  s_add_u32 m0, m0, 896
  s_nop 0
  buffer_load_dwordx4 v207, s[28:31], s72 offen offset:128 nt lds
  s_add_u32 s57, s57, 8192
  s_add_u32 s59, s59, 8192
  s_cmp_eq_u32 s59, 49152
  s_cselect_b32 s59, 0, s59
  s_xor_b32 s72, s56, s70
  s_add_u32 m0, s58, s43
  s_nop 0
  buffer_load_dwordx4 v207, s[24:27], s72 offen nt lds
  s_add_u32 m0, m0, 896
  s_nop 0
  buffer_load_dwordx4 v207, s[24:27], s72 offen offset:128 nt lds
  s_add_u32 s56, s56, 8192
  s_add_u32 s58, s58, 8192
  s_and_b32 s58, s58, 32767
  v_mul_f32 v40, v40, v216
  v_mul_f32 v41, v41, v216
  v_mul_f32 v42, v42, v216
  v_mul_f32 v43, v43, v216
  v_mul_f32 v44, v44, v216
  v_mul_f32 v45, v45, v216
  v_mul_f32 v46, v46, v216
  v_mul_f32 v47, v47, v216
  v_cvt_pk_bf16_f32 v116, v40, v41
  v_cvt_pk_bf16_f32 v117, v42, v43
  v_cvt_pk_bf16_f32 v118, v44, v45
  v_cvt_pk_bf16_f32 v119, v46, v47
  s_waitcnt vmcnt(8)
  s_barrier
  s_xor_b32 s72, s57, s70
  s_add_u32 m0, s59, s44
  s_nop 0
  buffer_load_dwordx4 v207, s[28:31], s72 offen nt lds
  s_add_u32 m0, m0, 896
  s_nop 0
  buffer_load_dwordx4 v207, s[28:31], s72 offen offset:128 nt lds
  s_add_u32 s57, s57, 8192
  s_add_u32 s59, s59, 8192
  s_cmp_eq_u32 s59, 49152
  s_cselect_b32 s59, 0, s59
  s_xor_b32 s72, s56, s70
  s_add_u32 m0, s58, s43
  s_nop 0
  buffer_load_dwordx4 v207, s[24:27], s72 offen nt lds
  s_add_u32 m0, m0, 896
  s_nop 0
  buffer_load_dwordx4 v207, s[24:27], s72 offen offset:128 nt lds
  s_add_u32 s56, s56, 8192
  s_add_u32 s58, s58, 8192
  s_and_b32 s58, s58, 32767
  v_mul_f32 v48, v48, v216
  v_mul_f32 v49, v49, v216
  v_mul_f32 v50, v50, v216
  v_mul_f32 v51, v51, v216
  v_mul_f32 v52, v52, v216
  v_mul_f32 v53, v53, v216
  v_mul_f32 v54, v54, v216
  v_mul_f32 v55, v55, v216
  v_cvt_pk_bf16_f32 v120, v48, v49
  v_cvt_pk_bf16_f32 v121, v50, v51
  v_cvt_pk_bf16_f32 v122, v52, v53
  v_cvt_pk_bf16_f32 v123, v54, v55
  s_waitcnt vmcnt(8)
  s_barrier
  s_xor_b32 s72, s57, s70
  s_add_u32 m0, s59, s44
  s_nop 0
  buffer_load_dwordx4 v207, s[28:31], s72 offen nt lds
  s_add_u32 m0, m0, 896
  s_nop 0
  buffer_load_dwordx4 v207, s[28:31], s72 offen offset:128 nt lds
  s_add_u32 s57, s57, 8192
  s_add_u32 s59, s59, 8192
  s_cmp_eq_u32 s59, 49152
  s_cselect_b32 s59, 0, s59
  s_xor_b32 s72, s56, s70
  s_add_u32 m0, s58, s43
  s_nop 0
  buffer_load_dwordx4 v207, s[24:27], s72 offen nt lds
  s_add_u32 m0, m0, 896
  s_nop 0
  buffer_load_dwordx4 v207, s[24:27], s72 offen offset:128 nt lds
  s_add_u32 s56, s56, 8192
  s_add_u32 s58, s58, 8192
  s_and_b32 s58, s58, 32767
  v_mul_f32 v56, v56, v216
  v_mul_f32 v57, v57, v216
  v_mul_f32 v58, v58, v216
  v_mul_f32 v59, v59, v216
  v_mul_f32 v60, v60, v216
  v_mul_f32 v61, v61, v216
  v_mul_f32 v62, v62, v216
  v_mul_f32 v63, v63, v216
  v_cvt_pk_bf16_f32 v124, v56, v57
  v_cvt_pk_bf16_f32 v125, v58, v59
  v_cvt_pk_bf16_f32 v126, v60, v61
  v_cvt_pk_bf16_f32 v127, v62, v63
  s_waitcnt vmcnt(8)
  s_barrier
  s_xor_b32 s72, s57, s70
  s_add_u32 m0, s59, s44
  s_nop 0
  buffer_load_dwordx4 v207, s[28:31], s72 offen nt lds
  s_add_u32 m0, m0, 896
  s_nop 0
  buffer_load_dwordx4 v207, s[28:31], s72 offen offset:128 nt lds
  s_add_u32 s57, s57, 8192
  s_add_u32 s59, s59, 8192
  s_cmp_eq_u32 s59, 49152
  s_cselect_b32 s59, 0, s59
  s_xor_b32 s72, s56, s70
  s_add_u32 m0, s58, s43
  s_nop 0
  buffer_load_dwordx4 v207, s[24:27], s72 offen nt lds
  s_add_u32 m0, m0, 896
  s_nop 0
  buffer_load_dwordx4 v207, s[24:27], s72 offen offset:128 nt lds
  s_add_u32 s56, s56, 8192
  s_add_u32 s58, s58, 8192
  s_and_b32 s58, s58, 32767
  s_waitcnt vmcnt(8)
  s_barrier
  s_xor_b32 s72, s57, s70
  s_add_u32 m0, s59, s44
  s_nop 0
  buffer_load_dwordx4 v207, s[28:31], s72 offen nt lds
  s_add_u32 m0, m0, 896
  s_nop 0
  buffer_load_dwordx4 v207, s[28:31], s72 offen offset:128 nt lds
  s_add_u32 s57, s57, 8192
  s_add_u32 s59, s59, 8192
  s_cmp_eq_u32 s59, 49152
  s_cselect_b32 s59, 0, s59
  s_xor_b32 s72, s56, s70
  s_add_u32 m0, s58, s43
  s_nop 0
  buffer_load_dwordx4 v207, s[24:27], s72 offen nt lds
  s_add_u32 m0, m0, 896
  s_nop 0
  buffer_load_dwordx4 v207, s[24:27], s72 offen offset:128 nt lds
  s_add_u32 s56, s56, 8192
  s_add_u32 s58, s58, 8192
  s_and_b32 s58, s58, 32767
  s_waitcnt vmcnt(8)
  s_barrier
  s_xor_b32 s72, s57, s70
  s_add_u32 m0, s59, s44
  s_nop 0
  buffer_load_dwordx4 v207, s[28:31], s72 offen nt lds
  s_add_u32 m0, m0, 896
  s_nop 0
  buffer_load_dwordx4 v207, s[28:31], s72 offen offset:128 nt lds
  s_add_u32 s57, s57, 8192
  s_add_u32 s59, s59, 8192
  s_cmp_eq_u32 s59, 49152
  s_cselect_b32 s59, 0, s59
  s_xor_b32 s72, s56, s70
  s_add_u32 m0, s58, s43
  s_nop 0
  buffer_load_dwordx4 v207, s[24:27], s72 offen nt lds
  s_add_u32 m0, m0, 896
  s_nop 0
  buffer_load_dwordx4 v207, s[24:27], s72 offen offset:128 nt lds
  s_add_u32 s56, s56, 8192
  s_add_u32 s58, s58, 8192
  s_and_b32 s58, s58, 32767
  s_waitcnt vmcnt(8)
  s_barrier
  s_xor_b32 s72, s57, s70
  s_add_u32 m0, s59, s44
  s_nop 0
  buffer_load_dwordx4 v207, s[28:31], s72 offen nt lds
  s_add_u32 m0, m0, 896
  s_nop 0
  buffer_load_dwordx4 v207, s[28:31], s72 offen offset:128 nt lds
  s_add_u32 s57, s57, 8192
  s_add_u32 s59, s59, 8192
  s_cmp_eq_u32 s59, 49152
  s_cselect_b32 s59, 0, s59
  s_xor_b32 s72, s56, s70
  s_add_u32 m0, s58, s43
  s_nop 0
  buffer_load_dwordx4 v207, s[24:27], s72 offen nt lds
  s_add_u32 m0, m0, 896
  s_nop 0
  buffer_load_dwordx4 v207, s[24:27], s72 offen offset:128 nt lds
  s_add_u32 s56, s56, 8192
  s_add_u32 s58, s58, 8192
  s_and_b32 s58, s58, 32767
  v_lshrrev_b32 v220, 4, v214
  s_lshr_b32 s67, s74, 2
  s_lshr_b32 s63, s2, 3
  s_lshl_b32 s63, s63, 15
  s_lshl_b32 s66, s42, 13
  s_add_u32 s63, s63, s66
  s_lshl_b32 s66, s67, 20
  s_add_u32 s63, s63, s66
  v_lshrrev_b32 v221, 3, v220
  v_and_b32 v220, 7, v220
  v_lshlrev_b32 v220, 7, v220
  v_lshl_add_u32 v221, v221, 10, v220
  v_add_u32 v221, s63, v221
  global_load_dword v222, v221, s[12:13]
  s_waitcnt vmcnt(9)
  s_barrier
  s_lshl_b32 s63, s42, 11
  v_add_u32 v218, s63, v214
  v_add_u32 v219, 124928, v218
  v_add_u32 v218, 90112, v218
  v_lshrrev_b32 v144, 4, v214
  v_mov_b32 v146, v214
  s_lshr_b32 s45, s74, 2
  s_and_b32 s46, s74, 3
  v_lshrrev_b32 v154, 3, v144
  v_and_b32 v155, 7, v144
  v_and_b32 v156, 6, v154
  v_xor_b32 v155, v155, v156
  v_lshlrev_b32 v155, 4, v155
  v_lshl_add_u32 v145, v154, 10, v155
  v_bfe_u32 v154, v144, 2, 3
  v_bfe_u32 v155, v144, 1, 1
  v_and_b32 v156, 6, v154
  v_xor_b32 v155, v155, v156
  v_lshlrev_b32 v155, 4, v155
  v_lshl_add_u32 v155, v154, 7, v155
  v_and_b32 v156, 1, v144
  v_lshl_add_u32 v155, v156, 3, v155
  v_lshrrev_b32 v156, 5, v144
  v_lshl_add_u32 v155, v156, 11, v155
  s_and_b32 s63, s42, 1
  s_lshl_b32 s63, s63, 6
  v_xor_b32 v148, s63, v155
  v_xor_b32 v149, 32, v148
  s_lshr_b32 s63, s42, 1
  s_lshl_b32 s63, s63, 10
  v_add_u32 v148, s63, v148
  v_add_u32 v149, s63, v149
  s_mul_i32 s63, s41, 5120
  s_add_u32 s63, s63, 8192
  v_add_u32 v152, s63, v146
  s_mul_i32 s63, s41, 17408
  s_lshl_b32 s66, s42, 11
  s_add_u32 s47, s63, s66
  s_lshl_b32 s63, s41, 15
  s_lshl_b32 s66, s42, 13
  s_add_u32 s51, s63, s66
  s_lshl_b32 s63, s40, 10
  s_add_u32 s3, s63, 8192
  s_add_u32 s100, s3, 17408
  s_lshl_b32 s52, s40, 12
  s_add_u32 s53, s52, 1024
  s_mul_i32 s63, s41, 17408
  s_add_u32 s101, s63, 16384
  s_lshl_b32 s63, s41, 10
  s_add_u32 s54, s63, 32768
  s_lshl_b32 s63, s73, 5
  s_lshl_b32 s66, s45, 3
  s_add_u32 s63, s63, s66
  s_mul_i32 s63, s63, 36864
  s_add_u32 s63, s63, 1048576
  s_add_u32 s20, s18, s63
  s_addc_u32 s21, s19, 0
  s_mov_b32 s22, 294912
  s_mov_b32 s23, 0x20000
  s_lshl_b32 s63, s45, 20
  s_lshl_b32 s66, s46, 8
  s_add_u32 s63, s63, s66
  s_add_u32 s24, s12, s63
  s_addc_u32 s25, s13, 0
  s_sub_u32 s26, 4194304, s63
  s_mov_b32 s27, 0x20000
  s_mul_i32 s66, s73, 147456
  s_lshl_b32 s63, s46, 8
  s_add_u32 s66, s66, s63
  s_add_u32 s28, s14, s66
  s_addc_u32 s29, s15, 0
  s_sub_u32 s30, 147456, s63
  s_mov_b32 s31, 0x20000
  s_lshl_b32 s63, s73, 2
  s_add_u32 s63, s63, s46
  s_mul_i32 s63, s63, 393216
  s_add_u32 s63, s63, 33554432
  s_add_u32 s32, s18, s63
  s_addc_u32 s33, s19, 0
  s_mov_b32 s34, 393216
  s_mov_b32 s35, 0x20000
  s_add_u32 s68, s18, 524288
  s_addc_u32 s69, s19, 0
  s_lshl_b32 s61, s73, 4
  s_add_u32 s61, s61, s74
  s_mov_b32 s58, 81920
  ds_write_b128 v218, v[96:99] offset:0
  buffer_store_dwordx4 v[96:99], v214, s[36:39], s48 offen offset:0 sc1
  ds_write_b128 v218, v[100:103] offset:17408
  buffer_store_dwordx4 v[100:103], v214, s[36:39], s48 offen offset:1024 sc1
  ds_write_b128 v219, v[104:107] offset:0
  buffer_store_dwordx4 v[104:107], v214, s[36:39], s48 offen offset:2048 sc1
  ds_write_b128 v219, v[108:111] offset:17408
  buffer_store_dwordx4 v[108:111], v214, s[36:39], s48 offen offset:3072 sc1
  s_waitcnt vmcnt(9)
  s_barrier
  ds_write_b128 v218, v[112:115] offset:1024
  buffer_store_dwordx4 v[112:115], v214, s[36:39], s49 offen offset:0 sc1
  ds_write_b128 v218, v[116:119] offset:18432
  buffer_store_dwordx4 v[116:119], v214, s[36:39], s49 offen offset:1024 sc1
  ds_write_b128 v219, v[120:123] offset:1024
  buffer_store_dwordx4 v[120:123], v214, s[36:39], s49 offen offset:2048 sc1
  ds_write_b128 v219, v[124:127] offset:18432
  buffer_store_dwordx4 v[124:127], v214, s[36:39], s49 offen offset:3072 sc1
  s_lshl_b32 s67, s46, 18
  s_add_u32 s67, s67, 0
  s_lshl_b32 s63, s42, 11
  s_add_u32 m0, s63, 81920
  s_lshl_b32 s66, s42, 13
  s_add_u32 s66, s66, s67
  s_add_u32 s66, s66, 0
  buffer_load_dwordx4 v145, s[24:27], s66 offen  lds
  s_add_u32 m0, m0, 896
  s_nop 0
  buffer_load_dwordx4 v145, s[24:27], s66 offen offset:128  lds
  s_lshl_b32 s63, s42, 11
  s_add_u32 m0, s63, 99328
  s_lshl_b32 s66, s42, 13
  s_add_u32 s66, s66, s67
  s_add_u32 s66, s66, 32768
  buffer_load_dwordx4 v145, s[24:27], s66 offen  lds
  s_add_u32 m0, m0, 896
  s_nop 0
  buffer_load_dwordx4 v145, s[24:27], s66 offen offset:128  lds
  s_waitcnt vmcnt(13)
  s_barrier
  s_lshl_b32 s67, s46, 18
  s_add_u32 s67, s67, 65536
  s_lshl_b32 s63, s42, 11
  s_add_u32 m0, s63, 116736
  s_lshl_b32 s66, s42, 13
  s_add_u32 s66, s66, s67
  s_add_u32 s66, s66, 0
  buffer_load_dwordx4 v145, s[24:27], s66 offen  lds
  s_add_u32 m0, m0, 896
  s_nop 0
  buffer_load_dwordx4 v145, s[24:27], s66 offen offset:128  lds
  s_lshl_b32 s63, s42, 11
  s_add_u32 m0, s63, 134144
  s_lshl_b32 s66, s42, 13
  s_add_u32 s66, s66, s67
  s_add_u32 s66, s66, 32768
  buffer_load_dwordx4 v145, s[24:27], s66 offen  lds
  s_add_u32 m0, m0, 896
  s_nop 0
  buffer_load_dwordx4 v145, s[24:27], s66 offen offset:128  lds
  s_barrier
  s_barrier
  s_waitcnt vmcnt(8) lgkmcnt(0)
  s_barrier
  v_mov_b32 v215, 151556
  ds_read_b32 v216, v215
  s_waitcnt lgkmcnt(0)
  v_readfirstlane_b32 s63, v216
  s_cmp_eq_u32 s63, 0
  s_cbranch_scc1 FT2_hB_ok
  s_mov_b32 s63, 0
FT2_hB_loop:
  s_barrier
  s_add_u32 s63, s63, 1
  s_cmp_lt_u32 s63, 64
  s_cbranch_scc1 FT2_hB_loop
FT2_hB_ok:
  s_lshl_b32 s67, s46, 18
  s_add_u32 s67, s67, 131072
  s_lshl_b32 s63, s42, 11
  s_add_u32 m0, s63, 12288
  s_lshl_b32 s66, s42, 13
  s_add_u32 s66, s66, s67
  s_add_u32 s66, s66, 0
  buffer_load_dwordx4 v145, s[24:27], s66 offen  lds
  s_add_u32 m0, m0, 896
  s_nop 0
  buffer_load_dwordx4 v145, s[24:27], s66 offen offset:128  lds
  s_lshl_b32 s63, s42, 11
  s_add_u32 m0, s63, 29696
  s_lshl_b32 s66, s42, 13
  s_add_u32 s66, s66, s67
  s_add_u32 s66, s66, 32768
  buffer_load_dwordx4 v145, s[24:27], s66 offen  lds
  s_add_u32 m0, m0, 896
  s_nop 0
  buffer_load_dwordx4 v145, s[24:27], s66 offen offset:128  lds
  s_branch F_q0
K1T2_j1:
  s_lshl_b32 s63, s42, 11
  v_add_u32 v218, s63, v214
  v_add_u32 v219, 55296, v218
  v_add_u32 v218, 20480, v218
  v_rcp_f32 v216, v192
  s_nop 0
  v_pk_mul_f32 v[0:1], v[0:1], v[216:217] op_sel_hi:[1,0]
  v_pk_mul_f32 v[2:3], v[2:3], v[216:217] op_sel_hi:[1,0]
  v_pk_mul_f32 v[4:5], v[4:5], v[216:217] op_sel_hi:[1,0]
  v_pk_mul_f32 v[6:7], v[6:7], v[216:217] op_sel_hi:[1,0]
  v_cvt_pk_bf16_f32 v96, v0, v1
  v_cvt_pk_bf16_f32 v97, v2, v3
  v_cvt_pk_bf16_f32 v98, v4, v5
  v_cvt_pk_bf16_f32 v99, v6, v7
  ds_write_b128 v218, v[96:99] offset:0
  buffer_store_dwordx4 v[96:99], v214, s[36:39], s48 offen offset:0 sc1
  v_pk_mul_f32 v[8:9], v[8:9], v[216:217] op_sel_hi:[1,0]
  v_pk_mul_f32 v[10:11], v[10:11], v[216:217] op_sel_hi:[1,0]
  v_pk_mul_f32 v[12:13], v[12:13], v[216:217] op_sel_hi:[1,0]
  v_pk_mul_f32 v[14:15], v[14:15], v[216:217] op_sel_hi:[1,0]
  v_cvt_pk_bf16_f32 v100, v8, v9
  v_cvt_pk_bf16_f32 v101, v10, v11
  v_cvt_pk_bf16_f32 v102, v12, v13
  v_cvt_pk_bf16_f32 v103, v14, v15
  ds_write_b128 v218, v[100:103] offset:17408
  buffer_store_dwordx4 v[100:103], v214, s[36:39], s48 offen offset:1024 sc1
  v_pk_mul_f32 v[16:17], v[16:17], v[216:217] op_sel_hi:[1,0]
  v_pk_mul_f32 v[18:19], v[18:19], v[216:217] op_sel_hi:[1,0]
  v_pk_mul_f32 v[20:21], v[20:21], v[216:217] op_sel_hi:[1,0]
  v_pk_mul_f32 v[22:23], v[22:23], v[216:217] op_sel_hi:[1,0]
  v_cvt_pk_bf16_f32 v104, v16, v17
  v_cvt_pk_bf16_f32 v105, v18, v19
  v_cvt_pk_bf16_f32 v106, v20, v21
  v_cvt_pk_bf16_f32 v107, v22, v23
  ds_write_b128 v219, v[104:107] offset:0
  buffer_store_dwordx4 v[104:107], v214, s[36:39], s48 offen offset:2048 sc1
  v_pk_mul_f32 v[24:25], v[24:25], v[216:217] op_sel_hi:[1,0]
  v_pk_mul_f32 v[26:27], v[26:27], v[216:217] op_sel_hi:[1,0]
  v_pk_mul_f32 v[28:29], v[28:29], v[216:217] op_sel_hi:[1,0]
  v_pk_mul_f32 v[30:31], v[30:31], v[216:217] op_sel_hi:[1,0]
  v_cvt_pk_bf16_f32 v108, v24, v25
  v_cvt_pk_bf16_f32 v109, v26, v27
  v_cvt_pk_bf16_f32 v110, v28, v29
  v_cvt_pk_bf16_f32 v111, v30, v31
  ds_write_b128 v219, v[108:111] offset:17408
  buffer_store_dwordx4 v[108:111], v214, s[36:39], s48 offen offset:3072 sc1
  v_rcp_f32 v216, v193
  s_nop 0
  v_pk_mul_f32 v[32:33], v[32:33], v[216:217] op_sel_hi:[1,0]
  v_pk_mul_f32 v[34:35], v[34:35], v[216:217] op_sel_hi:[1,0]
  v_pk_mul_f32 v[36:37], v[36:37], v[216:217] op_sel_hi:[1,0]
  v_pk_mul_f32 v[38:39], v[38:39], v[216:217] op_sel_hi:[1,0]
  v_cvt_pk_bf16_f32 v112, v32, v33
  v_cvt_pk_bf16_f32 v113, v34, v35
  v_cvt_pk_bf16_f32 v114, v36, v37
  v_cvt_pk_bf16_f32 v115, v38, v39
  ds_write_b128 v218, v[112:115] offset:1024
  buffer_store_dwordx4 v[112:115], v214, s[36:39], s49 offen offset:0 sc1
  v_pk_mul_f32 v[40:41], v[40:41], v[216:217] op_sel_hi:[1,0]
  v_pk_mul_f32 v[42:43], v[42:43], v[216:217] op_sel_hi:[1,0]
  v_pk_mul_f32 v[44:45], v[44:45], v[216:217] op_sel_hi:[1,0]
  v_pk_mul_f32 v[46:47], v[46:47], v[216:217] op_sel_hi:[1,0]
  v_cvt_pk_bf16_f32 v116, v40, v41
  v_cvt_pk_bf16_f32 v117, v42, v43
  v_cvt_pk_bf16_f32 v118, v44, v45
  v_cvt_pk_bf16_f32 v119, v46, v47
  ds_write_b128 v218, v[116:119] offset:18432
  buffer_store_dwordx4 v[116:119], v214, s[36:39], s49 offen offset:1024 sc1
  v_pk_mul_f32 v[48:49], v[48:49], v[216:217] op_sel_hi:[1,0]
  v_pk_mul_f32 v[50:51], v[50:51], v[216:217] op_sel_hi:[1,0]
  v_pk_mul_f32 v[52:53], v[52:53], v[216:217] op_sel_hi:[1,0]
  v_pk_mul_f32 v[54:55], v[54:55], v[216:217] op_sel_hi:[1,0]
  v_cvt_pk_bf16_f32 v120, v48, v49
  v_cvt_pk_bf16_f32 v121, v50, v51
  v_cvt_pk_bf16_f32 v122, v52, v53
  v_cvt_pk_bf16_f32 v123, v54, v55
  ds_write_b128 v219, v[120:123] offset:1024
  buffer_store_dwordx4 v[120:123], v214, s[36:39], s49 offen offset:2048 sc1
  v_pk_mul_f32 v[56:57], v[56:57], v[216:217] op_sel_hi:[1,0]
  v_pk_mul_f32 v[58:59], v[58:59], v[216:217] op_sel_hi:[1,0]
  v_pk_mul_f32 v[60:61], v[60:61], v[216:217] op_sel_hi:[1,0]
  v_pk_mul_f32 v[62:63], v[62:63], v[216:217] op_sel_hi:[1,0]
  v_cvt_pk_bf16_f32 v124, v56, v57
  v_cvt_pk_bf16_f32 v125, v58, v59
  v_cvt_pk_bf16_f32 v126, v60, v61
  v_cvt_pk_bf16_f32 v127, v62, v63
  ds_write_b128 v219, v[124:127] offset:18432
  buffer_store_dwordx4 v[124:127], v214, s[36:39], s49 offen offset:3072 sc1
  v_lshrrev_b32 v144, 4, v214
  v_mov_b32 v146, v214
  s_lshr_b32 s45, s74, 2
  s_and_b32 s46, s74, 3
  v_lshrrev_b32 v154, 3, v144
  v_and_b32 v155, 7, v144
  v_and_b32 v156, 6, v154
  v_xor_b32 v155, v155, v156
  v_lshlrev_b32 v155, 4, v155
  v_lshl_add_u32 v145, v154, 10, v155
  v_bfe_u32 v154, v144, 2, 3
  v_bfe_u32 v155, v144, 1, 1
  v_and_b32 v156, 6, v154
  v_xor_b32 v155, v155, v156
  v_lshlrev_b32 v155, 4, v155
  v_lshl_add_u32 v155, v154, 7, v155
  v_and_b32 v156, 1, v144
  v_lshl_add_u32 v155, v156, 3, v155
  v_lshrrev_b32 v156, 5, v144
  v_lshl_add_u32 v155, v156, 11, v155
  s_and_b32 s63, s42, 1
  s_lshl_b32 s63, s63, 6
  v_xor_b32 v148, s63, v155
  v_xor_b32 v149, 32, v148
  s_lshr_b32 s63, s42, 1
  s_lshl_b32 s63, s63, 10
  v_add_u32 v148, s63, v148
  v_add_u32 v149, s63, v149
  s_mul_i32 s63, s41, 5120
  s_add_u32 s63, s63, 8192
  v_add_u32 v152, s63, v146
  s_mul_i32 s63, s41, 17408
  s_lshl_b32 s66, s42, 11
  s_add_u32 s47, s63, s66
  s_lshl_b32 s63, s41, 15
  s_lshl_b32 s66, s42, 13
  s_add_u32 s51, s63, s66
  s_lshl_b32 s63, s40, 10
  s_add_u32 s3, s63, 8192
  s_add_u32 s100, s3, 17408
  s_lshl_b32 s52, s40, 12
  s_add_u32 s53, s52, 1024
  s_mul_i32 s63, s41, 17408
  s_add_u32 s101, s63, 16384
  s_lshl_b32 s63, s41, 10
  s_add_u32 s54, s63, 32768
  s_lshl_b32 s63, s73, 5
  s_lshl_b32 s66, s45, 3
  s_add_u32 s63, s63, s66
  s_mul_i32 s63, s63, 36864
  s_add_u32 s63, s63, 1048576
  s_add_u32 s20, s18, s63
  s_addc_u32 s21, s19, 0
  s_mov_b32 s22, 294912
  s_mov_b32 s23, 0x20000
  s_lshl_b32 s63, s45, 20
  s_lshl_b32 s66, s46, 8
  s_add_u32 s63, s63, s66
  s_add_u32 s24, s12, s63
  s_addc_u32 s25, s13, 0
  s_sub_u32 s26, 4194304, s63
  s_mov_b32 s27, 0x20000
  s_mul_i32 s66, s73, 147456
  s_lshl_b32 s63, s46, 8
  s_add_u32 s66, s66, s63
  s_add_u32 s28, s14, s66
  s_addc_u32 s29, s15, 0
  s_sub_u32 s30, 147456, s63
  s_mov_b32 s31, 0x20000
  s_lshl_b32 s63, s73, 2
  s_add_u32 s63, s63, s46
  s_mul_i32 s63, s63, 393216
  s_add_u32 s63, s63, 33554432
  s_add_u32 s32, s18, s63
  s_addc_u32 s33, s19, 0
  s_mov_b32 s34, 393216
  s_mov_b32 s35, 0x20000
  s_add_u32 s68, s18, 524288
  s_addc_u32 s69, s19, 0
  s_lshl_b32 s61, s73, 4
  s_add_u32 s61, s61, s74
  s_mov_b32 s58, 81920
  s_branch F_q1
K1_T3:
  s_cmp_eq_u32 s41, 0
  s_cbranch_scc0 K1T3_g1
  s_lshl_b32 s63, s73, 4
  s_add_u32 s63, s63, s74
  s_lshl_b32 s63, s63, 7
  s_add_u32 s63, s63, 524288
  v_mov_b32 v217, s63
  v_mov_b64 v[218:219], 0
  v_mov_b64 v[220:221], 0
  s_mov_b64 exec, 1
  global_store_dwordx4 v217, v[218:221], s[18:19] sc1
  s_mov_b64 exec, -1
  v_mov_b32 v217, 151552
  v_mov_b64 v[218:219], 0
  ds_write_b64 v217, v[218:219]
  s_waitcnt lgkmcnt(0)
  s_add_u32 m0, s53, s51
  s_nop 0
  buffer_load_dwordx4 v208, s[32:35], s52 offen  lds
  s_add_u32 m0, m0, 896
  s_nop 0
  buffer_load_dwordx4 v208, s[32:35], s52 offen offset:128  lds
  s_add_u32 s52, s52, 262144
  s_and_b32 s52, s52, 4194303
  s_add_u32 s53, s53, 8192
  s_and_b32 s53, s53, 32767
  s_add_u32 m0, s53, s51
  s_nop 0
  buffer_load_dwordx4 v208, s[32:35], s52 offen  lds
  s_add_u32 m0, m0, 896
  s_nop 0
  buffer_load_dwordx4 v208, s[32:35], s52 offen offset:128  lds
  s_add_u32 s52, s52, 262144
  s_and_b32 s52, s52, 4194303
  s_add_u32 s53, s53, 8192
  s_and_b32 s53, s53, 32767
  s_add_u32 m0, s53, s51
  s_nop 0
  buffer_load_dwordx4 v208, s[32:35], s52 offen  lds
  s_add_u32 m0, m0, 896
  s_nop 0
  buffer_load_dwordx4 v208, s[32:35], s52 offen offset:128  lds
  s_add_u32 s52, s52, 262144
  s_and_b32 s52, s52, 4194303
  s_add_u32 s53, s53, 8192
  s_and_b32 s53, s53, 32767
  v_mov_b64 v[0:1], 0
  v_mov_b64 v[2:3], 0
  v_mov_b64 v[4:5], 0
  v_mov_b64 v[6:7], 0
  v_mov_b64 v[8:9], 0
  v_mov_b64 v[10:11], 0
  v_mov_b64 v[12:13], 0
  v_mov_b64 v[14:15], 0
  v_mov_b64 v[16:17], 0
  v_mov_b64 v[18:19], 0
  v_mov_b64 v[20:21], 0
  v_mov_b64 v[22:23], 0
  v_mov_b64 v[24:25], 0
  v_mov_b64 v[26:27], 0
  v_mov_b64 v[28:29], 0
  v_mov_b64 v[30:31], 0
  v_mov_b64 v[32:33], 0
  v_mov_b64 v[34:35], 0
  v_mov_b64 v[36:37], 0
  v_mov_b64 v[38:39], 0
  v_mov_b64 v[40:41], 0
  v_mov_b64 v[42:43], 0
  v_mov_b64 v[44:45], 0
  v_mov_b64 v[46:47], 0
  v_mov_b64 v[48:49], 0
  v_mov_b64 v[50:51], 0
  v_mov_b64 v[52:53], 0
  v_mov_b64 v[54:55], 0
  v_mov_b64 v[56:57], 0
  v_mov_b64 v[58:59], 0
  v_mov_b64 v[60:61], 0
  v_mov_b64 v[62:63], 0
  v_mov_b64 v[64:65], 0
  v_mov_b64 v[66:67], 0
  v_mov_b64 v[68:69], 0
  v_mov_b64 v[70:71], 0
  v_mov_b64 v[72:73], 0
  v_mov_b64 v[74:75], 0
  v_mov_b64 v[76:77], 0
  v_mov_b64 v[78:79], 0
  v_mov_b64 v[80:81], 0
  v_mov_b64 v[82:83], 0
  v_mov_b64 v[84:85], 0
  v_mov_b64 v[86:87], 0
  v_mov_b64 v[88:89], 0
  v_mov_b64 v[90:91], 0
  v_mov_b64 v[92:93], 0
  v_mov_b64 v[94:95], 0
  s_waitcnt vmcnt(4)
  s_barrier
  v_add_u32 v170, s77, v168
  v_add_u32 v171, s77, v169
  v_add_u32 v172, s78, v170
  v_add_u32 v173, s78, v171
  ds_read_b128 v[144:147], v170 offset:0
  ds_read_b128 v[148:151], v170 offset:2048
  ds_read_b128 v[152:155], v172 offset:0
  ds_read_b64_tr_b16 a[0:1], v211 offset:0
  ds_read_b64_tr_b16 a[2:3], v211 offset:512
  ds_read_b64_tr_b16 a[4:5], v211 offset:8
  ds_read_b64_tr_b16 a[6:7], v211 offset:520
  ds_read_b64_tr_b16 a[8:9], v212 offset:0
  ds_read_b64_tr_b16 a[10:11], v212 offset:512
  ds_read_b64_tr_b16 a[12:13], v212 offset:8
  ds_read_b64_tr_b16 a[14:15], v212 offset:520
  ds_read_b64_tr_b16 a[16:17], v211 offset:1024
  ds_read_b64_tr_b16 a[18:19], v211 offset:1536
  ds_read_b64_tr_b16 a[20:21], v211 offset:1032
  ds_read_b64_tr_b16 a[22:23], v211 offset:1544
  s_mov_b32 s62, 0
K1T3a_qloop:
  s_waitcnt vmcnt(2)
  s_barrier
  s_waitcnt lgkmcnt(6)
  v_mfma_f32_16x16x32_bf16 v[0:3], a[0:3], v[144:147], v[0:3]
  ds_read_b64_tr_b16 a[24:25], v212 offset:1024
  ds_read_b64_tr_b16 a[26:27], v212 offset:1536
  s_add_u32 m0, s53, s51
  s_nop 0
  buffer_load_dwordx4 v208, s[32:35], s52 offen  lds
  s_waitcnt lgkmcnt(7)
  v_mfma_f32_16x16x32_bf16 v[32:35], a[0:3], v[148:151], v[32:35]
  s_waitcnt lgkmcnt(6)
  v_mfma_f32_16x16x32_bf16 v[64:67], a[0:3], v[152:155], v[64:67]
  v_mfma_f32_16x16x32_bf16 v[4:7], a[4:7], v[144:147], v[4:7]
  ds_read_b64_tr_b16 a[28:29], v212 offset:1032
  ds_read_b64_tr_b16 a[30:31], v212 offset:1544
  v_mfma_f32_16x16x32_bf16 v[36:39], a[4:7], v[148:151], v[36:39]
  v_mfma_f32_16x16x32_bf16 v[68:71], a[4:7], v[152:155], v[68:71]
  s_add_u32 s54, s54, 8192
  s_and_b32 s54, s54, 32767
  v_add_u32 v211, s54, v209
  v_add_u32 v212, s54, v210
  s_waitcnt lgkmcnt(8)
  v_mfma_f32_16x16x32_bf16 v[8:11], a[8:11], v[144:147], v[8:11]
  ds_read_b64_tr_b16 a[0:1], v211 offset:0
  ds_read_b64_tr_b16 a[2:3], v211 offset:512
  v_mfma_f32_16x16x32_bf16 v[40:43], a[8:11], v[148:151], v[40:43]
  v_mfma_f32_16x16x32_bf16 v[72:75], a[8:11], v[152:155], v[72:75]
  v_mfma_f32_16x16x32_bf16 v[12:15], a[12:15], v[144:147], v[12:15]
  ds_read_b64_tr_b16 a[4:5], v211 offset:8
  ds_read_b64_tr_b16 a[6:7], v211 offset:520
  s_add_u32 m0, m0, 896
  s_nop 0
  buffer_load_dwordx4 v208, s[32:35], s52 offen offset:128  lds
  s_add_u32 s52, s52, 262144
  s_and_b32 s52, s52, 4194303
  s_add_u32 s53, s53, 8192
  s_and_b32 s53, s53, 32767
  v_mfma_f32_16x16x32_bf16 v[44:47], a[12:15], v[148:151], v[44:47]
  v_mfma_f32_16x16x32_bf16 v[76:79], a[12:15], v[152:155], v[76:79]
  s_waitcnt lgkmcnt(8)
  v_mfma_f32_16x16x32_bf16 v[16:19], a[16:19], v[144:147], v[16:19]
  ds_read_b64_tr_b16 a[8:9], v212 offset:0
  ds_read_b64_tr_b16 a[10:11], v212 offset:512
  v_mfma_f32_16x16x32_bf16 v[48:51], a[16:19], v[148:151], v[48:51]
  v_mfma_f32_16x16x32_bf16 v[80:83], a[16:19], v[152:155], v[80:83]
  v_mfma_f32_16x16x32_bf16 v[20:23], a[20:23], v[144:147], v[20:23]
  ds_read_b64_tr_b16 a[12:13], v212 offset:8
  ds_read_b64_tr_b16 a[14:15], v212 offset:520
  v_mfma_f32_16x16x32_bf16 v[52:55], a[20:23], v[148:151], v[52:55]
  v_mfma_f32_16x16x32_bf16 v[84:87], a[20:23], v[152:155], v[84:87]
  ds_read_b128 v[156:159], v171 offset:0
  ds_read_b128 v[160:163], v171 offset:2048
  ds_read_b128 v[164:167], v173 offset:0
  s_waitcnt lgkmcnt(11)
  v_mfma_f32_16x16x32_bf16 v[24:27], a[24:27], v[144:147], v[24:27]
  ds_read_b64_tr_b16 a[16:17], v211 offset:1024
  ds_read_b64_tr_b16 a[18:19], v211 offset:1536
  v_mfma_f32_16x16x32_bf16 v[56:59], a[24:27], v[148:151], v[56:59]
  v_mfma_f32_16x16x32_bf16 v[88:91], a[24:27], v[152:155], v[88:91]
  v_mfma_f32_16x16x32_bf16 v[28:31], a[28:31], v[144:147], v[28:31]
  ds_read_b64_tr_b16 a[20:21], v211 offset:1032
  ds_read_b64_tr_b16 a[22:23], v211 offset:1544
  v_mfma_f32_16x16x32_bf16 v[60:63], a[28:31], v[148:151], v[60:63]
  v_mfma_f32_16x16x32_bf16 v[92:95], a[28:31], v[152:155], v[92:95]
  s_waitcnt vmcnt(2)
  s_barrier
  s_waitcnt lgkmcnt(6)
  v_mfma_f32_16x16x32_bf16 v[0:3], a[0:3], v[156:159], v[0:3]
  ds_read_b64_tr_b16 a[24:25], v212 offset:1024
  ds_read_b64_tr_b16 a[26:27], v212 offset:1536
  s_add_u32 m0, s53, s51
  s_nop 0
  buffer_load_dwordx4 v208, s[32:35], s52 offen  lds
  s_waitcnt lgkmcnt(7)
  v_mfma_f32_16x16x32_bf16 v[32:35], a[0:3], v[160:163], v[32:35]
  s_waitcnt lgkmcnt(6)
  v_mfma_f32_16x16x32_bf16 v[64:67], a[0:3], v[164:167], v[64:67]
  v_mfma_f32_16x16x32_bf16 v[4:7], a[4:7], v[156:159], v[4:7]
  ds_read_b64_tr_b16 a[28:29], v212 offset:1032
  ds_read_b64_tr_b16 a[30:31], v212 offset:1544
  v_mfma_f32_16x16x32_bf16 v[36:39], a[4:7], v[160:163], v[36:39]
  v_mfma_f32_16x16x32_bf16 v[68:71], a[4:7], v[164:167], v[68:71]
  s_add_u32 s54, s54, 8192
  s_and_b32 s54, s54, 32767
  v_add_u32 v211, s54, v209
  v_add_u32 v212, s54, v210
  v_mfma_f32_16x16x32_bf16 v[8:11], a[8:11], v[156:159], v[8:11]
  ds_read_b64_tr_b16 a[0:1], v211 offset:0
  ds_read_b64_tr_b16 a[2:3], v211 offset:512
  v_mfma_f32_16x16x32_bf16 v[40:43], a[8:11], v[160:163], v[40:43]
  v_mfma_f32_16x16x32_bf16 v[72:75], a[8:11], v[164:167], v[72:75]
  v_mfma_f32_16x16x32_bf16 v[12:15], a[12:15], v[156:159], v[12:15]
  ds_read_b64_tr_b16 a[4:5], v211 offset:8
  ds_read_b64_tr_b16 a[6:7], v211 offset:520
  s_add_u32 m0, m0, 896
  s_nop 0
  buffer_load_dwordx4 v208, s[32:35], s52 offen offset:128  lds
  s_add_u32 s52, s52, 262144
  s_and_b32 s52, s52, 4194303
  s_add_u32 s53, s53, 8192
  s_and_b32 s53, s53, 32767
  v_mfma_f32_16x16x32_bf16 v[44:47], a[12:15], v[160:163], v[44:47]
  v_mfma_f32_16x16x32_bf16 v[76:79], a[12:15], v[164:167], v[76:79]
  s_waitcnt lgkmcnt(8)
  v_mfma_f32_16x16x32_bf16 v[16:19], a[16:19], v[156:159], v[16:19]
  ds_read_b64_tr_b16 a[8:9], v212 offset:0
  ds_read_b64_tr_b16 a[10:11], v212 offset:512
  v_mfma_f32_16x16x32_bf16 v[48:51], a[16:19], v[160:163], v[48:51]
  v_mfma_f32_16x16x32_bf16 v[80:83], a[16:19], v[164:167], v[80:83]
  v_mfma_f32_16x16x32_bf16 v[20:23], a[20:23], v[156:159], v[20:23]
  ds_read_b64_tr_b16 a[12:13], v212 offset:8
  ds_read_b64_tr_b16 a[14:15], v212 offset:520
  v_mfma_f32_16x16x32_bf16 v[52:55], a[20:23], v[160:163], v[52:55]
  v_mfma_f32_16x16x32_bf16 v[84:87], a[20:23], v[164:167], v[84:87]
  s_xor_b32 s77, s77, 247808
  v_add_u32 v170, s77, v168
  v_add_u32 v171, s77, v169
  v_add_u32 v172, s78, v170
  v_add_u32 v173, s78, v171
  ds_read_b128 v[144:147], v170 offset:0
  ds_read_b128 v[148:151], v170 offset:2048
  ds_read_b128 v[152:155], v172 offset:0
  s_waitcnt lgkmcnt(11)
  v_mfma_f32_16x16x32_bf16 v[24:27], a[24:27], v[156:159], v[24:27]
  ds_read_b64_tr_b16 a[16:17], v211 offset:1024
  ds_read_b64_tr_b16 a[18:19], v211 offset:1536
  v_mfma_f32_16x16x32_bf16 v[56:59], a[24:27], v[160:163], v[56:59]
  v_mfma_f32_16x16x32_bf16 v[88:91], a[24:27], v[164:167], v[88:91]
  v_mfma_f32_16x16x32_bf16 v[28:31], a[28:31], v[156:159], v[28:31]
  ds_read_b64_tr_b16 a[20:21], v211 offset:1032
  ds_read_b64_tr_b16 a[22:23], v211 offset:1544
  v_mfma_f32_16x16x32_bf16 v[60:63], a[28:31], v[160:163], v[60:63]
  v_mfma_f32_16x16x32_bf16 v[92:95], a[28:31], v[164:167], v[92:95]
  s_add_u32 s62, s62, 1
  s_cmp_lt_u32 s62, 6
  s_cbranch_scc1 K1T3a_qloop
  s_waitcnt vmcnt(2)
  s_barrier
  s_waitcnt lgkmcnt(6)
  v_mfma_f32_16x16x32_bf16 v[0:3], a[0:3], v[144:147], v[0:3]
  ds_read_b64_tr_b16 a[24:25], v212 offset:1024
  ds_read_b64_tr_b16 a[26:27], v212 offset:1536
  s_add_u32 m0, s53, s51
  s_nop 0
  buffer_load_dwordx4 v208, s[32:35], s52 offen  lds
  s_waitcnt lgkmcnt(7)
  v_mfma_f32_16x16x32_bf16 v[32:35], a[0:3], v[148:151], v[32:35]
  s_waitcnt lgkmcnt(6)
  v_mfma_f32_16x16x32_bf16 v[64:67], a[0:3], v[152:155], v[64:67]
  v_mfma_f32_16x16x32_bf16 v[4:7], a[4:7], v[144:147], v[4:7]
  ds_read_b64_tr_b16 a[28:29], v212 offset:1032
  ds_read_b64_tr_b16 a[30:31], v212 offset:1544
  v_mfma_f32_16x16x32_bf16 v[36:39], a[4:7], v[148:151], v[36:39]
  v_mfma_f32_16x16x32_bf16 v[68:71], a[4:7], v[152:155], v[68:71]
  s_add_u32 s54, s54, 8192
  s_and_b32 s54, s54, 32767
  v_add_u32 v211, s54, v209
  v_add_u32 v212, s54, v210
  v_mfma_f32_16x16x32_bf16 v[8:11], a[8:11], v[144:147], v[8:11]
  ds_read_b64_tr_b16 a[0:1], v211 offset:0
  ds_read_b64_tr_b16 a[2:3], v211 offset:512
  v_mfma_f32_16x16x32_bf16 v[40:43], a[8:11], v[148:151], v[40:43]
  v_mfma_f32_16x16x32_bf16 v[72:75], a[8:11], v[152:155], v[72:75]
  v_mfma_f32_16x16x32_bf16 v[12:15], a[12:15], v[144:147], v[12:15]
  ds_read_b64_tr_b16 a[4:5], v211 offset:8
  ds_read_b64_tr_b16 a[6:7], v211 offset:520
  s_add_u32 m0, m0, 896
  s_nop 0
  buffer_load_dwordx4 v208, s[32:35], s52 offen offset:128  lds
  s_add_u32 s52, s52, 262144
  s_and_b32 s52, s52, 4194303
  s_add_u32 s53, s53, 8192
  s_and_b32 s53, s53, 32767
  v_mfma_f32_16x16x32_bf16 v[44:47], a[12:15], v[148:151], v[44:47]
  v_mfma_f32_16x16x32_bf16 v[76:79], a[12:15], v[152:155], v[76:79]
  s_waitcnt lgkmcnt(8)
  v_mfma_f32_16x16x32_bf16 v[16:19], a[16:19], v[144:147], v[16:19]
  ds_read_b64_tr_b16 a[8:9], v212 offset:0
  ds_read_b64_tr_b16 a[10:11], v212 offset:512
  v_mfma_f32_16x16x32_bf16 v[48:51], a[16:19], v[148:151], v[48:51]
  v_mfma_f32_16x16x32_bf16 v[80:83], a[16:19], v[152:155], v[80:83]
  v_mfma_f32_16x16x32_bf16 v[20:23], a[20:23], v[144:147], v[20:23]
  ds_read_b64_tr_b16 a[12:13], v212 offset:8
  ds_read_b64_tr_b16 a[14:15], v212 offset:520
  v_mfma_f32_16x16x32_bf16 v[52:55], a[20:23], v[148:151], v[52:55]
  v_mfma_f32_16x16x32_bf16 v[84:87], a[20:23], v[152:155], v[84:87]
  ds_read_b128 v[156:159], v171 offset:0
  ds_read_b128 v[160:163], v171 offset:2048
  ds_read_b128 v[164:167], v173 offset:0
  s_waitcnt lgkmcnt(11)
  v_mfma_f32_16x16x32_bf16 v[24:27], a[24:27], v[144:147], v[24:27]
  ds_read_b64_tr_b16 a[16:17], v211 offset:1024
  ds_read_b64_tr_b16 a[18:19], v211 offset:1536
  v_mfma_f32_16x16x32_bf16 v[56:59], a[24:27], v[148:151], v[56:59]
  v_mfma_f32_16x16x32_bf16 v[88:91], a[24:27], v[152:155], v[88:91]
  v_mfma_f32_16x16x32_bf16 v[28:31], a[28:31], v[144:147], v[28:31]
  ds_read_b64_tr_b16 a[20:21], v211 offset:1032
  ds_read_b64_tr_b16 a[22:23], v211 offset:1544
  v_mfma_f32_16x16x32_bf16 v[60:63], a[28:31], v[148:151], v[60:63]
  v_mfma_f32_16x16x32_bf16 v[92:95], a[28:31], v[152:155], v[92:95]
  s_waitcnt vmcnt(2)
  s_barrier
  s_waitcnt lgkmcnt(6)
  v_mfma_f32_16x16x32_bf16 v[0:3], a[0:3], v[156:159], v[0:3]
  ds_read_b64_tr_b16 a[24:25], v212 offset:1024
  ds_read_b64_tr_b16 a[26:27], v212 offset:1536
  s_waitcnt lgkmcnt(7)
  v_mfma_f32_16x16x32_bf16 v[32:35], a[0:3], v[160:163], v[32:35]
  s_waitcnt lgkmcnt(6)
  v_mfma_f32_16x16x32_bf16 v[64:67], a[0:3], v[164:167], v[64:67]
  v_mfma_f32_16x16x32_bf16 v[4:7], a[4:7], v[156:159], v[4:7]
  ds_read_b64_tr_b16 a[28:29], v212 offset:1032
  ds_read_b64_tr_b16 a[30:31], v212 offset:1544
  v_mfma_f32_16x16x32_bf16 v[36:39], a[4:7], v[160:163], v[36:39]
  v_mfma_f32_16x16x32_bf16 v[68:71], a[4:7], v[164:167], v[68:71]
  s_add_u32 s54, s54, 8192
  s_and_b32 s54, s54, 32767
  v_add_u32 v211, s54, v209
  v_add_u32 v212, s54, v210
  v_mfma_f32_16x16x32_bf16 v[8:11], a[8:11], v[156:159], v[8:11]
  ds_read_b64_tr_b16 a[0:1], v211 offset:0
  ds_read_b64_tr_b16 a[2:3], v211 offset:512
  v_mfma_f32_16x16x32_bf16 v[40:43], a[8:11], v[160:163], v[40:43]
  v_mfma_f32_16x16x32_bf16 v[72:75], a[8:11], v[164:167], v[72:75]
  v_mfma_f32_16x16x32_bf16 v[12:15], a[12:15], v[156:159], v[12:15]
  ds_read_b64_tr_b16 a[4:5], v211 offset:8
  ds_read_b64_tr_b16 a[6:7], v211 offset:520
  v_mfma_f32_16x16x32_bf16 v[44:47], a[12:15], v[160:163], v[44:47]
  v_mfma_f32_16x16x32_bf16 v[76:79], a[12:15], v[164:167], v[76:79]
  s_waitcnt lgkmcnt(8)
  v_mfma_f32_16x16x32_bf16 v[16:19], a[16:19], v[156:159], v[16:19]
  ds_read_b64_tr_b16 a[8:9], v212 offset:0
  ds_read_b64_tr_b16 a[10:11], v212 offset:512
  v_mfma_f32_16x16x32_bf16 v[48:51], a[16:19], v[160:163], v[48:51]
  v_mfma_f32_16x16x32_bf16 v[80:83], a[16:19], v[164:167], v[80:83]
  v_mfma_f32_16x16x32_bf16 v[20:23], a[20:23], v[156:159], v[20:23]
  ds_read_b64_tr_b16 a[12:13], v212 offset:8
  ds_read_b64_tr_b16 a[14:15], v212 offset:520
  v_mfma_f32_16x16x32_bf16 v[52:55], a[20:23], v[160:163], v[52:55]
  v_mfma_f32_16x16x32_bf16 v[84:87], a[20:23], v[164:167], v[84:87]
  s_xor_b32 s77, s77, 247808
  v_add_u32 v170, s77, v168
  v_add_u32 v171, s77, v169
  v_add_u32 v172, s78, v170
  v_add_u32 v173, s78, v171
  ds_read_b128 v[144:147], v170 offset:0
  ds_read_b128 v[148:151], v170 offset:2048
  ds_read_b128 v[152:155], v172 offset:0
  s_waitcnt lgkmcnt(11)
  v_mfma_f32_16x16x32_bf16 v[24:27], a[24:27], v[156:159], v[24:27]
  ds_read_b64_tr_b16 a[16:17], v211 offset:1024
  ds_read_b64_tr_b16 a[18:19], v211 offset:1536
  v_mfma_f32_16x16x32_bf16 v[56:59], a[24:27], v[160:163], v[56:59]
  v_mfma_f32_16x16x32_bf16 v[88:91], a[24:27], v[164:167], v[88:91]
  v_mfma_f32_16x16x32_bf16 v[28:31], a[28:31], v[156:159], v[28:31]
  ds_read_b64_tr_b16 a[20:21], v211 offset:1032
  ds_read_b64_tr_b16 a[22:23], v211 offset:1544
  v_mfma_f32_16x16x32_bf16 v[60:63], a[28:31], v[160:163], v[60:63]
  v_mfma_f32_16x16x32_bf16 v[92:95], a[28:31], v[164:167], v[92:95]
  s_waitcnt vmcnt(0)
  s_barrier
  s_waitcnt lgkmcnt(6)
  v_mfma_f32_16x16x32_bf16 v[0:3], a[0:3], v[144:147], v[0:3]
  ds_read_b64_tr_b16 a[24:25], v212 offset:1024
  ds_read_b64_tr_b16 a[26:27], v212 offset:1536
  s_waitcnt lgkmcnt(7)
  v_mfma_f32_16x16x32_bf16 v[32:35], a[0:3], v[148:151], v[32:35]
  s_waitcnt lgkmcnt(6)
  v_mfma_f32_16x16x32_bf16 v[64:67], a[0:3], v[152:155], v[64:67]
  v_mfma_f32_16x16x32_bf16 v[4:7], a[4:7], v[144:147], v[4:7]
  ds_read_b64_tr_b16 a[28:29], v212 offset:1032
  ds_read_b64_tr_b16 a[30:31], v212 offset:1544
  v_mfma_f32_16x16x32_bf16 v[36:39], a[4:7], v[148:151], v[36:39]
  v_mfma_f32_16x16x32_bf16 v[68:71], a[4:7], v[152:155], v[68:71]
  s_add_u32 s54, s54, 8192
  s_and_b32 s54, s54, 32767
  v_add_u32 v211, s54, v209
  v_add_u32 v212, s54, v210
  v_mfma_f32_16x16x32_bf16 v[8:11], a[8:11], v[144:147], v[8:11]
  ds_read_b64_tr_b16 a[0:1], v211 offset:0
  ds_read_b64_tr_b16 a[2:3], v211 offset:512
  v_mfma_f32_16x16x32_bf16 v[40:43], a[8:11], v[148:151], v[40:43]
  v_mfma_f32_16x16x32_bf16 v[72:75], a[8:11], v[152:155], v[72:75]
  v_mfma_f32_16x16x32_bf16 v[12:15], a[12:15], v[144:147], v[12:15]
  ds_read_b64_tr_b16 a[4:5], v211 offset:8
  ds_read_b64_tr_b16 a[6:7], v211 offset:520
  v_mfma_f32_16x16x32_bf16 v[44:47], a[12:15], v[148:151], v[44:47]
  v_mfma_f32_16x16x32_bf16 v[76:79], a[12:15], v[152:155], v[76:79]
  s_waitcnt lgkmcnt(8)
  v_mfma_f32_16x16x32_bf16 v[16:19], a[16:19], v[144:147], v[16:19]
  ds_read_b64_tr_b16 a[8:9], v212 offset:0
  ds_read_b64_tr_b16 a[10:11], v212 offset:512
  v_mfma_f32_16x16x32_bf16 v[48:51], a[16:19], v[148:151], v[48:51]
  v_mfma_f32_16x16x32_bf16 v[80:83], a[16:19], v[152:155], v[80:83]
  v_mfma_f32_16x16x32_bf16 v[20:23], a[20:23], v[144:147], v[20:23]
  ds_read_b64_tr_b16 a[12:13], v212 offset:8
  ds_read_b64_tr_b16 a[14:15], v212 offset:520
  v_mfma_f32_16x16x32_bf16 v[52:55], a[20:23], v[148:151], v[52:55]
  v_mfma_f32_16x16x32_bf16 v[84:87], a[20:23], v[152:155], v[84:87]
  ds_read_b128 v[156:159], v171 offset:0
  ds_read_b128 v[160:163], v171 offset:2048
  ds_read_b128 v[164:167], v173 offset:0
  s_waitcnt lgkmcnt(11)
  v_mfma_f32_16x16x32_bf16 v[24:27], a[24:27], v[144:147], v[24:27]
  ds_read_b64_tr_b16 a[16:17], v211 offset:1024
  ds_read_b64_tr_b16 a[18:19], v211 offset:1536
  v_mfma_f32_16x16x32_bf16 v[56:59], a[24:27], v[148:151], v[56:59]
  v_mfma_f32_16x16x32_bf16 v[88:91], a[24:27], v[152:155], v[88:91]
  v_mfma_f32_16x16x32_bf16 v[28:31], a[28:31], v[144:147], v[28:31]
  ds_read_b64_tr_b16 a[20:21], v211 offset:1032
  ds_read_b64_tr_b16 a[22:23], v211 offset:1544
  v_mfma_f32_16x16x32_bf16 v[60:63], a[28:31], v[148:151], v[60:63]
  v_mfma_f32_16x16x32_bf16 v[92:95], a[28:31], v[152:155], v[92:95]
  s_barrier
  s_waitcnt lgkmcnt(6)
  v_mfma_f32_16x16x32_bf16 v[0:3], a[0:3], v[156:159], v[0:3]
  ds_read_b64_tr_b16 a[24:25], v212 offset:1024
  ds_read_b64_tr_b16 a[26:27], v212 offset:1536
  s_waitcnt lgkmcnt(7)
  v_mfma_f32_16x16x32_bf16 v[32:35], a[0:3], v[160:163], v[32:35]
  s_waitcnt lgkmcnt(6)
  v_mfma_f32_16x16x32_bf16 v[64:67], a[0:3], v[164:167], v[64:67]
  v_mfma_f32_16x16x32_bf16 v[4:7], a[4:7], v[156:159], v[4:7]
  ds_read_b64_tr_b16 a[28:29], v212 offset:1032
  ds_read_b64_tr_b16 a[30:31], v212 offset:1544
  v_mfma_f32_16x16x32_bf16 v[36:39], a[4:7], v[160:163], v[36:39]
  v_mfma_f32_16x16x32_bf16 v[68:71], a[4:7], v[164:167], v[68:71]
  v_mfma_f32_16x16x32_bf16 v[8:11], a[8:11], v[156:159], v[8:11]
  v_mfma_f32_16x16x32_bf16 v[40:43], a[8:11], v[160:163], v[40:43]
  v_mfma_f32_16x16x32_bf16 v[72:75], a[8:11], v[164:167], v[72:75]
  v_mfma_f32_16x16x32_bf16 v[12:15], a[12:15], v[156:159], v[12:15]
  v_mfma_f32_16x16x32_bf16 v[44:47], a[12:15], v[160:163], v[44:47]
  v_mfma_f32_16x16x32_bf16 v[76:79], a[12:15], v[164:167], v[76:79]
  s_waitcnt lgkmcnt(4)
  v_mfma_f32_16x16x32_bf16 v[16:19], a[16:19], v[156:159], v[16:19]
  v_mfma_f32_16x16x32_bf16 v[48:51], a[16:19], v[160:163], v[48:51]
  v_mfma_f32_16x16x32_bf16 v[80:83], a[16:19], v[164:167], v[80:83]
  v_mfma_f32_16x16x32_bf16 v[20:23], a[20:23], v[156:159], v[20:23]
  v_mfma_f32_16x16x32_bf16 v[52:55], a[20:23], v[160:163], v[52:55]
  v_mfma_f32_16x16x32_bf16 v[84:87], a[20:23], v[164:167], v[84:87]
  s_waitcnt lgkmcnt(0)
  v_mfma_f32_16x16x32_bf16 v[24:27], a[24:27], v[156:159], v[24:27]
  v_mfma_f32_16x16x32_bf16 v[56:59], a[24:27], v[160:163], v[56:59]
  v_mfma_f32_16x16x32_bf16 v[88:91], a[24:27], v[164:167], v[88:91]
  v_mfma_f32_16x16x32_bf16 v[28:31], a[28:31], v[156:159], v[28:31]
  v_mfma_f32_16x16x32_bf16 v[60:63], a[28:31], v[160:163], v[60:63]
  v_mfma_f32_16x16x32_bf16 v[92:95], a[28:31], v[164:167], v[92:95]
  s_nop 7
  v_pk_mul_f32 v[0:1], v[0:1], s[64:65]
  v_pk_mul_f32 v[2:3], v[2:3], s[64:65]
  v_pk_mul_f32 v[4:5], v[4:5], s[64:65]
  v_pk_mul_f32 v[6:7], v[6:7], s[64:65]
  v_cvt_pk_bf16_f32 v96, v0, v1
  v_cvt_pk_bf16_f32 v97, v2, v3
  v_cvt_pk_bf16_f32 v98, v4, v5
  v_cvt_pk_bf16_f32 v99, v6, v7
  v_pk_mul_f32 v[8:9], v[8:9], s[64:65]
  v_pk_mul_f32 v[10:11], v[10:11], s[64:65]
  v_pk_mul_f32 v[12:13], v[12:13], s[64:65]
  v_pk_mul_f32 v[14:15], v[14:15], s[64:65]
  v_cvt_pk_bf16_f32 v100, v8, v9
  v_cvt_pk_bf16_f32 v101, v10, v11
  v_cvt_pk_bf16_f32 v102, v12, v13
  v_cvt_pk_bf16_f32 v103, v14, v15
  v_pk_mul_f32 v[16:17], v[16:17], s[64:65]
  v_pk_mul_f32 v[18:19], v[18:19], s[64:65]
  v_pk_mul_f32 v[20:21], v[20:21], s[64:65]
  v_pk_mul_f32 v[22:23], v[22:23], s[64:65]
  v_cvt_pk_bf16_f32 v104, v16, v17
  v_cvt_pk_bf16_f32 v105, v18, v19
  v_cvt_pk_bf16_f32 v106, v20, v21
  v_cvt_pk_bf16_f32 v107, v22, v23
  v_pk_mul_f32 v[24:25], v[24:25], s[64:65]
  v_pk_mul_f32 v[26:27], v[26:27], s[64:65]
  v_pk_mul_f32 v[28:29], v[28:29], s[64:65]
  v_pk_mul_f32 v[30:31], v[30:31], s[64:65]
  v_cvt_pk_bf16_f32 v108, v24, v25
  v_cvt_pk_bf16_f32 v109, v26, v27
  v_cvt_pk_bf16_f32 v110, v28, v29
  v_cvt_pk_bf16_f32 v111, v30, v31
  v_pk_mul_f32 v[32:33], v[32:33], s[64:65]
  v_pk_mul_f32 v[34:35], v[34:35], s[64:65]
  v_pk_mul_f32 v[36:37], v[36:37], s[64:65]
  v_pk_mul_f32 v[38:39], v[38:39], s[64:65]
  v_cvt_pk_bf16_f32 v112, v32, v33
  v_cvt_pk_bf16_f32 v113, v34, v35
  v_cvt_pk_bf16_f32 v114, v36, v37
  v_cvt_pk_bf16_f32 v115, v38, v39
  v_pk_mul_f32 v[40:41], v[40:41], s[64:65]
  v_pk_mul_f32 v[42:43], v[42:43], s[64:65]
  v_pk_mul_f32 v[44:45], v[44:45], s[64:65]
  v_pk_mul_f32 v[46:47], v[46:47], s[64:65]
  v_cvt_pk_bf16_f32 v116, v40, v41
  v_cvt_pk_bf16_f32 v117, v42, v43
  v_cvt_pk_bf16_f32 v118, v44, v45
  v_cvt_pk_bf16_f32 v119, v46, v47
  v_pk_mul_f32 v[48:49], v[48:49], s[64:65]
  v_pk_mul_f32 v[50:51], v[50:51], s[64:65]
  v_pk_mul_f32 v[52:53], v[52:53], s[64:65]
  v_pk_mul_f32 v[54:55], v[54:55], s[64:65]
  v_cvt_pk_bf16_f32 v120, v48, v49
  v_cvt_pk_bf16_f32 v121, v50, v51
  v_cvt_pk_bf16_f32 v122, v52, v53
  v_cvt_pk_bf16_f32 v123, v54, v55
  v_pk_mul_f32 v[56:57], v[56:57], s[64:65]
  v_pk_mul_f32 v[58:59], v[58:59], s[64:65]
  v_pk_mul_f32 v[60:61], v[60:61], s[64:65]
  v_pk_mul_f32 v[62:63], v[62:63], s[64:65]
  v_cvt_pk_bf16_f32 v124, v56, v57
  v_cvt_pk_bf16_f32 v125, v58, v59
  v_cvt_pk_bf16_f32 v126, v60, v61
  v_cvt_pk_bf16_f32 v127, v62, v63
  v_pk_mul_f32 v[64:65], v[64:65], s[64:65]
  v_pk_mul_f32 v[66:67], v[66:67], s[64:65]
  v_pk_mul_f32 v[68:69], v[68:69], s[64:65]
  v_pk_mul_f32 v[70:71], v[70:71], s[64:65]
  v_cvt_pk_bf16_f32 v128, v64, v65
  v_cvt_pk_bf16_f32 v129, v66, v67
  v_cvt_pk_bf16_f32 v130, v68, v69
  v_cvt_pk_bf16_f32 v131, v70, v71
  v_pk_mul_f32 v[72:73], v[72:73], s[64:65]
  v_pk_mul_f32 v[74:75], v[74:75], s[64:65]
  v_pk_mul_f32 v[76:77], v[76:77], s[64:65]
  v_pk_mul_f32 v[78:79], v[78:79], s[64:65]
  v_cvt_pk_bf16_f32 v132, v72, v73
  v_cvt_pk_bf16_f32 v133, v74, v75
  v_cvt_pk_bf16_f32 v134, v76, v77
  v_cvt_pk_bf16_f32 v135, v78, v79
  v_pk_mul_f32 v[80:81], v[80:81], s[64:65]
  v_pk_mul_f32 v[82:83], v[82:83], s[64:65]
  v_pk_mul_f32 v[84:85], v[84:85], s[64:65]
  v_pk_mul_f32 v[86:87], v[86:87], s[64:65]
  v_cvt_pk_bf16_f32 v136, v80, v81
  v_cvt_pk_bf16_f32 v137, v82, v83
  v_cvt_pk_bf16_f32 v138, v84, v85
  v_cvt_pk_bf16_f32 v139, v86, v87
  v_pk_mul_f32 v[88:89], v[88:89], s[64:65]
  v_pk_mul_f32 v[90:91], v[90:91], s[64:65]
  v_pk_mul_f32 v[92:93], v[92:93], s[64:65]
  v_pk_mul_f32 v[94:95], v[94:95], s[64:65]
  v_cvt_pk_bf16_f32 v140, v88, v89
  v_cvt_pk_bf16_f32 v141, v90, v91
  v_cvt_pk_bf16_f32 v142, v92, v93
  v_cvt_pk_bf16_f32 v143, v94, v95
  s_lshl_b32 s63, s73, 4
  s_add_u32 s63, s63, s74
  s_lshr_b32 s66, s63, 5
  s_lshl_b32 s66, s66, 2
  s_and_b32 s63, s63, 31
  s_lshl_b32 s63, 1, s63
  v_mov_b32 v217, s66
  v_mov_b32 v218, s63
  s_mov_b64 exec, 1
  global_atomic_or v217, v218, s[16:17] sc1
  s_mov_b64 exec, -1
  s_branch K1T3_mid
K1T3_g1:
  s_add_u32 m0, s76, s3
  s_add_u32 s72, s45, s55
  buffer_load_dwordx4 v213, s[20:23], s72 offen  lds
  s_add_u32 m0, m0, 1024
  s_add_u32 s72, s72, 8192
  buffer_load_dwordx4 v213, s[20:23], s72 offen  lds
  s_add_u32 m0, s76, s100
  s_add_u32 s72, s46, s55
  buffer_load_dwordx4 v213, s[20:23], s72 offen  lds
  s_add_u32 m0, m0, 1024
  s_add_u32 s72, s72, 8192
  buffer_load_dwordx4 v213, s[20:23], s72 offen  lds
  s_cmp_lt_u32 s42, 2
  s_cbranch_scc0 XL14
  s_add_u32 m0, s76, s101
  s_add_u32 s72, s47, s55
  buffer_load_dwordx4 v213, s[20:23], s72 offen  lds
XL14:
  s_add_u32 s55, s55, 128
  s_and_b32 s55, s55, 1023
  s_xor_b32 s76, s76, 247808
  s_add_u32 m0, s76, s3
  s_add_u32 s72, s45, s55
  buffer_load_dwordx4 v213, s[20:23], s72 offen  lds
  s_add_u32 m0, m0, 1024
  s_add_u32 s72, s72, 8192
  buffer_load_dwordx4 v213, s[20:23], s72 offen  lds
  s_add_u32 m0, s76, s100
  s_add_u32 s72, s46, s55
  buffer_load_dwordx4 v213, s[20:23], s72 offen  lds
  s_add_u32 m0, m0, 1024
  s_add_u32 s72, s72, 8192
  buffer_load_dwordx4 v213, s[20:23], s72 offen  lds
  s_cmp_lt_u32 s42, 2
  s_cbranch_scc0 XL15
  s_add_u32 m0, s76, s101
  s_add_u32 s72, s47, s55
  buffer_load_dwordx4 v213, s[20:23], s72 offen  lds
XL15:
  s_add_u32 s55, s55, 128
  s_and_b32 s55, s55, 1023
  s_xor_b32 s76, s76, 247808
  s_waitcnt vmcnt(4)
  s_barrier
  s_barrier
  s_mov_b32 s67, 0
  s_xor_b32 s72, 0, s70
  s_add_u32 m0, s67, s43
  s_nop 0
  buffer_load_dwordx4 v207, s[24:27], s72 offen nt lds
  s_add_u32 m0, m0, 896
  s_nop 0
  buffer_load_dwordx4 v207, s[24:27], s72 offen offset:128 nt lds
  s_waitcnt vmcnt(2)
  s_barrier
  s_add_u32 m0, s76, s3
  s_add_u32 s72, s45, s55
  buffer_load_dwordx4 v213, s[20:23], s72 offen  lds
  s_add_u32 m0, m0, 1024
  s_add_u32 s72, s72, 8192
  buffer_load_dwordx4 v213, s[20:23], s72 offen  lds
  s_add_u32 m0, s76, s100
  s_add_u32 s72, s46, s55
  buffer_load_dwordx4 v213, s[20:23], s72 offen  lds
  s_add_u32 m0, m0, 1024
  s_add_u32 s72, s72, 8192
  buffer_load_dwordx4 v213, s[20:23], s72 offen  lds
  s_cmp_lt_u32 s42, 2
  s_cbranch_scc0 XL16
  s_add_u32 m0, s76, s101
  s_add_u32 s72, s47, s55
  buffer_load_dwordx4 v213, s[20:23], s72 offen  lds
XL16:
  s_add_u32 s55, s55, 128
  s_and_b32 s55, s55, 1023
  s_xor_b32 s76, s76, 247808
  s_barrier
  s_mov_b32 s67, 8192
  s_xor_b32 s72, 8192, s70
  s_add_u32 m0, s67, s43
  s_nop 0
  buffer_load_dwordx4 v207, s[24:27], s72 offen nt lds
  s_add_u32 m0, m0, 896
  s_nop 0
  buffer_load_dwordx4 v207, s[24:27], s72 offen offset:128 nt lds
  s_waitcnt vmcnt(2)
  s_barrier
  s_add_u32 m0, s76, s3
  s_add_u32 s72, s45, s55
  buffer_load_dwordx4 v213, s[20:23], s72 offen  lds
  s_add_u32 m0, m0, 1024
  s_add_u32 s72, s72, 8192
  buffer_load_dwordx4 v213, s[20:23], s72 offen  lds
  s_add_u32 m0, s76, s100
  s_add_u32 s72, s46, s55
  buffer_load_dwordx4 v213, s[20:23], s72 offen  lds
  s_add_u32 m0, m0, 1024
  s_add_u32 s72, s72, 8192
  buffer_load_dwordx4 v213, s[20:23], s72 offen  lds
  s_cmp_lt_u32 s42, 2
  s_cbranch_scc0 XL17
  s_add_u32 m0, s76, s101
  s_add_u32 s72, s47, s55
  buffer_load_dwordx4 v213, s[20:23], s72 offen  lds
XL17:
  s_add_u32 s55, s55, 128
  s_and_b32 s55, s55, 1023
  s_xor_b32 s76, s76, 247808
  s_barrier
  s_mov_b32 s67, 32768
  s_xor_b32 s72, 0, s70
  s_add_u32 m0, s67, s43
  s_nop 0
  buffer_load_dwordx4 v207, s[28:31], s72 offen nt lds
  s_add_u32 m0, m0, 896
  s_nop 0
  buffer_load_dwordx4 v207, s[28:31], s72 offen offset:128 nt lds
  s_waitcnt vmcnt(2)
  s_barrier
  s_add_u32 m0, s76, s3
  s_add_u32 s72, s45, s55
  buffer_load_dwordx4 v213, s[20:23], s72 offen  lds
  s_add_u32 m0, m0, 1024
  s_add_u32 s72, s72, 8192
  buffer_load_dwordx4 v213, s[20:23], s72 offen  lds
  s_add_u32 m0, s76, s100
  s_add_u32 s72, s46, s55
  buffer_load_dwordx4 v213, s[20:23], s72 offen  lds
  s_add_u32 m0, m0, 1024
  s_add_u32 s72, s72, 8192
  buffer_load_dwordx4 v213, s[20:23], s72 offen  lds
  s_cmp_lt_u32 s42, 2
  s_cbranch_scc0 XL18
  s_add_u32 m0, s76, s101
  s_add_u32 s72, s47, s55
  buffer_load_dwordx4 v213, s[20:23], s72 offen  lds
XL18:
  s_add_u32 s55, s55, 128
  s_and_b32 s55, s55, 1023
  s_xor_b32 s76, s76, 247808
  s_mov_b32 s67, 16384
  s_xor_b32 s72, 16384, s70
  s_add_u32 m0, s67, s43
  s_nop 0
  buffer_load_dwordx4 v207, s[24:27], s72 offen nt lds
  s_add_u32 m0, m0, 896
  s_nop 0
  buffer_load_dwordx4 v207, s[24:27], s72 offen offset:128 nt lds
  s_barrier
  s_waitcnt vmcnt(2)
  s_barrier
  s_add_u32 m0, s76, s3
  s_add_u32 s72, s45, s55
  buffer_load_dwordx4 v213, s[20:23], s72 offen  lds
  s_add_u32 m0, m0, 1024
  s_add_u32 s72, s72, 8192
  buffer_load_dwordx4 v213, s[20:23], s72 offen  lds
  s_add_u32 m0, s76, s100
  s_add_u32 s72, s46, s55
  buffer_load_dwordx4 v213, s[20:23], s72 offen  lds
  s_add_u32 m0, m0, 1024
  s_add_u32 s72, s72, 8192
  buffer_load_dwordx4 v213, s[20:23], s72 offen  lds
  s_cmp_lt_u32 s42, 2
  s_cbranch_scc0 XL19
  s_add_u32 m0, s76, s101
  s_add_u32 s72, s47, s55
  buffer_load_dwordx4 v213, s[20:23], s72 offen  lds
XL19:
  s_add_u32 s55, s55, 128
  s_and_b32 s55, s55, 1023
  s_xor_b32 s76, s76, 247808
  s_mov_b32 s67, 40960
  s_xor_b32 s72, 8192, s70
  s_add_u32 m0, s67, s43
  s_nop 0
  buffer_load_dwordx4 v207, s[28:31], s72 offen nt lds
  s_add_u32 m0, m0, 896
  s_nop 0
  buffer_load_dwordx4 v207, s[28:31], s72 offen offset:128 nt lds
  s_barrier
  s_mov_b32 s67, 24576
  s_xor_b32 s72, 24576, s70
  s_add_u32 m0, s67, s43
  s_nop 0
  buffer_load_dwordx4 v207, s[24:27], s72 offen nt lds
  s_add_u32 m0, m0, 896
  s_nop 0
  buffer_load_dwordx4 v207, s[24:27], s72 offen offset:128 nt lds
  v_mov_b64 v[0:1], 0
  v_mov_b64 v[2:3], 0
  v_mov_b64 v[4:5], 0
  v_mov_b64 v[6:7], 0
  v_mov_b64 v[8:9], 0
  v_mov_b64 v[10:11], 0
  v_mov_b64 v[12:13], 0
  v_mov_b64 v[14:15], 0
  v_mov_b64 v[16:17], 0
  v_mov_b64 v[18:19], 0
  v_mov_b64 v[20:21], 0
  v_mov_b64 v[22:23], 0
  v_mov_b64 v[24:25], 0
  v_mov_b64 v[26:27], 0
  v_mov_b64 v[28:29], 0
  v_mov_b64 v[30:31], 0
  v_mov_b64 v[32:33], 0
  v_mov_b64 v[34:35], 0
  v_mov_b64 v[36:37], 0
  v_mov_b64 v[38:39], 0
  v_mov_b64 v[40:41], 0
  v_mov_b64 v[42:43], 0
  v_mov_b64 v[44:45], 0
  v_mov_b64 v[46:47], 0
  v_mov_b64 v[48:49], 0
  v_mov_b64 v[50:51], 0
  v_mov_b64 v[52:53], 0
  v_mov_b64 v[54:55], 0
  v_mov_b64 v[56:57], 0
  v_mov_b64 v[58:59], 0
  v_mov_b64 v[60:61], 0
  v_mov_b64 v[62:63], 0
  v_mov_b64 v[64:65], 0
  v_mov_b64 v[66:67], 0
  v_mov_b64 v[68:69], 0
  v_mov_b64 v[70:71], 0
  v_mov_b64 v[72:73], 0
  v_mov_b64 v[74:75], 0
  v_mov_b64 v[76:77], 0
  v_mov_b64 v[78:79], 0
  v_mov_b64 v[80:81], 0
  v_mov_b64 v[82:83], 0
  v_mov_b64 v[84:85], 0
  v_mov_b64 v[86:87], 0
  v_mov_b64 v[88:89], 0
  v_mov_b64 v[90:91], 0
  v_mov_b64 v[92:93], 0
  v_mov_b64 v[94:95], 0
  s_waitcnt vmcnt(4)
  s_barrier
  s_add_u32 m0, s76, s3
  s_add_u32 s72, s45, s55
  buffer_load_dwordx4 v213, s[20:23], s72 offen  lds
  s_add_u32 m0, m0, 1024
  s_add_u32 s72, s72, 8192
  buffer_load_dwordx4 v213, s[20:23], s72 offen  lds
  s_add_u32 m0, s76, s100
  s_add_u32 s72, s46, s55
  buffer_load_dwordx4 v213, s[20:23], s72 offen  lds
  s_add_u32 m0, m0, 1024
  s_add_u32 s72, s72, 8192
  buffer_load_dwordx4 v213, s[20:23], s72 offen  lds
  s_cmp_lt_u32 s42, 2
  s_cbranch_scc0 XL20
  s_add_u32 m0, s76, s101
  s_add_u32 s72, s47, s55
  buffer_load_dwordx4 v213, s[20:23], s72 offen  lds
XL20:
  s_add_u32 s55, s55, 128
  s_and_b32 s55, s55, 1023
  s_xor_b32 s76, s76, 247808
  s_barrier
  s_mov_b32 s67, 49152
  s_xor_b32 s72, 16384, s70
  s_add_u32 m0, s67, s43
  s_nop 0
  buffer_load_dwordx4 v207, s[28:31], s72 offen nt lds
  s_add_u32 m0, m0, 896
  s_nop 0
  buffer_load_dwordx4 v207, s[28:31], s72 offen offset:128 nt lds
  s_waitcnt vmcnt(2)
  s_barrier
  s_add_u32 m0, s76, s3
  s_add_u32 s72, s45, s55
  buffer_load_dwordx4 v213, s[20:23], s72 offen  lds
  s_add_u32 m0, m0, 1024
  s_add_u32 s72, s72, 8192
  buffer_load_dwordx4 v213, s[20:23], s72 offen  lds
  s_add_u32 m0, s76, s100
  s_add_u32 s72, s46, s55
  buffer_load_dwordx4 v213, s[20:23], s72 offen  lds
  s_add_u32 m0, m0, 1024
  s_add_u32 s72, s72, 8192
  buffer_load_dwordx4 v213, s[20:23], s72 offen  lds
  s_cmp_lt_u32 s42, 2
  s_cbranch_scc0 XL21
  s_add_u32 m0, s76, s101
  s_add_u32 s72, s47, s55
  buffer_load_dwordx4 v213, s[20:23], s72 offen  lds
XL21:
  s_add_u32 s55, s55, 128
  s_and_b32 s55, s55, 1023
  s_xor_b32 s76, s76, 247808
  s_barrier
  s_mov_b32 s67, 57344
  s_xor_b32 s72, 24576, s70
  s_add_u32 m0, s67, s43
  s_nop 0
  buffer_load_dwordx4 v207, s[28:31], s72 offen nt lds
  s_add_u32 m0, m0, 896
  s_nop 0
  buffer_load_dwordx4 v207, s[28:31], s72 offen offset:128 nt lds
  s_waitcnt vmcnt(2)
  s_barrier
  s_add_u32 m0, s53, s51
  s_nop 0
  buffer_load_dwordx4 v208, s[32:35], s52 offen  lds
  s_add_u32 m0, m0, 896
  s_nop 0
  buffer_load_dwordx4 v208, s[32:35], s52 offen offset:128  lds
  s_add_u32 s52, s52, 262144
  s_and_b32 s52, s52, 4194303
  s_add_u32 s53, s53, 8192
  s_and_b32 s53, s53, 32767
  s_add_u32 m0, s76, s3
  s_add_u32 s72, s45, s55
  buffer_load_dwordx4 v213, s[20:23], s72 offen  lds
  s_add_u32 m0, m0, 1024
  s_add_u32 s72, s72, 8192
  buffer_load_dwordx4 v213, s[20:23], s72 offen  lds
  s_add_u32 m0, s76, s100
  s_add_u32 s72, s46, s55
  buffer_load_dwordx4 v213, s[20:23], s72 offen  lds
  s_add_u32 m0, m0, 1024
  s_add_u32 s72, s72, 8192
  buffer_load_dwordx4 v213, s[20:23], s72 offen  lds
  s_cmp_lt_u32 s42, 2
  s_cbranch_scc0 XL22
  s_add_u32 m0, s76, s101
  s_add_u32 s72, s47, s55
  buffer_load_dwordx4 v213, s[20:23], s72 offen  lds
XL22:
  s_add_u32 s55, s55, 128
  s_and_b32 s55, s55, 1023
  s_xor_b32 s76, s76, 247808
  s_mov_b32 s67, 65536
  s_xor_b32 s72, 32768, s70
  s_add_u32 m0, s67, s43
  s_nop 0
  buffer_load_dwordx4 v207, s[28:31], s72 offen nt lds
  s_add_u32 m0, m0, 896
  s_nop 0
  buffer_load_dwordx4 v207, s[28:31], s72 offen offset:128 nt lds
  s_barrier
  s_add_u32 m0, s53, s51
  s_nop 0
  buffer_load_dwordx4 v208, s[32:35], s52 offen  lds
  s_add_u32 m0, m0, 896
  s_nop 0
  buffer_load_dwordx4 v208, s[32:35], s52 offen offset:128  lds
  s_add_u32 s52, s52, 262144
  s_and_b32 s52, s52, 4194303
  s_add_u32 s53, s53, 8192
  s_and_b32 s53, s53, 32767
  s_barrier
  s_add_u32 m0, s53, s51
  s_nop 0
  buffer_load_dwordx4 v208, s[32:35], s52 offen  lds
  s_add_u32 m0, m0, 896
  s_nop 0
  buffer_load_dwordx4 v208, s[32:35], s52 offen offset:128  lds
  s_add_u32 s52, s52, 262144
  s_and_b32 s52, s52, 4194303
  s_add_u32 s53, s53, 8192
  s_and_b32 s53, s53, 32767
  s_add_u32 m0, s76, s3
  s_add_u32 s72, s45, s55
  buffer_load_dwordx4 v213, s[20:23], s72 offen  lds
  s_add_u32 m0, m0, 1024
  s_add_u32 s72, s72, 8192
  buffer_load_dwordx4 v213, s[20:23], s72 offen  lds
  s_add_u32 m0, s76, s100
  s_add_u32 s72, s46, s55
  buffer_load_dwordx4 v213, s[20:23], s72 offen  lds
  s_add_u32 m0, m0, 1024
  s_add_u32 s72, s72, 8192
  buffer_load_dwordx4 v213, s[20:23], s72 offen  lds
  s_cmp_lt_u32 s42, 2
  s_cbranch_scc0 XL23
  s_add_u32 m0, s76, s101
  s_add_u32 s72, s47, s55
  buffer_load_dwordx4 v213, s[20:23], s72 offen  lds
XL23:
  s_add_u32 s55, s55, 128
  s_and_b32 s55, s55, 1023
  s_xor_b32 s76, s76, 247808
  s_mov_b32 s67, 73728
  s_xor_b32 s72, 40960, s70
  s_add_u32 m0, s67, s43
  s_nop 0
  buffer_load_dwordx4 v207, s[28:31], s72 offen nt lds
  s_add_u32 m0, m0, 896
  s_nop 0
  buffer_load_dwordx4 v207, s[28:31], s72 offen offset:128 nt lds
  s_waitcnt vmcnt(12)
  s_barrier
  v_add_u32 v170, s77, v168
  v_add_u32 v171, s77, v169
  v_add_u32 v172, s78, v170
  v_add_u32 v173, s78, v171
  ds_read_b128 v[144:147], v170 offset:0
  ds_read_b128 v[148:151], v170 offset:2048
  ds_read_b128 v[152:155], v172 offset:0
  ds_read_b64_tr_b16 a[0:1], v211 offset:0
  ds_read_b64_tr_b16 a[2:3], v211 offset:512
  ds_read_b64_tr_b16 a[4:5], v211 offset:8
  ds_read_b64_tr_b16 a[6:7], v211 offset:520
  ds_read_b64_tr_b16 a[8:9], v212 offset:0
  ds_read_b64_tr_b16 a[10:11], v212 offset:512
  ds_read_b64_tr_b16 a[12:13], v212 offset:8
  ds_read_b64_tr_b16 a[14:15], v212 offset:520
  ds_read_b64_tr_b16 a[16:17], v211 offset:1024
  ds_read_b64_tr_b16 a[18:19], v211 offset:1536
  ds_read_b64_tr_b16 a[20:21], v211 offset:1032
  ds_read_b64_tr_b16 a[22:23], v211 offset:1544
  s_mov_b32 s62, 0
K1T3b_qloop:
  s_waitcnt vmcnt(8)
  s_barrier
  s_waitcnt lgkmcnt(6)
  v_mfma_f32_16x16x32_bf16 v[0:3], a[0:3], v[144:147], v[0:3]
  ds_read_b64_tr_b16 a[24:25], v212 offset:1024
  ds_read_b64_tr_b16 a[26:27], v212 offset:1536
  s_cmp_eq_u32 s62, 0
  s_cbranch_scc1 VL24
  s_xor_b32 s72, s57, s70
  s_add_u32 m0, s59, s44
  s_nop 0
  buffer_load_dwordx4 v207, s[28:31], s72 offen nt lds
  s_add_u32 m0, m0, 896
  s_nop 0
  buffer_load_dwordx4 v207, s[28:31], s72 offen offset:128 nt lds
  s_add_u32 s57, s57, 8192
  s_add_u32 s59, s59, 8192
  s_cmp_eq_u32 s59, 49152
  s_cselect_b32 s59, 0, s59
VL24:
  s_waitcnt lgkmcnt(7)
  v_mfma_f32_16x16x32_bf16 v[32:35], a[0:3], v[148:151], v[32:35]
  s_waitcnt lgkmcnt(6)
  v_mfma_f32_16x16x32_bf16 v[64:67], a[0:3], v[152:155], v[64:67]
  v_mfma_f32_16x16x32_bf16 v[4:7], a[4:7], v[144:147], v[4:7]
  ds_read_b64_tr_b16 a[28:29], v212 offset:1032
  ds_read_b64_tr_b16 a[30:31], v212 offset:1544
  s_xor_b32 s72, s56, s70
  s_add_u32 m0, s58, s43
  s_nop 0
  buffer_load_dwordx4 v207, s[24:27], s72 offen nt lds
  v_mfma_f32_16x16x32_bf16 v[36:39], a[4:7], v[148:151], v[36:39]
  v_mfma_f32_16x16x32_bf16 v[68:71], a[4:7], v[152:155], v[68:71]
  s_add_u32 s54, s54, 8192
  s_and_b32 s54, s54, 32767
  v_add_u32 v211, s54, v209
  v_add_u32 v212, s54, v210
  s_waitcnt lgkmcnt(8)
  v_mfma_f32_16x16x32_bf16 v[8:11], a[8:11], v[144:147], v[8:11]
  ds_read_b64_tr_b16 a[0:1], v211 offset:0
  ds_read_b64_tr_b16 a[2:3], v211 offset:512
  v_mfma_f32_16x16x32_bf16 v[40:43], a[8:11], v[148:151], v[40:43]
  s_add_u32 m0, m0, 896
  s_nop 0
  buffer_load_dwordx4 v207, s[24:27], s72 offen offset:128 nt lds
  v_mfma_f32_16x16x32_bf16 v[72:75], a[8:11], v[152:155], v[72:75]
  v_mfma_f32_16x16x32_bf16 v[12:15], a[12:15], v[144:147], v[12:15]
  ds_read_b64_tr_b16 a[4:5], v211 offset:8
  ds_read_b64_tr_b16 a[6:7], v211 offset:520
  v_mfma_f32_16x16x32_bf16 v[44:47], a[12:15], v[148:151], v[44:47]
  v_mfma_f32_16x16x32_bf16 v[76:79], a[12:15], v[152:155], v[76:79]
  s_add_u32 s56, s56, 8192
  s_add_u32 s58, s58, 8192
  s_and_b32 s58, s58, 32767
  s_add_u32 m0, s53, s51
  s_nop 0
  buffer_load_dwordx4 v208, s[32:35], s52 offen  lds
  s_waitcnt lgkmcnt(8)
  v_mfma_f32_16x16x32_bf16 v[16:19], a[16:19], v[144:147], v[16:19]
  ds_read_b64_tr_b16 a[8:9], v212 offset:0
  ds_read_b64_tr_b16 a[10:11], v212 offset:512
  v_mfma_f32_16x16x32_bf16 v[48:51], a[16:19], v[148:151], v[48:51]
  v_mfma_f32_16x16x32_bf16 v[80:83], a[16:19], v[152:155], v[80:83]
  v_mfma_f32_16x16x32_bf16 v[20:23], a[20:23], v[144:147], v[20:23]
  ds_read_b64_tr_b16 a[12:13], v212 offset:8
  ds_read_b64_tr_b16 a[14:15], v212 offset:520
  s_add_u32 m0, m0, 896
  s_nop 0
  buffer_load_dwordx4 v208, s[32:35], s52 offen offset:128  lds
  s_add_u32 s52, s52, 262144
  s_and_b32 s52, s52, 4194303
  s_add_u32 s53, s53, 8192
  s_and_b32 s53, s53, 32767
  v_mfma_f32_16x16x32_bf16 v[52:55], a[20:23], v[148:151], v[52:55]
  v_mfma_f32_16x16x32_bf16 v[84:87], a[20:23], v[152:155], v[84:87]
  ds_read_b128 v[156:159], v171 offset:0
  ds_read_b128 v[160:163], v171 offset:2048
  ds_read_b128 v[164:167], v173 offset:0
  s_waitcnt lgkmcnt(11)
  v_mfma_f32_16x16x32_bf16 v[24:27], a[24:27], v[144:147], v[24:27]
  ds_read_b64_tr_b16 a[16:17], v211 offset:1024
  ds_read_b64_tr_b16 a[18:19], v211 offset:1536
  v_mfma_f32_16x16x32_bf16 v[56:59], a[24:27], v[148:151], v[56:59]
  v_mfma_f32_16x16x32_bf16 v[88:91], a[24:27], v[152:155], v[88:91]
  v_mfma_f32_16x16x32_bf16 v[28:31], a[28:31], v[144:147], v[28:31]
  ds_read_b64_tr_b16 a[20:21], v211 offset:1032
  ds_read_b64_tr_b16 a[22:23], v211 offset:1544
  v_mfma_f32_16x16x32_bf16 v[60:63], a[28:31], v[148:151], v[60:63]
  v_mfma_f32_16x16x32_bf16 v[92:95], a[28:31], v[152:155], v[92:95]
  s_waitcnt vmcnt(6)
  s_barrier
  s_waitcnt lgkmcnt(6)
  v_mfma_f32_16x16x32_bf16 v[0:3], a[0:3], v[156:159], v[0:3]
  ds_read_b64_tr_b16 a[24:25], v212 offset:1024
  ds_read_b64_tr_b16 a[26:27], v212 offset:1536
  s_cmp_eq_u32 s62, 0
  s_cbranch_scc1 VL25
  s_xor_b32 s72, s57, s70
  s_add_u32 m0, s59, s44
  s_nop 0
  buffer_load_dwordx4 v207, s[28:31], s72 offen nt lds
  s_add_u32 m0, m0, 896
  s_nop 0
  buffer_load_dwordx4 v207, s[28:31], s72 offen offset:128 nt lds
  s_add_u32 s57, s57, 8192
  s_add_u32 s59, s59, 8192
  s_cmp_eq_u32 s59, 49152
  s_cselect_b32 s59, 0, s59
VL25:
  s_waitcnt lgkmcnt(7)
  v_mfma_f32_16x16x32_bf16 v[32:35], a[0:3], v[160:163], v[32:35]
  s_xor_b32 s72, s56, s70
  s_add_u32 m0, s58, s43
  s_nop 0
  buffer_load_dwordx4 v207, s[24:27], s72 offen nt lds
  s_waitcnt lgkmcnt(6)
  v_mfma_f32_16x16x32_bf16 v[64:67], a[0:3], v[164:167], v[64:67]
  v_mfma_f32_16x16x32_bf16 v[4:7], a[4:7], v[156:159], v[4:7]
  ds_read_b64_tr_b16 a[28:29], v212 offset:1032
  ds_read_b64_tr_b16 a[30:31], v212 offset:1544
  s_add_u32 m0, m0, 896
  s_nop 0
  buffer_load_dwordx4 v207, s[24:27], s72 offen offset:128 nt lds
  v_mfma_f32_16x16x32_bf16 v[36:39], a[4:7], v[160:163], v[36:39]
  v_mfma_f32_16x16x32_bf16 v[68:71], a[4:7], v[164:167], v[68:71]
  s_add_u32 s54, s54, 8192
  s_and_b32 s54, s54, 32767
  v_add_u32 v211, s54, v209
  v_add_u32 v212, s54, v210
  s_add_u32 s56, s56, 8192
  s_add_u32 s58, s58, 8192
  s_and_b32 s58, s58, 32767
  s_add_u32 m0, s53, s51
  s_nop 0
  buffer_load_dwordx4 v208, s[32:35], s52 offen  lds
  v_mfma_f32_16x16x32_bf16 v[8:11], a[8:11], v[156:159], v[8:11]
  ds_read_b64_tr_b16 a[0:1], v211 offset:0
  ds_read_b64_tr_b16 a[2:3], v211 offset:512
  v_mfma_f32_16x16x32_bf16 v[40:43], a[8:11], v[160:163], v[40:43]
  s_add_u32 m0, m0, 896
  s_nop 0
  buffer_load_dwordx4 v208, s[32:35], s52 offen offset:128  lds
  v_mfma_f32_16x16x32_bf16 v[72:75], a[8:11], v[164:167], v[72:75]
  v_mfma_f32_16x16x32_bf16 v[12:15], a[12:15], v[156:159], v[12:15]
  ds_read_b64_tr_b16 a[4:5], v211 offset:8
  ds_read_b64_tr_b16 a[6:7], v211 offset:520
  s_add_u32 s52, s52, 262144
  s_and_b32 s52, s52, 4194303
  s_add_u32 s53, s53, 8192
  s_and_b32 s53, s53, 32767
  s_add_u32 m0, s76, s3
  s_add_u32 s72, s45, s55
  buffer_load_dwordx4 v213, s[20:23], s72 offen  lds
  v_mfma_f32_16x16x32_bf16 v[44:47], a[12:15], v[160:163], v[44:47]
  v_mfma_f32_16x16x32_bf16 v[76:79], a[12:15], v[164:167], v[76:79]
  s_add_u32 m0, m0, 1024
  s_add_u32 s72, s72, 8192
  buffer_load_dwordx4 v213, s[20:23], s72 offen  lds
  s_waitcnt lgkmcnt(8)
  v_mfma_f32_16x16x32_bf16 v[16:19], a[16:19], v[156:159], v[16:19]
  ds_read_b64_tr_b16 a[8:9], v212 offset:0
  ds_read_b64_tr_b16 a[10:11], v212 offset:512
  v_mfma_f32_16x16x32_bf16 v[48:51], a[16:19], v[160:163], v[48:51]
  s_add_u32 m0, s76, s100
  s_add_u32 s72, s46, s55
  buffer_load_dwordx4 v213, s[20:23], s72 offen  lds
  v_mfma_f32_16x16x32_bf16 v[80:83], a[16:19], v[164:167], v[80:83]
  v_mfma_f32_16x16x32_bf16 v[20:23], a[20:23], v[156:159], v[20:23]
  ds_read_b64_tr_b16 a[12:13], v212 offset:8
  ds_read_b64_tr_b16 a[14:15], v212 offset:520
  s_add_u32 m0, m0, 1024
  s_add_u32 s72, s72, 8192
  buffer_load_dwordx4 v213, s[20:23], s72 offen  lds
  v_mfma_f32_16x16x32_bf16 v[52:55], a[20:23], v[160:163], v[52:55]
  v_mfma_f32_16x16x32_bf16 v[84:87], a[20:23], v[164:167], v[84:87]
  s_xor_b32 s77, s77, 247808
  v_add_u32 v170, s77, v168
  v_add_u32 v171, s77, v169
  v_add_u32 v172, s78, v170
  v_add_u32 v173, s78, v171
  ds_read_b128 v[144:147], v170 offset:0
  ds_read_b128 v[148:151], v170 offset:2048
  ds_read_b128 v[152:155], v172 offset:0
  s_cmp_lt_u32 s42, 2
  s_cbranch_scc0 XL26
  s_add_u32 m0, s76, s101
  s_add_u32 s72, s47, s55
  buffer_load_dwordx4 v213, s[20:23], s72 offen  lds
XL26:
  s_add_u32 s55, s55, 128
  s_and_b32 s55, s55, 1023
  s_xor_b32 s76, s76, 247808
  s_waitcnt lgkmcnt(11)
  v_mfma_f32_16x16x32_bf16 v[24:27], a[24:27], v[156:159], v[24:27]
  ds_read_b64_tr_b16 a[16:17], v211 offset:1024
  ds_read_b64_tr_b16 a[18:19], v211 offset:1536
  v_mfma_f32_16x16x32_bf16 v[56:59], a[24:27], v[160:163], v[56:59]
  v_mfma_f32_16x16x32_bf16 v[88:91], a[24:27], v[164:167], v[88:91]
  v_mfma_f32_16x16x32_bf16 v[28:31], a[28:31], v[156:159], v[28:31]
  ds_read_b64_tr_b16 a[20:21], v211 offset:1032
  ds_read_b64_tr_b16 a[22:23], v211 offset:1544
  v_mfma_f32_16x16x32_bf16 v[60:63], a[28:31], v[160:163], v[60:63]
  v_mfma_f32_16x16x32_bf16 v[92:95], a[28:31], v[164:167], v[92:95]
  s_add_u32 s62, s62, 1
  s_cmp_lt_u32 s62, 6
  s_cbranch_scc1 K1T3b_qloop
  s_waitcnt vmcnt(10)
  s_barrier
  s_waitcnt lgkmcnt(6)
  v_mfma_f32_16x16x32_bf16 v[0:3], a[0:3], v[144:147], v[0:3]
  ds_read_b64_tr_b16 a[24:25], v212 offset:1024
  ds_read_b64_tr_b16 a[26:27], v212 offset:1536
  s_xor_b32 s72, s57, s70
  s_add_u32 m0, s59, s44
  s_nop 0
  buffer_load_dwordx4 v207, s[28:31], s72 offen nt lds
  s_waitcnt lgkmcnt(7)
  v_mfma_f32_16x16x32_bf16 v[32:35], a[0:3], v[148:151], v[32:35]
  s_waitcnt lgkmcnt(6)
  v_mfma_f32_16x16x32_bf16 v[64:67], a[0:3], v[152:155], v[64:67]
  v_mfma_f32_16x16x32_bf16 v[4:7], a[4:7], v[144:147], v[4:7]
  ds_read_b64_tr_b16 a[28:29], v212 offset:1032
  ds_read_b64_tr_b16 a[30:31], v212 offset:1544
  s_add_u32 m0, m0, 896
  s_nop 0
  buffer_load_dwordx4 v207, s[28:31], s72 offen offset:128 nt lds
  v_mfma_f32_16x16x32_bf16 v[36:39], a[4:7], v[148:151], v[36:39]
  v_mfma_f32_16x16x32_bf16 v[68:71], a[4:7], v[152:155], v[68:71]
  s_add_u32 s54, s54, 8192
  s_and_b32 s54, s54, 32767
  v_add_u32 v211, s54, v209
  v_add_u32 v212, s54, v210
  v_mfma_f32_16x16x32_bf16 v[8:11], a[8:11], v[144:147], v[8:11]
  ds_read_b64_tr_b16 a[0:1], v211 offset:0
  ds_read_b64_tr_b16 a[2:3], v211 offset:512
  s_add_u32 s57, s57, 8192
  s_add_u32 s59, s59, 8192
  s_cmp_eq_u32 s59, 49152
  s_cselect_b32 s59, 0, s59
  s_xor_b32 s72, s56, s70
  s_add_u32 m0, s58, s43
  s_nop 0
  buffer_load_dwordx4 v207, s[24:27], s72 offen nt lds
  v_mfma_f32_16x16x32_bf16 v[40:43], a[8:11], v[148:151], v[40:43]
  v_mfma_f32_16x16x32_bf16 v[72:75], a[8:11], v[152:155], v[72:75]
  v_mfma_f32_16x16x32_bf16 v[12:15], a[12:15], v[144:147], v[12:15]
  ds_read_b64_tr_b16 a[4:5], v211 offset:8
  ds_read_b64_tr_b16 a[6:7], v211 offset:520
  s_add_u32 m0, m0, 896
  s_nop 0
  buffer_load_dwordx4 v207, s[24:27], s72 offen offset:128 nt lds
  v_mfma_f32_16x16x32_bf16 v[44:47], a[12:15], v[148:151], v[44:47]
  v_mfma_f32_16x16x32_bf16 v[76:79], a[12:15], v[152:155], v[76:79]
  s_waitcnt lgkmcnt(8)
  v_mfma_f32_16x16x32_bf16 v[16:19], a[16:19], v[144:147], v[16:19]
  ds_read_b64_tr_b16 a[8:9], v212 offset:0
  ds_read_b64_tr_b16 a[10:11], v212 offset:512
  s_add_u32 s56, s56, 8192
  s_add_u32 s58, s58, 8192
  s_and_b32 s58, s58, 32767
  s_add_u32 m0, s53, s51
  s_nop 0
  buffer_load_dwordx4 v208, s[32:35], s52 offen  lds
  v_mfma_f32_16x16x32_bf16 v[48:51], a[16:19], v[148:151], v[48:51]
  v_mfma_f32_16x16x32_bf16 v[80:83], a[16:19], v[152:155], v[80:83]
  v_mfma_f32_16x16x32_bf16 v[20:23], a[20:23], v[144:147], v[20:23]
  ds_read_b64_tr_b16 a[12:13], v212 offset:8
  ds_read_b64_tr_b16 a[14:15], v212 offset:520
  s_add_u32 m0, m0, 896
  s_nop 0
  buffer_load_dwordx4 v208, s[32:35], s52 offen offset:128  lds
  s_add_u32 s52, s52, 262144
  s_and_b32 s52, s52, 4194303
  s_add_u32 s53, s53, 8192
  s_and_b32 s53, s53, 32767
  v_mfma_f32_16x16x32_bf16 v[52:55], a[20:23], v[148:151], v[52:55]
  v_mfma_f32_16x16x32_bf16 v[84:87], a[20:23], v[152:155], v[84:87]
  ds_read_b128 v[156:159], v171 offset:0
  ds_read_b128 v[160:163], v171 offset:2048
  ds_read_b128 v[164:167], v173 offset:0
  s_waitcnt lgkmcnt(11)
  v_mfma_f32_16x16x32_bf16 v[24:27], a[24:27], v[144:147], v[24:27]
  ds_read_b64_tr_b16 a[16:17], v211 offset:1024
  ds_read_b64_tr_b16 a[18:19], v211 offset:1536
  v_mfma_f32_16x16x32_bf16 v[56:59], a[24:27], v[148:151], v[56:59]
  v_mfma_f32_16x16x32_bf16 v[88:91], a[24:27], v[152:155], v[88:91]
  v_mfma_f32_16x16x32_bf16 v[28:31], a[28:31], v[144:147], v[28:31]
  ds_read_b64_tr_b16 a[20:21], v211 offset:1032
  ds_read_b64_tr_b16 a[22:23], v211 offset:1544
  v_mfma_f32_16x16x32_bf16 v[60:63], a[28:31], v[148:151], v[60:63]
  v_mfma_f32_16x16x32_bf16 v[92:95], a[28:31], v[152:155], v[92:95]
  s_waitcnt vmcnt(6)
  s_barrier
  s_waitcnt lgkmcnt(6)
  v_mfma_f32_16x16x32_bf16 v[0:3], a[0:3], v[156:159], v[0:3]
  ds_read_b64_tr_b16 a[24:25], v212 offset:1024
  ds_read_b64_tr_b16 a[26:27], v212 offset:1536
  s_xor_b32 s72, s57, s70
  s_add_u32 m0, s59, s44
  s_nop 0
  buffer_load_dwordx4 v207, s[28:31], s72 offen nt lds
  s_waitcnt lgkmcnt(7)
  v_mfma_f32_16x16x32_bf16 v[32:35], a[0:3], v[160:163], v[32:35]
  s_waitcnt lgkmcnt(6)
  v_mfma_f32_16x16x32_bf16 v[64:67], a[0:3], v[164:167], v[64:67]
  v_mfma_f32_16x16x32_bf16 v[4:7], a[4:7], v[156:159], v[4:7]
  ds_read_b64_tr_b16 a[28:29], v212 offset:1032
  ds_read_b64_tr_b16 a[30:31], v212 offset:1544
  v_mfma_f32_16x16x32_bf16 v[36:39], a[4:7], v[160:163], v[36:39]
  s_add_u32 m0, m0, 896
  s_nop 0
  buffer_load_dwordx4 v207, s[28:31], s72 offen offset:128 nt lds
  v_mfma_f32_16x16x32_bf16 v[68:71], a[4:7], v[164:167], v[68:71]
  s_add_u32 s54, s54, 8192
  s_and_b32 s54, s54, 32767
  v_add_u32 v211, s54, v209
  v_add_u32 v212, s54, v210
  v_mfma_f32_16x16x32_bf16 v[8:11], a[8:11], v[156:159], v[8:11]
  ds_read_b64_tr_b16 a[0:1], v211 offset:0
  ds_read_b64_tr_b16 a[2:3], v211 offset:512
  v_mfma_f32_16x16x32_bf16 v[40:43], a[8:11], v[160:163], v[40:43]
  v_mfma_f32_16x16x32_bf16 v[72:75], a[8:11], v[164:167], v[72:75]
  v_mfma_f32_16x16x32_bf16 v[12:15], a[12:15], v[156:159], v[12:15]
  ds_read_b64_tr_b16 a[4:5], v211 offset:8
  ds_read_b64_tr_b16 a[6:7], v211 offset:520
  s_add_u32 s57, s57, 8192
  s_add_u32 s59, s59, 8192
  s_cmp_eq_u32 s59, 49152
  s_cselect_b32 s59, 0, s59
  s_xor_b32 s72, s56, s70
  s_add_u32 m0, s58, s43
  s_nop 0
  buffer_load_dwordx4 v207, s[24:27], s72 offen nt lds
  v_mfma_f32_16x16x32_bf16 v[44:47], a[12:15], v[160:163], v[44:47]
  v_mfma_f32_16x16x32_bf16 v[76:79], a[12:15], v[164:167], v[76:79]
  s_waitcnt lgkmcnt(8)
  v_mfma_f32_16x16x32_bf16 v[16:19], a[16:19], v[156:159], v[16:19]
  ds_read_b64_tr_b16 a[8:9], v212 offset:0
  ds_read_b64_tr_b16 a[10:11], v212 offset:512
  v_mfma_f32_16x16x32_bf16 v[48:51], a[16:19], v[160:163], v[48:51]
  v_mfma_f32_16x16x32_bf16 v[80:83], a[16:19], v[164:167], v[80:83]
  s_add_u32 m0, m0, 896
  s_nop 0
  buffer_load_dwordx4 v207, s[24:27], s72 offen offset:128 nt lds
  s_add_u32 s56, s56, 8192
  s_add_u32 s58, s58, 8192
  s_and_b32 s58, s58, 32767
  v_mfma_f32_16x16x32_bf16 v[20:23], a[20:23], v[156:159], v[20:23]
  ds_read_b64_tr_b16 a[12:13], v212 offset:8
  ds_read_b64_tr_b16 a[14:15], v212 offset:520
  v_mfma_f32_16x16x32_bf16 v[52:55], a[20:23], v[160:163], v[52:55]
  v_mfma_f32_16x16x32_bf16 v[84:87], a[20:23], v[164:167], v[84:87]
  s_xor_b32 s77, s77, 247808
  v_add_u32 v170, s77, v168
  v_add_u32 v171, s77, v169
  v_add_u32 v172, s78, v170
  v_add_u32 v173, s78, v171
  ds_read_b128 v[144:147], v170 offset:0
  ds_read_b128 v[148:151], v170 offset:2048
  ds_read_b128 v[152:155], v172 offset:0
  s_waitcnt lgkmcnt(11)
  v_mfma_f32_16x16x32_bf16 v[24:27], a[24:27], v[156:159], v[24:27]
  ds_read_b64_tr_b16 a[16:17], v211 offset:1024
  ds_read_b64_tr_b16 a[18:19], v211 offset:1536
  v_mfma_f32_16x16x32_bf16 v[56:59], a[24:27], v[160:163], v[56:59]
  v_mfma_f32_16x16x32_bf16 v[88:91], a[24:27], v[164:167], v[88:91]
  v_mfma_f32_16x16x32_bf16 v[28:31], a[28:31], v[156:159], v[28:31]
  ds_read_b64_tr_b16 a[20:21], v211 offset:1032
  ds_read_b64_tr_b16 a[22:23], v211 offset:1544
  v_mfma_f32_16x16x32_bf16 v[60:63], a[28:31], v[160:163], v[60:63]
  v_mfma_f32_16x16x32_bf16 v[92:95], a[28:31], v[164:167], v[92:95]
  s_waitcnt vmcnt(4)
  s_barrier
  s_waitcnt lgkmcnt(6)
  v_mfma_f32_16x16x32_bf16 v[0:3], a[0:3], v[144:147], v[0:3]
  ds_read_b64_tr_b16 a[24:25], v212 offset:1024
  ds_read_b64_tr_b16 a[26:27], v212 offset:1536
  s_xor_b32 s72, s57, s70
  s_add_u32 m0, s59, s44
  s_nop 0
  buffer_load_dwordx4 v207, s[28:31], s72 offen nt lds
  s_waitcnt lgkmcnt(7)
  v_mfma_f32_16x16x32_bf16 v[32:35], a[0:3], v[148:151], v[32:35]
  s_waitcnt lgkmcnt(6)
  v_mfma_f32_16x16x32_bf16 v[64:67], a[0:3], v[152:155], v[64:67]
  v_mfma_f32_16x16x32_bf16 v[4:7], a[4:7], v[144:147], v[4:7]
  ds_read_b64_tr_b16 a[28:29], v212 offset:1032
  ds_read_b64_tr_b16 a[30:31], v212 offset:1544
  v_mfma_f32_16x16x32_bf16 v[36:39], a[4:7], v[148:151], v[36:39]
  s_add_u32 m0, m0, 896
  s_nop 0
  buffer_load_dwordx4 v207, s[28:31], s72 offen offset:128 nt lds
  v_mfma_f32_16x16x32_bf16 v[68:71], a[4:7], v[152:155], v[68:71]
  s_add_u32 s54, s54, 8192
  s_and_b32 s54, s54, 32767
  v_add_u32 v211, s54, v209
  v_add_u32 v212, s54, v210
  v_mfma_f32_16x16x32_bf16 v[8:11], a[8:11], v[144:147], v[8:11]
  ds_read_b64_tr_b16 a[0:1], v211 offset:0
  ds_read_b64_tr_b16 a[2:3], v211 offset:512
  v_mfma_f32_16x16x32_bf16 v[40:43], a[8:11], v[148:151], v[40:43]
  v_mfma_f32_16x16x32_bf16 v[72:75], a[8:11], v[152:155], v[72:75]
  v_mfma_f32_16x16x32_bf16 v[12:15], a[12:15], v[144:147], v[12:15]
  ds_read_b64_tr_b16 a[4:5], v211 offset:8
  ds_read_b64_tr_b16 a[6:7], v211 offset:520
  s_add_u32 s57, s57, 8192
  s_add_u32 s59, s59, 8192
  s_cmp_eq_u32 s59, 49152
  s_cselect_b32 s59, 0, s59
  s_xor_b32 s72, s56, s70
  s_add_u32 m0, s58, s43
  s_nop 0
  buffer_load_dwordx4 v207, s[24:27], s72 offen nt lds
  v_mfma_f32_16x16x32_bf16 v[44:47], a[12:15], v[148:151], v[44:47]
  v_mfma_f32_16x16x32_bf16 v[76:79], a[12:15], v[152:155], v[76:79]
  s_waitcnt lgkmcnt(8)
  v_mfma_f32_16x16x32_bf16 v[16:19], a[16:19], v[144:147], v[16:19]
  ds_read_b64_tr_b16 a[8:9], v212 offset:0
  ds_read_b64_tr_b16 a[10:11], v212 offset:512
  v_mfma_f32_16x16x32_bf16 v[48:51], a[16:19], v[148:151], v[48:51]
  v_mfma_f32_16x16x32_bf16 v[80:83], a[16:19], v[152:155], v[80:83]
  s_add_u32 m0, m0, 896
  s_nop 0
  buffer_load_dwordx4 v207, s[24:27], s72 offen offset:128 nt lds
  s_add_u32 s56, s56, 8192
  s_add_u32 s58, s58, 8192
  s_and_b32 s58, s58, 32767
  v_mfma_f32_16x16x32_bf16 v[20:23], a[20:23], v[144:147], v[20:23]
  ds_read_b64_tr_b16 a[12:13], v212 offset:8
  ds_read_b64_tr_b16 a[14:15], v212 offset:520
  v_mfma_f32_16x16x32_bf16 v[52:55], a[20:23], v[148:151], v[52:55]
  v_mfma_f32_16x16x32_bf16 v[84:87], a[20:23], v[152:155], v[84:87]
  ds_read_b128 v[156:159], v171 offset:0
  ds_read_b128 v[160:163], v171 offset:2048
  ds_read_b128 v[164:167], v173 offset:0
  s_waitcnt lgkmcnt(11)
  v_mfma_f32_16x16x32_bf16 v[24:27], a[24:27], v[144:147], v[24:27]
  ds_read_b64_tr_b16 a[16:17], v211 offset:1024
  ds_read_b64_tr_b16 a[18:19], v211 offset:1536
  v_mfma_f32_16x16x32_bf16 v[56:59], a[24:27], v[148:151], v[56:59]
  v_mfma_f32_16x16x32_bf16 v[88:91], a[24:27], v[152:155], v[88:91]
  v_mfma_f32_16x16x32_bf16 v[28:31], a[28:31], v[144:147], v[28:31]
  ds_read_b64_tr_b16 a[20:21], v211 offset:1032
  ds_read_b64_tr_b16 a[22:23], v211 offset:1544
  v_mfma_f32_16x16x32_bf16 v[60:63], a[28:31], v[148:151], v[60:63]
  v_mfma_f32_16x16x32_bf16 v[92:95], a[28:31], v[152:155], v[92:95]
  s_barrier
  s_waitcnt lgkmcnt(6)
  v_mfma_f32_16x16x32_bf16 v[0:3], a[0:3], v[156:159], v[0:3]
  ds_read_b64_tr_b16 a[24:25], v212 offset:1024
  ds_read_b64_tr_b16 a[26:27], v212 offset:1536
  s_xor_b32 s72, s56, s70
  s_add_u32 m0, s58, s43
  s_nop 0
  buffer_load_dwordx4 v207, s[24:27], s72 offen nt lds
  s_waitcnt lgkmcnt(7)
  v_mfma_f32_16x16x32_bf16 v[32:35], a[0:3], v[160:163], v[32:35]
  s_waitcnt lgkmcnt(6)
  v_mfma_f32_16x16x32_bf16 v[64:67], a[0:3], v[164:167], v[64:67]
  v_mfma_f32_16x16x32_bf16 v[4:7], a[4:7], v[156:159], v[4:7]
  ds_read_b64_tr_b16 a[28:29], v212 offset:1032
  ds_read_b64_tr_b16 a[30:31], v212 offset:1544
  v_mfma_f32_16x16x32_bf16 v[36:39], a[4:7], v[160:163], v[36:39]
  v_mfma_f32_16x16x32_bf16 v[68:71], a[4:7], v[164:167], v[68:71]
  v_mfma_f32_16x16x32_bf16 v[8:11], a[8:11], v[156:159], v[8:11]
  v_mfma_f32_16x16x32_bf16 v[40:43], a[8:11], v[160:163], v[40:43]
  v_mfma_f32_16x16x32_bf16 v[72:75], a[8:11], v[164:167], v[72:75]
  v_mfma_f32_16x16x32_bf16 v[12:15], a[12:15], v[156:159], v[12:15]
  s_add_u32 m0, m0, 896
  s_nop 0
  buffer_load_dwordx4 v207, s[24:27], s72 offen offset:128 nt lds
  s_add_u32 s56, s56, 8192
  s_add_u32 s58, s58, 8192
  s_and_b32 s58, s58, 32767
  v_mfma_f32_16x16x32_bf16 v[44:47], a[12:15], v[160:163], v[44:47]
  v_mfma_f32_16x16x32_bf16 v[76:79], a[12:15], v[164:167], v[76:79]
  s_waitcnt lgkmcnt(4)
  v_mfma_f32_16x16x32_bf16 v[16:19], a[16:19], v[156:159], v[16:19]
  v_mfma_f32_16x16x32_bf16 v[48:51], a[16:19], v[160:163], v[48:51]
  v_mfma_f32_16x16x32_bf16 v[80:83], a[16:19], v[164:167], v[80:83]
  v_mfma_f32_16x16x32_bf16 v[20:23], a[20:23], v[156:159], v[20:23]
  v_mfma_f32_16x16x32_bf16 v[52:55], a[20:23], v[160:163], v[52:55]
  v_mfma_f32_16x16x32_bf16 v[84:87], a[20:23], v[164:167], v[84:87]
  s_waitcnt lgkmcnt(0)
  v_mfma_f32_16x16x32_bf16 v[24:27], a[24:27], v[156:159], v[24:27]
  v_mfma_f32_16x16x32_bf16 v[56:59], a[24:27], v[160:163], v[56:59]
  v_mfma_f32_16x16x32_bf16 v[88:91], a[24:27], v[164:167], v[88:91]
  v_mfma_f32_16x16x32_bf16 v[28:31], a[28:31], v[156:159], v[28:31]
  v_mfma_f32_16x16x32_bf16 v[60:63], a[28:31], v[160:163], v[60:63]
  v_mfma_f32_16x16x32_bf16 v[92:95], a[28:31], v[164:167], v[92:95]
  s_barrier
  s_nop 7
  v_mul_f32 v0, s64, v0
  v_mul_f32 v1, s64, v1
  v_mul_f32 v2, s64, v2
  v_mul_f32 v3, s64, v3
  v_mul_f32 v4, s64, v4
  v_mul_f32 v5, s64, v5
  v_mul_f32 v6, s64, v6
  v_mul_f32 v7, s64, v7
  v_cvt_pk_bf16_f32 v96, v0, v1
  v_cvt_pk_bf16_f32 v97, v2, v3
  v_cvt_pk_bf16_f32 v98, v4, v5
  v_cvt_pk_bf16_f32 v99, v6, v7
  v_mul_f32 v8, s64, v8
  v_mul_f32 v9, s64, v9
  v_mul_f32 v10, s64, v10
  v_mul_f32 v11, s64, v11
  v_mul_f32 v12, s64, v12
  v_mul_f32 v13, s64, v13
  v_mul_f32 v14, s64, v14
  v_mul_f32 v15, s64, v15
  v_cvt_pk_bf16_f32 v100, v8, v9
  v_cvt_pk_bf16_f32 v101, v10, v11
  v_cvt_pk_bf16_f32 v102, v12, v13
  v_cvt_pk_bf16_f32 v103, v14, v15
  v_mul_f32 v16, s64, v16
  v_mul_f32 v17, s64, v17
  v_mul_f32 v18, s64, v18
  v_mul_f32 v19, s64, v19
  v_mul_f32 v20, s64, v20
  v_mul_f32 v21, s64, v21
  v_mul_f32 v22, s64, v22
  v_mul_f32 v23, s64, v23
  v_cvt_pk_bf16_f32 v104, v16, v17
  v_cvt_pk_bf16_f32 v105, v18, v19
  v_cvt_pk_bf16_f32 v106, v20, v21
  v_cvt_pk_bf16_f32 v107, v22, v23
  v_mul_f32 v24, s64, v24
  v_mul_f32 v25, s64, v25
  v_mul_f32 v26, s64, v26
  v_mul_f32 v27, s64, v27
  v_mul_f32 v28, s64, v28
  v_mul_f32 v29, s64, v29
  v_mul_f32 v30, s64, v30
  v_mul_f32 v31, s64, v31
  v_cvt_pk_bf16_f32 v108, v24, v25
  v_cvt_pk_bf16_f32 v109, v26, v27
  v_cvt_pk_bf16_f32 v110, v28, v29
  v_cvt_pk_bf16_f32 v111, v30, v31
  v_mul_f32 v32, s64, v32
  v_mul_f32 v33, s64, v33
  v_mul_f32 v34, s64, v34
  v_mul_f32 v35, s64, v35
  v_mul_f32 v36, s64, v36
  v_mul_f32 v37, s64, v37
  v_mul_f32 v38, s64, v38
  v_mul_f32 v39, s64, v39
  v_cvt_pk_bf16_f32 v112, v32, v33
  v_cvt_pk_bf16_f32 v113, v34, v35
  v_cvt_pk_bf16_f32 v114, v36, v37
  v_cvt_pk_bf16_f32 v115, v38, v39
  v_mul_f32 v40, s64, v40
  v_mul_f32 v41, s64, v41
  v_mul_f32 v42, s64, v42
  v_mul_f32 v43, s64, v43
  v_mul_f32 v44, s64, v44
  v_mul_f32 v45, s64, v45
  v_mul_f32 v46, s64, v46
  v_mul_f32 v47, s64, v47
  v_cvt_pk_bf16_f32 v116, v40, v41
  v_cvt_pk_bf16_f32 v117, v42, v43
  v_cvt_pk_bf16_f32 v118, v44, v45
  v_cvt_pk_bf16_f32 v119, v46, v47
  v_mul_f32 v48, s64, v48
  v_mul_f32 v49, s64, v49
  v_mul_f32 v50, s64, v50
  v_mul_f32 v51, s64, v51
  v_mul_f32 v52, s64, v52
  v_mul_f32 v53, s64, v53
  v_mul_f32 v54, s64, v54
  v_mul_f32 v55, s64, v55
  v_cvt_pk_bf16_f32 v120, v48, v49
  v_cvt_pk_bf16_f32 v121, v50, v51
  v_cvt_pk_bf16_f32 v122, v52, v53
  v_cvt_pk_bf16_f32 v123, v54, v55
  v_mul_f32 v56, s64, v56
  v_mul_f32 v57, s64, v57
  v_mul_f32 v58, s64, v58
  v_mul_f32 v59, s64, v59
  v_mul_f32 v60, s64, v60
  v_mul_f32 v61, s64, v61
  v_mul_f32 v62, s64, v62
  v_mul_f32 v63, s64, v63
  v_cvt_pk_bf16_f32 v124, v56, v57
  v_cvt_pk_bf16_f32 v125, v58, v59
  v_cvt_pk_bf16_f32 v126, v60, v61
  v_cvt_pk_bf16_f32 v127, v62, v63
  v_mul_f32 v64, s64, v64
  v_mul_f32 v65, s64, v65
  v_mul_f32 v66, s64, v66
  v_mul_f32 v67, s64, v67
  v_mul_f32 v68, s64, v68
  v_mul_f32 v69, s64, v69
  v_mul_f32 v70, s64, v70
  v_mul_f32 v71, s64, v71
  v_cvt_pk_bf16_f32 v128, v64, v65
  v_cvt_pk_bf16_f32 v129, v66, v67
  v_cvt_pk_bf16_f32 v130, v68, v69
  v_cvt_pk_bf16_f32 v131, v70, v71
  v_mul_f32 v72, s64, v72
  v_mul_f32 v73, s64, v73
  v_mul_f32 v74, s64, v74
  v_mul_f32 v75, s64, v75
  v_mul_f32 v76, s64, v76
  v_mul_f32 v77, s64, v77
  v_mul_f32 v78, s64, v78
  v_mul_f32 v79, s64, v79
  v_cvt_pk_bf16_f32 v132, v72, v73
  v_cvt_pk_bf16_f32 v133, v74, v75
  v_cvt_pk_bf16_f32 v134, v76, v77
  v_cvt_pk_bf16_f32 v135, v78, v79
  v_mul_f32 v80, s64, v80
  v_mul_f32 v81, s64, v81
  v_mul_f32 v82, s64, v82
  v_mul_f32 v83, s64, v83
  v_mul_f32 v84, s64, v84
  v_mul_f32 v85, s64, v85
  v_mul_f32 v86, s64, v86
  v_mul_f32 v87, s64, v87
  v_cvt_pk_bf16_f32 v136, v80, v81
  v_cvt_pk_bf16_f32 v137, v82, v83
  v_cvt_pk_bf16_f32 v138, v84, v85
  v_cvt_pk_bf16_f32 v139, v86, v87
  v_mul_f32 v88, s64, v88
  v_mul_f32 v89, s64, v89
  v_mul_f32 v90, s64, v90
  v_mul_f32 v91, s64, v91
  v_mul_f32 v92, s64, v92
  v_mul_f32 v93, s64, v93
  v_mul_f32 v94, s64, v94
  v_mul_f32 v95, s64, v95
  v_cvt_pk_bf16_f32 v140, v88, v89
  v_cvt_pk_bf16_f32 v141, v90, v91
  v_cvt_pk_bf16_f32 v142, v92, v93
  v_cvt_pk_bf16_f32 v143, v94, v95
K1T3_mid:
  s_setprio 1
  s_waitcnt vmcnt(6)
  s_barrier
  v_mov_b32 v215, 151552
  ds_read_b32 v216, v215
  ds_read_b128 a[0:3], v197 offset:0
  ds_read_b128 a[4:7], v198 offset:0
  ds_read_b128 a[8:11], v197 offset:1024
  ds_read_b128 a[12:15], v198 offset:1024
  ds_read_b128 a[16:19], v197 offset:4096
  ds_read_b128 a[20:23], v198 offset:4096
  s_waitcnt lgkmcnt(6)
  v_readfirstlane_b32 s63, v216
  s_cmp_eq_u32 s63, 0
  s_cbranch_scc1 K1T3_hA_ok
  s_mov_b32 s63, 0
K1T3_hA_loop:
  s_barrier
  s_add_u32 s63, s63, 1
  s_cmp_lt_u32 s63, 64
  s_cbranch_scc1 K1T3_hA_loop
K1T3_hA_ok:
  s_waitcnt lgkmcnt(4)
  v_mfma_f32_16x16x32_bf16 v[144:147], a[0:3], v[96:99], 0
  ds_read_b128 a[24:27], v197 offset:5120
  v_mov_b64 v[0:1], 0
  v_mov_b64 v[2:3], 0
  v_mfma_f32_16x16x32_bf16 v[152:155], a[0:3], v[112:115], 0
  v_mov_b64 v[4:5], 0
  v_mov_b64 v[6:7], 0
  v_mfma_f32_16x16x32_bf16 v[160:163], a[0:3], v[128:131], 0
  v_mov_b64 v[8:9], 0
  v_mov_b64 v[10:11], 0
  v_mfma_f32_16x16x32_bf16 v[144:147], a[4:7], v[100:103], v[144:147]
  ds_read_b128 a[28:31], v198 offset:5120
  v_mov_b64 v[12:13], 0
  v_mov_b64 v[14:15], 0
  v_mov_b64 v[16:17], 0
  v_mfma_f32_16x16x32_bf16 v[152:155], a[4:7], v[116:119], v[152:155]
  v_mov_b64 v[18:19], 0
  v_mov_b64 v[20:21], 0
  v_mfma_f32_16x16x32_bf16 v[160:163], a[4:7], v[132:135], v[160:163]
  v_mov_b64 v[22:23], 0
  v_mov_b64 v[24:25], 0
  s_waitcnt lgkmcnt(4)
  v_mfma_f32_16x16x32_bf16 v[144:147], a[8:11], v[104:107], v[144:147]
  ds_read_b128 a[0:3], v197 offset:8192
  v_mov_b64 v[26:27], 0
  v_mov_b64 v[28:29], 0
  v_mfma_f32_16x16x32_bf16 v[152:155], a[8:11], v[120:123], v[152:155]
  v_mov_b64 v[30:31], 0
  v_mov_b64 v[32:33], 0
  v_mfma_f32_16x16x32_bf16 v[160:163], a[8:11], v[136:139], v[160:163]
  v_mov_b64 v[34:35], 0
  v_mov_b64 v[36:37], 0
  v_mfma_f32_16x16x32_bf16 v[144:147], a[12:15], v[108:111], v[144:147]
  ds_read_b128 a[4:7], v198 offset:8192
  v_mov_b64 v[38:39], 0
  v_mov_b64 v[40:41], 0
  v_mfma_f32_16x16x32_bf16 v[152:155], a[12:15], v[124:127], v[152:155]
  v_mov_b64 v[42:43], 0
  v_mov_b64 v[44:45], 0
  v_mfma_f32_16x16x32_bf16 v[160:163], a[12:15], v[140:143], v[160:163]
  v_mov_b64 v[46:47], 0
  v_mov_b64 v[48:49], 0
  v_mov_b64 v[50:51], 0
  s_waitcnt lgkmcnt(4)
  v_mfma_f32_16x16x32_bf16 v[148:151], a[16:19], v[96:99], 0
  ds_read_b128 a[8:11], v197 offset:9216
  v_mov_b64 v[52:53], 0
  v_mov_b64 v[54:55], 0
  v_mfma_f32_16x16x32_bf16 v[156:159], a[16:19], v[112:115], 0
  v_mov_b64 v[56:57], 0
  v_mov_b64 v[58:59], 0
  v_mfma_f32_16x16x32_bf16 v[164:167], a[16:19], v[128:131], 0
  v_mov_b64 v[60:61], 0
  v_mov_b64 v[62:63], 0
  v_mfma_f32_16x16x32_bf16 v[148:151], a[20:23], v[100:103], v[148:151]
  ds_read_b128 a[12:15], v198 offset:9216
  v_mov_b64 v[64:65], 0
  v_mov_b64 v[66:67], 0
  v_mfma_f32_16x16x32_bf16 v[156:159], a[20:23], v[116:119], v[156:159]
  v_mov_b64 v[68:69], 0
  v_mov_b64 v[70:71], 0
  v_mfma_f32_16x16x32_bf16 v[164:167], a[20:23], v[132:135], v[164:167]
  v_mov_b64 v[72:73], 0
  v_mov_b64 v[74:75], 0
  s_waitcnt lgkmcnt(4)
  v_mfma_f32_16x16x32_bf16 v[148:151], a[24:27], v[104:107], v[148:151]
  ds_read_b128 a[16:19], v197 offset:12288
  v_mov_b64 v[76:77], 0
  v_mov_b64 v[78:79], 0
  v_mfma_f32_16x16x32_bf16 v[156:159], a[24:27], v[120:123], v[156:159]
  v_mov_b64 v[80:81], 0
  v_mov_b64 v[82:83], 0
  v_mov_b64 v[84:85], 0
  v_mfma_f32_16x16x32_bf16 v[164:167], a[24:27], v[136:139], v[164:167]
  v_mov_b64 v[86:87], 0
  v_mov_b64 v[88:89], 0
  v_mfma_f32_16x16x32_bf16 v[148:151], a[28:31], v[108:111], v[148:151]
  ds_read_b128 a[20:23], v198 offset:12288
  v_mov_b64 v[90:91], 0
  v_mov_b64 v[92:93], 0
  v_mfma_f32_16x16x32_bf16 v[156:159], a[28:31], v[124:127], v[156:159]
  v_mov_b64 v[94:95], 0
  v_mov_b32 v192, 0
  v_mfma_f32_16x16x32_bf16 v[164:167], a[28:31], v[140:143], v[164:167]
  v_mov_b32 v193, 0
  v_mov_b32 v194, 0
  s_barrier
  s_waitcnt lgkmcnt(4)
  v_mfma_f32_16x16x32_bf16 v[168:171], a[0:3], v[96:99], 0
  ds_read_b128 a[24:27], v197 offset:13312
  v_exp_f32 v144, v144
  v_exp_f32 v145, v145
  v_mfma_f32_16x16x32_bf16 v[176:179], a[0:3], v[112:115], 0
  v_add_f32 v192, v192, v144
  v_exp_f32 v146, v146
  v_mfma_f32_16x16x32_bf16 v[184:187], a[0:3], v[128:131], 0
  v_add_f32 v192, v192, v145
  v_cvt_pk_bf16_f32 v144, v144, v145
  v_exp_f32 v147, v147
  v_mfma_f32_16x16x32_bf16 v[168:171], a[4:7], v[100:103], v[168:171]
  ds_read_b128 a[28:31], v198 offset:13312
  v_add_f32 v192, v192, v146
  v_exp_f32 v148, v148
  v_mfma_f32_16x16x32_bf16 v[176:179], a[4:7], v[116:119], v[176:179]
  v_add_f32 v192, v192, v147
  v_cvt_pk_bf16_f32 v145, v146, v147
  v_exp_f32 v149, v149
  v_mfma_f32_16x16x32_bf16 v[184:187], a[4:7], v[132:135], v[184:187]
  v_add_f32 v192, v192, v148
  v_exp_f32 v150, v150
  s_waitcnt lgkmcnt(4)
  v_mfma_f32_16x16x32_bf16 v[168:171], a[8:11], v[104:107], v[168:171]
  ds_read_b64_tr_b16 a[0:1], v203 offset:0
  ds_read_b64_tr_b16 a[2:3], v203 offset:4096
  v_add_f32 v192, v192, v149
  v_cvt_pk_bf16_f32 v146, v148, v149
  v_exp_f32 v151, v151
  v_mfma_f32_16x16x32_bf16 v[176:179], a[8:11], v[120:123], v[176:179]
  v_add_f32 v192, v192, v150
  v_add_f32 v192, v192, v151
  v_cvt_pk_bf16_f32 v147, v150, v151
  v_mfma_f32_16x16x32_bf16 v[184:187], a[8:11], v[136:139], v[184:187]
  v_xor_b32 v197, 16384, v197
  v_xor_b32 v198, 16384, v198
  v_exp_f32 v152, v152
  v_exp_f32 v153, v153
  v_mfma_f32_16x16x32_bf16 v[168:171], a[12:15], v[108:111], v[168:171]
  ds_read_b64_tr_b16 a[4:5], v204 offset:0
  ds_read_b64_tr_b16 a[6:7], v204 offset:4096
  v_add_f32 v193, v193, v152
  v_exp_f32 v154, v154
  v_mfma_f32_16x16x32_bf16 v[176:179], a[12:15], v[124:127], v[176:179]
  v_add_f32 v193, v193, v153
  v_cvt_pk_bf16_f32 v152, v152, v153
  v_exp_f32 v155, v155
  v_mfma_f32_16x16x32_bf16 v[184:187], a[12:15], v[140:143], v[184:187]
  v_add_f32 v193, v193, v154
  v_exp_f32 v156, v156
  s_waitcnt lgkmcnt(6)
  v_mfma_f32_16x16x32_bf16 v[172:175], a[16:19], v[96:99], 0
  ds_read_b64_tr_b16 a[8:9], v205 offset:0
  ds_read_b64_tr_b16 a[10:11], v205 offset:4096
  v_add_f32 v193, v193, v155
  v_cvt_pk_bf16_f32 v153, v154, v155
  v_exp_f32 v157, v157
  v_mfma_f32_16x16x32_bf16 v[180:183], a[16:19], v[112:115], 0
  v_add_f32 v193, v193, v156
  v_exp_f32 v158, v158
  v_mfma_f32_16x16x32_bf16 v[188:191], a[16:19], v[128:131], 0
  v_add_f32 v193, v193, v157
  v_cvt_pk_bf16_f32 v154, v156, v157
  v_exp_f32 v159, v159
  v_mfma_f32_16x16x32_bf16 v[172:175], a[20:23], v[100:103], v[172:175]
  ds_read_b64_tr_b16 a[12:13], v206 offset:0
  ds_read_b64_tr_b16 a[14:15], v206 offset:4096
  v_add_f32 v193, v193, v158
  v_add_f32 v193, v193, v159
  v_cvt_pk_bf16_f32 v155, v158, v159
  v_mfma_f32_16x16x32_bf16 v[180:183], a[20:23], v[116:119], v[180:183]
  v_exp_f32 v160, v160
  v_exp_f32 v161, v161
  v_mfma_f32_16x16x32_bf16 v[188:191], a[20:23], v[132:135], v[188:191]
  v_add_f32 v194, v194, v160
  v_exp_f32 v162, v162
  s_waitcnt lgkmcnt(8)
  v_mfma_f32_16x16x32_bf16 v[172:175], a[24:27], v[104:107], v[172:175]
  ds_read_b64_tr_b16 a[16:17], v203 offset:1024
  ds_read_b64_tr_b16 a[18:19], v203 offset:5120
  v_add_f32 v194, v194, v161
  v_cvt_pk_bf16_f32 v160, v160, v161
  v_exp_f32 v163, v163
  v_mfma_f32_16x16x32_bf16 v[180:183], a[24:27], v[120:123], v[180:183]
  v_add_f32 v194, v194, v162
  v_exp_f32 v164, v164
  v_mfma_f32_16x16x32_bf16 v[188:191], a[24:27], v[136:139], v[188:191]
  v_add_f32 v194, v194, v163
  v_cvt_pk_bf16_f32 v161, v162, v163
  v_exp_f32 v165, v165
  v_mfma_f32_16x16x32_bf16 v[172:175], a[28:31], v[108:111], v[172:175]
  ds_read_b64_tr_b16 a[20:21], v204 offset:1024
  ds_read_b64_tr_b16 a[22:23], v204 offset:5120
  v_add_f32 v194, v194, v164
  v_exp_f32 v166, v166
  v_mfma_f32_16x16x32_bf16 v[180:183], a[28:31], v[124:127], v[180:183]
  v_add_f32 v194, v194, v165
  v_cvt_pk_bf16_f32 v162, v164, v165
  v_exp_f32 v167, v167
  v_mfma_f32_16x16x32_bf16 v[188:191], a[28:31], v[140:143], v[188:191]
  v_add_f32 v194, v194, v166
  v_add_f32 v194, v194, v167
  v_cvt_pk_bf16_f32 v163, v166, v167
  s_mov_b32 s62, 0
K1T3_attloop:
  s_waitcnt vmcnt(2)
  s_barrier
  s_waitcnt lgkmcnt(8)
  v_mfma_f32_16x16x32_bf16 v[0:3], a[0:3], v[144:147], v[0:3]
  ds_read_b64_tr_b16 a[24:25], v205 offset:1024
  ds_read_b64_tr_b16 a[26:27], v205 offset:5120
  v_exp_f32 v168, v168
  v_mfma_f32_16x16x32_bf16 v[32:35], a[0:3], v[152:155], v[32:35]
  v_exp_f32 v169, v169
  v_mfma_f32_16x16x32_bf16 v[64:67], a[0:3], v[160:163], v[64:67]
  v_add_f32 v192, v192, v168
  v_mfma_f32_16x16x32_bf16 v[4:7], a[4:7], v[144:147], v[4:7]
  ds_read_b64_tr_b16 a[28:29], v206 offset:1024
  ds_read_b64_tr_b16 a[30:31], v206 offset:5120
  v_exp_f32 v170, v170
  v_mfma_f32_16x16x32_bf16 v[36:39], a[4:7], v[152:155], v[36:39]
  v_add_f32 v192, v192, v169
  v_cvt_pk_bf16_f32 v168, v168, v169
  v_mfma_f32_16x16x32_bf16 v[68:71], a[4:7], v[160:163], v[68:71]
  v_exp_f32 v171, v171
  s_waitcnt lgkmcnt(8)
  v_mfma_f32_16x16x32_bf16 v[8:11], a[8:11], v[144:147], v[8:11]
  ds_read_b128 a[0:3], v197 offset:0
  v_add_f32 v192, v192, v170
  v_mfma_f32_16x16x32_bf16 v[40:43], a[8:11], v[152:155], v[40:43]
  v_exp_f32 v172, v172
  v_mfma_f32_16x16x32_bf16 v[72:75], a[8:11], v[160:163], v[72:75]
  v_add_f32 v192, v192, v171
  v_cvt_pk_bf16_f32 v169, v170, v171
  v_mfma_f32_16x16x32_bf16 v[12:15], a[12:15], v[144:147], v[12:15]
  ds_read_b128 a[4:7], v198 offset:0
  v_exp_f32 v173, v173
  v_mfma_f32_16x16x32_bf16 v[44:47], a[12:15], v[152:155], v[44:47]
  v_add_f32 v192, v192, v172
  v_mfma_f32_16x16x32_bf16 v[76:79], a[12:15], v[160:163], v[76:79]
  v_exp_f32 v174, v174
  s_waitcnt lgkmcnt(6)
  v_mfma_f32_16x16x32_bf16 v[16:19], a[16:19], v[144:147], v[16:19]
  ds_read_b128 a[8:11], v197 offset:1024
  v_add_f32 v192, v192, v173
  v_cvt_pk_bf16_f32 v170, v172, v173
  v_mfma_f32_16x16x32_bf16 v[48:51], a[16:19], v[152:155], v[48:51]
  v_exp_f32 v175, v175
  v_mfma_f32_16x16x32_bf16 v[80:83], a[16:19], v[160:163], v[80:83]
  v_add_f32 v192, v192, v174
  v_mfma_f32_16x16x32_bf16 v[20:23], a[20:23], v[144:147], v[20:23]
  ds_read_b128 a[12:15], v198 offset:1024
  v_add_f32 v192, v192, v175
  v_cvt_pk_bf16_f32 v171, v174, v175
  v_mfma_f32_16x16x32_bf16 v[52:55], a[20:23], v[152:155], v[52:55]
  v_exp_f32 v176, v176
  v_mfma_f32_16x16x32_bf16 v[84:87], a[20:23], v[160:163], v[84:87]
  v_exp_f32 v177, v177
  s_waitcnt lgkmcnt(4)
  v_mfma_f32_16x16x32_bf16 v[24:27], a[24:27], v[144:147], v[24:27]
  ds_read_b128 a[16:19], v197 offset:4096
  v_add_f32 v193, v193, v176
  v_mfma_f32_16x16x32_bf16 v[56:59], a[24:27], v[152:155], v[56:59]
  v_exp_f32 v178, v178
  v_mfma_f32_16x16x32_bf16 v[88:91], a[24:27], v[160:163], v[88:91]
  v_add_f32 v193, v193, v177
  v_cvt_pk_bf16_f32 v176, v176, v177
  v_mfma_f32_16x16x32_bf16 v[28:31], a[28:31], v[144:147], v[28:31]
  ds_read_b128 a[20:23], v198 offset:4096
  v_exp_f32 v179, v179
  v_mfma_f32_16x16x32_bf16 v[60:63], a[28:31], v[152:155], v[60:63]
  v_add_f32 v193, v193, v178
  v_mfma_f32_16x16x32_bf16 v[92:95], a[28:31], v[160:163], v[92:95]
  v_exp_f32 v180, v180
  s_waitcnt lgkmcnt(4)
  v_mfma_f32_16x16x32_bf16 v[144:147], a[0:3], v[96:99], 0
  ds_read_b128 a[24:27], v197 offset:5120
  v_add_f32 v193, v193, v179
  v_cvt_pk_bf16_f32 v177, v178, v179
  v_mfma_f32_16x16x32_bf16 v[152:155], a[0:3], v[112:115], 0
  v_exp_f32 v181, v181
  v_mfma_f32_16x16x32_bf16 v[160:163], a[0:3], v[128:131], 0
  v_add_f32 v193, v193, v180
  v_mfma_f32_16x16x32_bf16 v[144:147], a[4:7], v[100:103], v[144:147]
  ds_read_b128 a[28:31], v198 offset:5120
  v_exp_f32 v182, v182
  v_mfma_f32_16x16x32_bf16 v[152:155], a[4:7], v[116:119], v[152:155]
  v_add_f32 v193, v193, v181
  v_cvt_pk_bf16_f32 v178, v180, v181
  v_mfma_f32_16x16x32_bf16 v[160:163], a[4:7], v[132:135], v[160:163]
  v_exp_f32 v183, v183
  s_waitcnt lgkmcnt(4)
  v_mfma_f32_16x16x32_bf16 v[144:147], a[8:11], v[104:107], v[144:147]
  ds_read_b64_tr_b16 a[0:1], v203 offset:8192
  ds_read_b64_tr_b16 a[2:3], v203 offset:12288
  v_add_f32 v193, v193, v182
  v_mfma_f32_16x16x32_bf16 v[152:155], a[8:11], v[120:123], v[152:155]
  v_add_f32 v193, v193, v183
  v_cvt_pk_bf16_f32 v179, v182, v183
  v_mfma_f32_16x16x32_bf16 v[160:163], a[8:11], v[136:139], v[160:163]
  v_exp_f32 v184, v184
  v_mfma_f32_16x16x32_bf16 v[144:147], a[12:15], v[108:111], v[144:147]
  ds_read_b64_tr_b16 a[4:5], v204 offset:8192
  ds_read_b64_tr_b16 a[6:7], v204 offset:12288
  v_exp_f32 v185, v185
  v_mfma_f32_16x16x32_bf16 v[152:155], a[12:15], v[124:127], v[152:155]
  v_add_f32 v194, v194, v184
  v_mfma_f32_16x16x32_bf16 v[160:163], a[12:15], v[140:143], v[160:163]
  v_exp_f32 v186, v186
  s_waitcnt lgkmcnt(6)
  v_mfma_f32_16x16x32_bf16 v[148:151], a[16:19], v[96:99], 0
  ds_read_b64_tr_b16 a[8:9], v205 offset:8192
  ds_read_b64_tr_b16 a[10:11], v205 offset:12288
  v_add_f32 v194, v194, v185
  v_cvt_pk_bf16_f32 v184, v184, v185
  v_mfma_f32_16x16x32_bf16 v[156:159], a[16:19], v[112:115], 0
  v_exp_f32 v187, v187
  v_mfma_f32_16x16x32_bf16 v[164:167], a[16:19], v[128:131], 0
  v_add_f32 v194, v194, v186
  v_mfma_f32_16x16x32_bf16 v[148:151], a[20:23], v[100:103], v[148:151]
  ds_read_b64_tr_b16 a[12:13], v206 offset:8192
  ds_read_b64_tr_b16 a[14:15], v206 offset:12288
  v_exp_f32 v188, v188
  v_mfma_f32_16x16x32_bf16 v[156:159], a[20:23], v[116:119], v[156:159]
  v_add_f32 v194, v194, v187
  v_cvt_pk_bf16_f32 v185, v186, v187
  v_mfma_f32_16x16x32_bf16 v[164:167], a[20:23], v[132:135], v[164:167]
  v_exp_f32 v189, v189
  s_waitcnt lgkmcnt(8)
  v_mfma_f32_16x16x32_bf16 v[148:151], a[24:27], v[104:107], v[148:151]
  ds_read_b64_tr_b16 a[16:17], v203 offset:9216
  ds_read_b64_tr_b16 a[18:19], v203 offset:13312
  v_add_f32 v194, v194, v188
  v_mfma_f32_16x16x32_bf16 v[156:159], a[24:27], v[120:123], v[156:159]
  v_exp_f32 v190, v190
  v_mfma_f32_16x16x32_bf16 v[164:167], a[24:27], v[136:139], v[164:167]
  v_add_f32 v194, v194, v189
  v_cvt_pk_bf16_f32 v186, v188, v189
  v_mfma_f32_16x16x32_bf16 v[148:151], a[28:31], v[108:111], v[148:151]
  ds_read_b64_tr_b16 a[20:21], v204 offset:9216
  ds_read_b64_tr_b16 a[22:23], v204 offset:13312
  v_exp_f32 v191, v191
  v_mfma_f32_16x16x32_bf16 v[156:159], a[28:31], v[124:127], v[156:159]
  v_add_f32 v194, v194, v190
  v_mfma_f32_16x16x32_bf16 v[164:167], a[28:31], v[140:143], v[164:167]
  v_add_f32 v194, v194, v191
  v_cvt_pk_bf16_f32 v187, v190, v191
  s_waitcnt vmcnt(0)
  s_barrier
  s_waitcnt lgkmcnt(8)
  v_mfma_f32_16x16x32_bf16 v[0:3], a[0:3], v[168:171], v[0:3]
  ds_read_b64_tr_b16 a[24:25], v205 offset:9216
  ds_read_b64_tr_b16 a[26:27], v205 offset:13312
  v_exp_f32 v144, v144
  v_mfma_f32_16x16x32_bf16 v[32:35], a[0:3], v[176:179], v[32:35]
  v_exp_f32 v145, v145
  v_mfma_f32_16x16x32_bf16 v[64:67], a[0:3], v[184:187], v[64:67]
  v_add_f32 v192, v192, v144
  v_mfma_f32_16x16x32_bf16 v[4:7], a[4:7], v[168:171], v[4:7]
  ds_read_b64_tr_b16 a[28:29], v206 offset:9216
  ds_read_b64_tr_b16 a[30:31], v206 offset:13312
  v_exp_f32 v146, v146
  v_mfma_f32_16x16x32_bf16 v[36:39], a[4:7], v[176:179], v[36:39]
  v_add_f32 v192, v192, v145
  v_cvt_pk_bf16_f32 v144, v144, v145
  v_mfma_f32_16x16x32_bf16 v[68:71], a[4:7], v[184:187], v[68:71]
  v_exp_f32 v147, v147
  s_waitcnt lgkmcnt(8)
  v_mfma_f32_16x16x32_bf16 v[8:11], a[8:11], v[168:171], v[8:11]
  ds_read_b128 a[0:3], v197 offset:8192
  v_add_f32 v192, v192, v146
  v_mfma_f32_16x16x32_bf16 v[40:43], a[8:11], v[176:179], v[40:43]
  v_exp_f32 v148, v148
  v_mfma_f32_16x16x32_bf16 v[72:75], a[8:11], v[184:187], v[72:75]
  s_add_u32 s61, s61, 16384
  s_cmp_eq_u32 s61, 81920
  s_cselect_b32 s61, 32768, s61
  v_add_u32 v203, s61, v199
  v_add_u32 v204, s61, v200
  v_add_u32 v205, s61, v201
  v_add_u32 v206, s61, v202
  v_add_f32 v192, v192, v147
  v_cvt_pk_bf16_f32 v145, v146, v147
  v_mfma_f32_16x16x32_bf16 v[12:15], a[12:15], v[168:171], v[12:15]
  ds_read_b128 a[4:7], v198 offset:8192
  v_exp_f32 v149, v149
  v_mfma_f32_16x16x32_bf16 v[44:47], a[12:15], v[176:179], v[44:47]
  v_add_f32 v192, v192, v148
  v_mfma_f32_16x16x32_bf16 v[76:79], a[12:15], v[184:187], v[76:79]
  v_exp_f32 v150, v150
  s_waitcnt lgkmcnt(6)
  v_mfma_f32_16x16x32_bf16 v[16:19], a[16:19], v[168:171], v[16:19]
  ds_read_b128 a[8:11], v197 offset:9216
  v_add_f32 v192, v192, v149
  v_cvt_pk_bf16_f32 v146, v148, v149
  v_mfma_f32_16x16x32_bf16 v[48:51], a[16:19], v[176:179], v[48:51]
  v_exp_f32 v151, v151
  v_mfma_f32_16x16x32_bf16 v[80:83], a[16:19], v[184:187], v[80:83]
  v_add_f32 v192, v192, v150
  v_mfma_f32_16x16x32_bf16 v[20:23], a[20:23], v[168:171], v[20:23]
  ds_read_b128 a[12:15], v198 offset:9216
  v_add_f32 v192, v192, v151
  v_cvt_pk_bf16_f32 v147, v150, v151
  v_mfma_f32_16x16x32_bf16 v[52:55], a[20:23], v[176:179], v[52:55]
  v_exp_f32 v152, v152
  v_mfma_f32_16x16x32_bf16 v[84:87], a[20:23], v[184:187], v[84:87]
  v_exp_f32 v153, v153
  s_waitcnt lgkmcnt(4)
  v_mfma_f32_16x16x32_bf16 v[24:27], a[24:27], v[168:171], v[24:27]
  ds_read_b128 a[16:19], v197 offset:12288
  v_add_f32 v193, v193, v152
  v_mfma_f32_16x16x32_bf16 v[56:59], a[24:27], v[176:179], v[56:59]
  v_exp_f32 v154, v154
  v_mfma_f32_16x16x32_bf16 v[88:91], a[24:27], v[184:187], v[88:91]
  v_add_f32 v193, v193, v153
  v_cvt_pk_bf16_f32 v152, v152, v153
  v_mfma_f32_16x16x32_bf16 v[28:31], a[28:31], v[168:171], v[28:31]
  ds_read_b128 a[20:23], v198 offset:12288
  v_exp_f32 v155, v155
  v_mfma_f32_16x16x32_bf16 v[60:63], a[28:31], v[176:179], v[60:63]
  v_add_f32 v193, v193, v154
  v_mfma_f32_16x16x32_bf16 v[92:95], a[28:31], v[184:187], v[92:95]
  v_exp_f32 v156, v156
  s_waitcnt lgkmcnt(4)
  v_mfma_f32_16x16x32_bf16 v[168:171], a[0:3], v[96:99], 0
  ds_read_b128 a[24:27], v197 offset:13312
  v_add_f32 v193, v193, v155
  v_cvt_pk_bf16_f32 v153, v154, v155
  v_mfma_f32_16x16x32_bf16 v[176:179], a[0:3], v[112:115], 0
  v_exp_f32 v157, v157
  v_mfma_f32_16x16x32_bf16 v[184:187], a[0:3], v[128:131], 0
  v_add_f32 v193, v193, v156
  v_mfma_f32_16x16x32_bf16 v[168:171], a[4:7], v[100:103], v[168:171]
  ds_read_b128 a[28:31], v198 offset:13312
  v_exp_f32 v158, v158
  v_mfma_f32_16x16x32_bf16 v[176:179], a[4:7], v[116:119], v[176:179]
  v_add_f32 v193, v193, v157
  v_cvt_pk_bf16_f32 v154, v156, v157
  v_mfma_f32_16x16x32_bf16 v[184:187], a[4:7], v[132:135], v[184:187]
  v_exp_f32 v159, v159
  s_waitcnt lgkmcnt(4)
  v_mfma_f32_16x16x32_bf16 v[168:171], a[8:11], v[104:107], v[168:171]
  ds_read_b64_tr_b16 a[0:1], v203 offset:0
  ds_read_b64_tr_b16 a[2:3], v203 offset:4096
  v_add_f32 v193, v193, v158
  v_mfma_f32_16x16x32_bf16 v[176:179], a[8:11], v[120:123], v[176:179]
  v_add_f32 v193, v193, v159
  v_cvt_pk_bf16_f32 v155, v158, v159
  v_mfma_f32_16x16x32_bf16 v[184:187], a[8:11], v[136:139], v[184:187]
  v_xor_b32 v197, 16384, v197
  v_xor_b32 v198, 16384, v198
  v_exp_f32 v160, v160
  v_mfma_f32_16x16x32_bf16 v[168:171], a[12:15], v[108:111], v[168:171]
  ds_read_b64_tr_b16 a[4:5], v204 offset:0
  ds_read_b64_tr_b16 a[6:7], v204 offset:4096
  v_exp_f32 v161, v161
  v_mfma_f32_16x16x32_bf16 v[176:179], a[12:15], v[124:127], v[176:179]
  v_add_f32 v194, v194, v160
  v_mfma_f32_16x16x32_bf16 v[184:187], a[12:15], v[140:143], v[184:187]
  v_exp_f32 v162, v162
  s_waitcnt lgkmcnt(6)
  v_mfma_f32_16x16x32_bf16 v[172:175], a[16:19], v[96:99], 0
  ds_read_b64_tr_b16 a[8:9], v205 offset:0
  ds_read_b64_tr_b16 a[10:11], v205 offset:4096
  v_add_f32 v194, v194, v161
  v_cvt_pk_bf16_f32 v160, v160, v161
  v_mfma_f32_16x16x32_bf16 v[180:183], a[16:19], v[112:115], 0
  v_exp_f32 v163, v163
  v_mfma_f32_16x16x32_bf16 v[188:191], a[16:19], v[128:131], 0
  v_add_f32 v194, v194, v162
  v_mfma_f32_16x16x32_bf16 v[172:175], a[20:23], v[100:103], v[172:175]
  ds_read_b64_tr_b16 a[12:13], v206 offset:0
  ds_read_b64_tr_b16 a[14:15], v206 offset:4096
  v_exp_f32 v164, v164
  v_mfma_f32_16x16x32_bf16 v[180:183], a[20:23], v[116:119], v[180:183]
  v_add_f32 v194, v194, v163
  v_cvt_pk_bf16_f32 v161, v162, v163
  v_mfma_f32_16x16x32_bf16 v[188:191], a[20:23], v[132:135], v[188:191]
  v_exp_f32 v165, v165
  s_waitcnt lgkmcnt(8)
  v_mfma_f32_16x16x32_bf16 v[172:175], a[24:27], v[104:107], v[172:175]
  ds_read_b64_tr_b16 a[16:17], v203 offset:1024
  ds_read_b64_tr_b16 a[18:19], v203 offset:5120
  v_add_f32 v194, v194, v164
  v_mfma_f32_16x16x32_bf16 v[180:183], a[24:27], v[120:123], v[180:183]
  v_exp_f32 v166, v166
  v_mfma_f32_16x16x32_bf16 v[188:191], a[24:27], v[136:139], v[188:191]
  v_add_f32 v194, v194, v165
  v_cvt_pk_bf16_f32 v162, v164, v165
  v_mfma_f32_16x16x32_bf16 v[172:175], a[28:31], v[108:111], v[172:175]
  ds_read_b64_tr_b16 a[20:21], v204 offset:1024
  ds_read_b64_tr_b16 a[22:23], v204 offset:5120
  v_exp_f32 v167, v167
  v_mfma_f32_16x16x32_bf16 v[180:183], a[28:31], v[124:127], v[180:183]
  v_add_f32 v194, v194, v166
  v_mfma_f32_16x16x32_bf16 v[188:191], a[28:31], v[140:143], v[188:191]
  v_add_f32 v194, v194, v167
  v_cvt_pk_bf16_f32 v163, v166, v167
  s_add_u32 s62, s62, 1
  s_cmp_lt_u32 s62, 7
  s_cbranch_scc1 K1T3_attloop
  s_barrier
  s_waitcnt lgkmcnt(8)
  v_mfma_f32_16x16x32_bf16 v[0:3], a[0:3], v[144:147], v[0:3]
  ds_read_b64_tr_b16 a[24:25], v205 offset:1024
  ds_read_b64_tr_b16 a[26:27], v205 offset:5120
  v_exp_f32 v168, v168
  v_exp_f32 v169, v169
  v_mfma_f32_16x16x32_bf16 v[32:35], a[0:3], v[152:155], v[32:35]
  v_add_f32 v192, v192, v168
  v_exp_f32 v170, v170
  v_mfma_f32_16x16x32_bf16 v[64:67], a[0:3], v[160:163], v[64:67]
  v_add_f32 v192, v192, v169
  v_cvt_pk_bf16_f32 v168, v168, v169
  v_exp_f32 v171, v171
  v_mfma_f32_16x16x32_bf16 v[4:7], a[4:7], v[144:147], v[4:7]
  ds_read_b64_tr_b16 a[28:29], v206 offset:1024
  ds_read_b64_tr_b16 a[30:31], v206 offset:5120
  v_add_f32 v192, v192, v170
  v_exp_f32 v172, v172
  v_mfma_f32_16x16x32_bf16 v[36:39], a[4:7], v[152:155], v[36:39]
  v_add_f32 v192, v192, v171
  v_cvt_pk_bf16_f32 v169, v170, v171
  v_exp_f32 v173, v173
  v_mfma_f32_16x16x32_bf16 v[68:71], a[4:7], v[160:163], v[68:71]
  v_add_f32 v192, v192, v172
  v_exp_f32 v174, v174
  s_waitcnt lgkmcnt(8)
  v_mfma_f32_16x16x32_bf16 v[8:11], a[8:11], v[144:147], v[8:11]
  ds_read_b64_tr_b16 a[0:1], v203 offset:8192
  ds_read_b64_tr_b16 a[2:3], v203 offset:12288
  v_add_f32 v192, v192, v173
  v_cvt_pk_bf16_f32 v170, v172, v173
  v_exp_f32 v175, v175
  v_mfma_f32_16x16x32_bf16 v[40:43], a[8:11], v[152:155], v[40:43]
  v_add_f32 v192, v192, v174
  v_add_f32 v192, v192, v175
  v_cvt_pk_bf16_f32 v171, v174, v175
  v_mfma_f32_16x16x32_bf16 v[72:75], a[8:11], v[160:163], v[72:75]
  v_exp_f32 v176, v176
  v_exp_f32 v177, v177
  v_mfma_f32_16x16x32_bf16 v[12:15], a[12:15], v[144:147], v[12:15]
  ds_read_b64_tr_b16 a[4:5], v204 offset:8192
  ds_read_b64_tr_b16 a[6:7], v204 offset:12288
  v_add_f32 v193, v193, v176
  v_exp_f32 v178, v178
  v_mfma_f32_16x16x32_bf16 v[44:47], a[12:15], v[152:155], v[44:47]
  v_add_f32 v193, v193, v177
  v_cvt_pk_bf16_f32 v176, v176, v177
  v_exp_f32 v179, v179
  v_mfma_f32_16x16x32_bf16 v[76:79], a[12:15], v[160:163], v[76:79]
  v_add_f32 v193, v193, v178
  v_exp_f32 v180, v180
  s_waitcnt lgkmcnt(8)
  v_mfma_f32_16x16x32_bf16 v[16:19], a[16:19], v[144:147], v[16:19]
  ds_read_b64_tr_b16 a[8:9], v205 offset:8192
  ds_read_b64_tr_b16 a[10:11], v205 offset:12288
  v_add_f32 v193, v193, v179
  v_cvt_pk_bf16_f32 v177, v178, v179
  v_exp_f32 v181, v181
  v_mfma_f32_16x16x32_bf16 v[48:51], a[16:19], v[152:155], v[48:51]
  v_add_f32 v193, v193, v180
  v_exp_f32 v182, v182
  v_mfma_f32_16x16x32_bf16 v[80:83], a[16:19], v[160:163], v[80:83]
  v_add_f32 v193, v193, v181
  v_cvt_pk_bf16_f32 v178, v180, v181
  v_exp_f32 v183, v183
  v_mfma_f32_16x16x32_bf16 v[20:23], a[20:23], v[144:147], v[20:23]
  ds_read_b64_tr_b16 a[12:13], v206 offset:8192
  ds_read_b64_tr_b16 a[14:15], v206 offset:12288
  v_add_f32 v193, v193, v182
  v_add_f32 v193, v193, v183
  v_cvt_pk_bf16_f32 v179, v182, v183
  v_mfma_f32_16x16x32_bf16 v[52:55], a[20:23], v[152:155], v[52:55]
  v_exp_f32 v184, v184
  v_exp_f32 v185, v185
  v_mfma_f32_16x16x32_bf16 v[84:87], a[20:23], v[160:163], v[84:87]
  v_add_f32 v194, v194, v184
  v_exp_f32 v186, v186
  s_waitcnt lgkmcnt(8)
  v_mfma_f32_16x16x32_bf16 v[24:27], a[24:27], v[144:147], v[24:27]
  ds_read_b64_tr_b16 a[16:17], v203 offset:9216
  ds_read_b64_tr_b16 a[18:19], v203 offset:13312
  v_add_f32 v194, v194, v185
  v_cvt_pk_bf16_f32 v184, v184, v185
  v_exp_f32 v187, v187
  v_mfma_f32_16x16x32_bf16 v[56:59], a[24:27], v[152:155], v[56:59]
  v_add_f32 v194, v194, v186
  v_exp_f32 v188, v188
  v_mfma_f32_16x16x32_bf16 v[88:91], a[24:27], v[160:163], v[88:91]
  v_add_f32 v194, v194, v187
  v_cvt_pk_bf16_f32 v185, v186, v187
  v_exp_f32 v189, v189
  v_mfma_f32_16x16x32_bf16 v[28:31], a[28:31], v[144:147], v[28:31]
  ds_read_b64_tr_b16 a[20:21], v204 offset:9216
  ds_read_b64_tr_b16 a[22:23], v204 offset:13312
  v_add_f32 v194, v194, v188
  v_exp_f32 v190, v190
  v_mfma_f32_16x16x32_bf16 v[60:63], a[28:31], v[152:155], v[60:63]
  v_add_f32 v194, v194, v189
  v_cvt_pk_bf16_f32 v186, v188, v189
  v_exp_f32 v191, v191
  v_mfma_f32_16x16x32_bf16 v[92:95], a[28:31], v[160:163], v[92:95]
  v_add_f32 v194, v194, v190
  v_add_f32 v194, v194, v191
  v_cvt_pk_bf16_f32 v187, v190, v191
  s_barrier
  s_waitcnt lgkmcnt(8)
  v_mfma_f32_16x16x32_bf16 v[0:3], a[0:3], v[168:171], v[0:3]
  ds_read_b64_tr_b16 a[24:25], v205 offset:9216
  ds_read_b64_tr_b16 a[26:27], v205 offset:13312
  v_mfma_f32_16x16x32_bf16 v[32:35], a[0:3], v[176:179], v[32:35]
  v_mfma_f32_16x16x32_bf16 v[64:67], a[0:3], v[184:187], v[64:67]
  v_mfma_f32_16x16x32_bf16 v[4:7], a[4:7], v[168:171], v[4:7]
  ds_read_b64_tr_b16 a[28:29], v206 offset:9216
  ds_read_b64_tr_b16 a[30:31], v206 offset:13312
  v_mfma_f32_16x16x32_bf16 v[36:39], a[4:7], v[176:179], v[36:39]
  v_mfma_f32_16x16x32_bf16 v[68:71], a[4:7], v[184:187], v[68:71]
  s_waitcnt lgkmcnt(8)
  v_mfma_f32_16x16x32_bf16 v[8:11], a[8:11], v[168:171], v[8:11]
  v_mfma_f32_16x16x32_bf16 v[40:43], a[8:11], v[176:179], v[40:43]
  v_mfma_f32_16x16x32_bf16 v[72:75], a[8:11], v[184:187], v[72:75]
  v_mfma_f32_16x16x32_bf16 v[12:15], a[12:15], v[168:171], v[12:15]
  v_mfma_f32_16x16x32_bf16 v[44:47], a[12:15], v[176:179], v[44:47]
  v_mfma_f32_16x16x32_bf16 v[76:79], a[12:15], v[184:187], v[76:79]
  s_waitcnt lgkmcnt(4)
  v_mfma_f32_16x16x32_bf16 v[16:19], a[16:19], v[168:171], v[16:19]
  v_mfma_f32_16x16x32_bf16 v[48:51], a[16:19], v[176:179], v[48:51]
  v_mfma_f32_16x16x32_bf16 v[80:83], a[16:19], v[184:187], v[80:83]
  v_mfma_f32_16x16x32_bf16 v[20:23], a[20:23], v[168:171], v[20:23]
  v_mfma_f32_16x16x32_bf16 v[52:55], a[20:23], v[176:179], v[52:55]
  v_mfma_f32_16x16x32_bf16 v[84:87], a[20:23], v[184:187], v[84:87]
  s_waitcnt lgkmcnt(0)
  v_mfma_f32_16x16x32_bf16 v[24:27], a[24:27], v[168:171], v[24:27]
  v_mfma_f32_16x16x32_bf16 v[56:59], a[24:27], v[176:179], v[56:59]
  v_mfma_f32_16x16x32_bf16 v[88:91], a[24:27], v[184:187], v[88:91]
  v_mfma_f32_16x16x32_bf16 v[28:31], a[28:31], v[168:171], v[28:31]
  v_mfma_f32_16x16x32_bf16 v[60:63], a[28:31], v[176:179], v[60:63]
  v_mfma_f32_16x16x32_bf16 v[92:95], a[28:31], v[184:187], v[92:95]
  s_setprio 0
  s_nop 7
  v_mov_b32 v215, v192
  v_mov_b32 v216, v192
  s_nop 1
  v_permlane16_swap_b32 v215, v216
  v_add_f32 v192, v215, v216
  v_mov_b32 v215, v192
  v_mov_b32 v216, v192
  s_nop 1
  v_permlane32_swap_b32 v215, v216
  v_add_f32 v192, v215, v216
  v_mov_b32 v215, v193
  v_mov_b32 v216, v193
  s_nop 1
  v_permlane16_swap_b32 v215, v216
  v_add_f32 v193, v215, v216
  v_mov_b32 v215, v193
  v_mov_b32 v216, v193
  s_nop 1
  v_permlane32_swap_b32 v215, v216
  v_add_f32 v193, v215, v216
  v_mov_b32 v215, v194
  v_mov_b32 v216, v194
  s_nop 1
  v_permlane16_swap_b32 v215, v216
  v_add_f32 v194, v215, v216
  v_mov_b32 v215, v194
  v_mov_b32 v216, v194
  s_nop 1
  v_permlane32_swap_b32 v215, v216
  v_add_f32 v194, v215, v216
  s_mov_b32 s63, 0x33800000
  s_mov_b32 s66, 0x4b800000
  s_mov_b64 s[96:97], -1
  v_cmp_le_f32 vcc, s63, v192
  s_nop 0
  s_and_b64 s[96:97], s[96:97], vcc
  v_cmp_ge_f32 vcc, s66, v192
  s_nop 0
  s_and_b64 s[96:97], s[96:97], vcc
  v_cmp_le_f32 vcc, s63, v193
  s_nop 0
  s_and_b64 s[96:97], s[96:97], vcc
  v_cmp_ge_f32 vcc, s66, v193
  s_nop 0
  s_and_b64 s[96:97], s[96:97], vcc
  v_cmp_le_f32 vcc, s63, v194
  s_nop 0
  s_and_b64 s[96:97], s[96:97], vcc
  v_cmp_ge_f32 vcc, s66, v194
  s_nop 0
  s_and_b64 s[96:97], s[96:97], vcc
  s_lshl_b32 s67, s41, 2
  s_add_u32 s67, s67, 151552
  v_mov_b32 v215, s67
  s_cmp_eq_u64 s[96:97], -1
  s_cbranch_scc1 K1T3_rowsok
  v_mov_b32 v216, 1
  ds_write_b32 v215, v216
  s_waitcnt lgkmcnt(0)
K1T3_rowsok:
  s_barrier
  ds_read_b32 v216, v215
  s_waitcnt lgkmcnt(0)
  v_readfirstlane_b32 s63, v216
  s_cmp_eq_u32 s63, 0
  s_cbranch_scc1 K1T3_noslow
  s_cmp_eq_u32 s41, 0
  s_cselect_b32 s67, 81920, 0
  v_add_u32 v197, s67, v195
  v_add_u32 v198, s67, v196
  s_add_u32 s66, s67, 8192
  v_add_u32 v203, s66, v199
  v_add_u32 v204, s66, v200
  v_add_u32 v205, s66, v201
  v_add_u32 v206, s66, v202
  v_mov_b32 v168, 0xff800000
  v_mov_b32 v169, 0xff800000
  v_mov_b32 v170, 0xff800000
  s_lshl_b32 s60, s41, 17
  s_mov_b32 s61, 0
K1T3_slow_p0:
  s_add_u32 m0, s67, s43
  s_xor_b32 s72, s60, s70
  buffer_load_dwordx4 v207, s[24:27], s72 offen lds
  s_add_u32 m0, m0, 896
  s_nop 0
  buffer_load_dwordx4 v207, s[24:27], s72 offen offset:128 lds
  s_waitcnt vmcnt(0)
  s_barrier
  ds_read_b128 a[0:3], v197 offset:0
  ds_read_b128 a[4:7], v198 offset:0
  ds_read_b128 a[8:11], v197 offset:1024
  ds_read_b128 a[12:15], v198 offset:1024
  ds_read_b128 a[16:19], v197 offset:4096
  ds_read_b128 a[20:23], v198 offset:4096
  ds_read_b128 a[24:27], v197 offset:5120
  ds_read_b128 a[28:31], v198 offset:5120
  s_waitcnt lgkmcnt(0)
  v_mfma_f32_16x16x32_bf16 v[144:147], a[0:3], v[96:99], 0
  v_mfma_f32_16x16x32_bf16 v[152:155], a[0:3], v[112:115], 0
  v_mfma_f32_16x16x32_bf16 v[160:163], a[0:3], v[128:131], 0
  v_mfma_f32_16x16x32_bf16 v[144:147], a[4:7], v[100:103], v[144:147]
  v_mfma_f32_16x16x32_bf16 v[152:155], a[4:7], v[116:119], v[152:155]
  v_mfma_f32_16x16x32_bf16 v[160:163], a[4:7], v[132:135], v[160:163]
  v_mfma_f32_16x16x32_bf16 v[144:147], a[8:11], v[104:107], v[144:147]
  v_mfma_f32_16x16x32_bf16 v[152:155], a[8:11], v[120:123], v[152:155]
  v_mfma_f32_16x16x32_bf16 v[160:163], a[8:11], v[136:139], v[160:163]
  v_mfma_f32_16x16x32_bf16 v[144:147], a[12:15], v[108:111], v[144:147]
  v_mfma_f32_16x16x32_bf16 v[152:155], a[12:15], v[124:127], v[152:155]
  v_mfma_f32_16x16x32_bf16 v[160:163], a[12:15], v[140:143], v[160:163]
  v_mfma_f32_16x16x32_bf16 v[148:151], a[16:19], v[96:99], 0
  v_mfma_f32_16x16x32_bf16 v[156:159], a[16:19], v[112:115], 0
  v_mfma_f32_16x16x32_bf16 v[164:167], a[16:19], v[128:131], 0
  v_mfma_f32_16x16x32_bf16 v[148:151], a[20:23], v[100:103], v[148:151]
  v_mfma_f32_16x16x32_bf16 v[156:159], a[20:23], v[116:119], v[156:159]
  v_mfma_f32_16x16x32_bf16 v[164:167], a[20:23], v[132:135], v[164:167]
  v_mfma_f32_16x16x32_bf16 v[148:151], a[24:27], v[104:107], v[148:151]
  v_mfma_f32_16x16x32_bf16 v[156:159], a[24:27], v[120:123], v[156:159]
  v_mfma_f32_16x16x32_bf16 v[164:167], a[24:27], v[136:139], v[164:167]
  v_mfma_f32_16x16x32_bf16 v[148:151], a[28:31], v[108:111], v[148:151]
  v_mfma_f32_16x16x32_bf16 v[156:159], a[28:31], v[124:127], v[156:159]
  v_mfma_f32_16x16x32_bf16 v[164:167], a[28:31], v[140:143], v[164:167]
  s_nop 7
  s_nop 7
  v_max3_f32 v168, v168, v144, v145
  v_max3_f32 v168, v168, v146, v147
  v_max3_f32 v168, v168, v148, v149
  v_max3_f32 v168, v168, v150, v151
  v_max3_f32 v169, v169, v152, v153
  v_max3_f32 v169, v169, v154, v155
  v_max3_f32 v169, v169, v156, v157
  v_max3_f32 v169, v169, v158, v159
  v_max3_f32 v170, v170, v160, v161
  v_max3_f32 v170, v170, v162, v163
  v_max3_f32 v170, v170, v164, v165
  v_max3_f32 v170, v170, v166, v167
  s_barrier
  s_add_u32 s60, s60, 8192
  s_add_u32 s61, s61, 1
  s_cmp_lt_u32 s61, 16
  s_cbranch_scc1 K1T3_slow_p0
  v_mov_b32 v215, v168
  v_mov_b32 v216, v168
  s_nop 1
  v_permlane16_swap_b32 v215, v216
  v_max_f32 v168, v215, v216
  v_mov_b32 v215, v168
  v_mov_b32 v216, v168
  s_nop 1
  v_permlane32_swap_b32 v215, v216
  v_max_f32 v168, v215, v216
  v_mov_b32 v215, v169
  v_mov_b32 v216, v169
  s_nop 1
  v_permlane16_swap_b32 v215, v216
  v_max_f32 v169, v215, v216
  v_mov_b32 v215, v169
  v_mov_b32 v216, v169
  s_nop 1
  v_permlane32_swap_b32 v215, v216
  v_max_f32 v169, v215, v216
  v_mov_b32 v215, v170
  v_mov_b32 v216, v170
  s_nop 1
  v_permlane16_swap_b32 v215, v216
  v_max_f32 v170, v215, v216
  v_mov_b32 v215, v170
  v_mov_b32 v216, v170
  s_nop 1
  v_permlane32_swap_b32 v215, v216
  v_max_f32 v170, v215, v216
  v_sub_f32 v172, 0, v168
  v_sub_f32 v173, 0, v168
  v_sub_f32 v174, 0, v168
  v_sub_f32 v175, 0, v168
  v_sub_f32 v176, 0, v169
  v_sub_f32 v177, 0, v169
  v_sub_f32 v178, 0, v169
  v_sub_f32 v179, 0, v169
  v_sub_f32 v180, 0, v170
  v_sub_f32 v181, 0, v170
  v_sub_f32 v182, 0, v170
  v_sub_f32 v183, 0, v170
  v_mov_b64 v[0:1], 0
  v_mov_b64 v[2:3], 0
  v_mov_b64 v[4:5], 0
  v_mov_b64 v[6:7], 0
  v_mov_b64 v[8:9], 0
  v_mov_b64 v[10:11], 0
  v_mov_b64 v[12:13], 0
  v_mov_b64 v[14:15], 0
  v_mov_b64 v[16:17], 0
  v_mov_b64 v[18:19], 0
  v_mov_b64 v[20:21], 0
  v_mov_b64 v[22:23], 0
  v_mov_b64 v[24:25], 0
  v_mov_b64 v[26:27], 0
  v_mov_b64 v[28:29], 0
  v_mov_b64 v[30:31], 0
  v_mov_b64 v[32:33], 0
  v_mov_b64 v[34:35], 0
  v_mov_b64 v[36:37], 0
  v_mov_b64 v[38:39], 0
  v_mov_b64 v[40:41], 0
  v_mov_b64 v[42:43], 0
  v_mov_b64 v[44:45], 0
  v_mov_b64 v[46:47], 0
  v_mov_b64 v[48:49], 0
  v_mov_b64 v[50:51], 0
  v_mov_b64 v[52:53], 0
  v_mov_b64 v[54:55], 0
  v_mov_b64 v[56:57], 0
  v_mov_b64 v[58:59], 0
  v_mov_b64 v[60:61], 0
  v_mov_b64 v[62:63], 0
  v_mov_b64 v[64:65], 0
  v_mov_b64 v[66:67], 0
  v_mov_b64 v[68:69], 0
  v_mov_b64 v[70:71], 0
  v_mov_b64 v[72:73], 0
  v_mov_b64 v[74:75], 0
  v_mov_b64 v[76:77], 0
  v_mov_b64 v[78:79], 0
  v_mov_b64 v[80:81], 0
  v_mov_b64 v[82:83], 0
  v_mov_b64 v[84:85], 0
  v_mov_b64 v[86:87], 0
  v_mov_b64 v[88:89], 0
  v_mov_b64 v[90:91], 0
  v_mov_b64 v[92:93], 0
  v_mov_b64 v[94:95], 0
  v_mov_b32 v192, 0
  v_mov_b32 v193, 0
  v_mov_b32 v194, 0
  s_lshl_b32 s60, s41, 17
  s_mov_b32 s61, 0
K1T3_slow_p1:
  s_add_u32 m0, s67, s43
  s_xor_b32 s72, s60, s70
  buffer_load_dwordx4 v207, s[24:27], s72 offen lds
  s_add_u32 m0, m0, 896
  s_nop 0
  buffer_load_dwordx4 v207, s[24:27], s72 offen offset:128 lds
  s_add_u32 m0, s67, s43
  s_add_u32 m0, m0, 8192
  s_xor_b32 s72, s60, s70
  buffer_load_dwordx4 v207, s[28:31], s72 offen lds
  s_add_u32 m0, m0, 896
  s_nop 0
  buffer_load_dwordx4 v207, s[28:31], s72 offen offset:128 lds
  s_waitcnt vmcnt(0)
  s_barrier
  ds_read_b128 a[0:3], v197 offset:0
  ds_read_b128 a[4:7], v198 offset:0
  ds_read_b128 a[8:11], v197 offset:1024
  ds_read_b128 a[12:15], v198 offset:1024
  ds_read_b128 a[16:19], v197 offset:4096
  ds_read_b128 a[20:23], v198 offset:4096
  ds_read_b128 a[24:27], v197 offset:5120
  ds_read_b128 a[28:31], v198 offset:5120
  s_waitcnt lgkmcnt(0)
  v_mfma_f32_16x16x32_bf16 v[144:147], a[0:3], v[96:99], v[172:175]
  v_mfma_f32_16x16x32_bf16 v[152:155], a[0:3], v[112:115], v[176:179]
  v_mfma_f32_16x16x32_bf16 v[160:163], a[0:3], v[128:131], v[180:183]
  v_mfma_f32_16x16x32_bf16 v[144:147], a[4:7], v[100:103], v[144:147]
  v_mfma_f32_16x16x32_bf16 v[152:155], a[4:7], v[116:119], v[152:155]
  v_mfma_f32_16x16x32_bf16 v[160:163], a[4:7], v[132:135], v[160:163]
  v_mfma_f32_16x16x32_bf16 v[144:147], a[8:11], v[104:107], v[144:147]
  v_mfma_f32_16x16x32_bf16 v[152:155], a[8:11], v[120:123], v[152:155]
  v_mfma_f32_16x16x32_bf16 v[160:163], a[8:11], v[136:139], v[160:163]
  v_mfma_f32_16x16x32_bf16 v[144:147], a[12:15], v[108:111], v[144:147]
  v_mfma_f32_16x16x32_bf16 v[152:155], a[12:15], v[124:127], v[152:155]
  v_mfma_f32_16x16x32_bf16 v[160:163], a[12:15], v[140:143], v[160:163]
  v_mfma_f32_16x16x32_bf16 v[148:151], a[16:19], v[96:99], v[172:175]
  v_mfma_f32_16x16x32_bf16 v[156:159], a[16:19], v[112:115], v[176:179]
  v_mfma_f32_16x16x32_bf16 v[164:167], a[16:19], v[128:131], v[180:183]
  v_mfma_f32_16x16x32_bf16 v[148:151], a[20:23], v[100:103], v[148:151]
  v_mfma_f32_16x16x32_bf16 v[156:159], a[20:23], v[116:119], v[156:159]
  v_mfma_f32_16x16x32_bf16 v[164:167], a[20:23], v[132:135], v[164:167]
  v_mfma_f32_16x16x32_bf16 v[148:151], a[24:27], v[104:107], v[148:151]
  v_mfma_f32_16x16x32_bf16 v[156:159], a[24:27], v[120:123], v[156:159]
  v_mfma_f32_16x16x32_bf16 v[164:167], a[24:27], v[136:139], v[164:167]
  v_mfma_f32_16x16x32_bf16 v[148:151], a[28:31], v[108:111], v[148:151]
  v_mfma_f32_16x16x32_bf16 v[156:159], a[28:31], v[124:127], v[156:159]
  v_mfma_f32_16x16x32_bf16 v[164:167], a[28:31], v[140:143], v[164:167]
  s_nop 7
  s_nop 7
  v_exp_f32 v144, v144
  v_exp_f32 v145, v145
  v_exp_f32 v146, v146
  v_exp_f32 v147, v147
  v_exp_f32 v148, v148
  v_exp_f32 v149, v149
  v_exp_f32 v150, v150
  v_exp_f32 v151, v151
  s_nop 0
  v_add_f32 v192, v192, v144
  v_add_f32 v192, v192, v145
  v_add_f32 v192, v192, v146
  v_add_f32 v192, v192, v147
  v_add_f32 v192, v192, v148
  v_add_f32 v192, v192, v149
  v_add_f32 v192, v192, v150
  v_add_f32 v192, v192, v151
  v_cvt_pk_bf16_f32 v144, v144, v145
  v_cvt_pk_bf16_f32 v145, v146, v147
  v_cvt_pk_bf16_f32 v146, v148, v149
  v_cvt_pk_bf16_f32 v147, v150, v151
  v_exp_f32 v152, v152
  v_exp_f32 v153, v153
  v_exp_f32 v154, v154
  v_exp_f32 v155, v155
  v_exp_f32 v156, v156
  v_exp_f32 v157, v157
  v_exp_f32 v158, v158
  v_exp_f32 v159, v159
  s_nop 0
  v_add_f32 v193, v193, v152
  v_add_f32 v193, v193, v153
  v_add_f32 v193, v193, v154
  v_add_f32 v193, v193, v155
  v_add_f32 v193, v193, v156
  v_add_f32 v193, v193, v157
  v_add_f32 v193, v193, v158
  v_add_f32 v193, v193, v159
  v_cvt_pk_bf16_f32 v152, v152, v153
  v_cvt_pk_bf16_f32 v153, v154, v155
  v_cvt_pk_bf16_f32 v154, v156, v157
  v_cvt_pk_bf16_f32 v155, v158, v159
  v_exp_f32 v160, v160
  v_exp_f32 v161, v161
  v_exp_f32 v162, v162
  v_exp_f32 v163, v163
  v_exp_f32 v164, v164
  v_exp_f32 v165, v165
  v_exp_f32 v166, v166
  v_exp_f32 v167, v167
  s_nop 0
  v_add_f32 v194, v194, v160
  v_add_f32 v194, v194, v161
  v_add_f32 v194, v194, v162
  v_add_f32 v194, v194, v163
  v_add_f32 v194, v194, v164
  v_add_f32 v194, v194, v165
  v_add_f32 v194, v194, v166
  v_add_f32 v194, v194, v167
  v_cvt_pk_bf16_f32 v160, v160, v161
  v_cvt_pk_bf16_f32 v161, v162, v163
  v_cvt_pk_bf16_f32 v162, v164, v165
  v_cvt_pk_bf16_f32 v163, v166, v167
  ds_read_b64_tr_b16 a[0:1], v203 offset:0
  ds_read_b64_tr_b16 a[2:3], v203 offset:4096
  ds_read_b64_tr_b16 a[4:5], v204 offset:0
  ds_read_b64_tr_b16 a[6:7], v204 offset:4096
  ds_read_b64_tr_b16 a[8:9], v205 offset:0
  ds_read_b64_tr_b16 a[10:11], v205 offset:4096
  ds_read_b64_tr_b16 a[12:13], v206 offset:0
  ds_read_b64_tr_b16 a[14:15], v206 offset:4096
  ds_read_b64_tr_b16 a[16:17], v203 offset:1024
  ds_read_b64_tr_b16 a[18:19], v203 offset:5120
  ds_read_b64_tr_b16 a[20:21], v204 offset:1024
  ds_read_b64_tr_b16 a[22:23], v204 offset:5120
  ds_read_b64_tr_b16 a[24:25], v205 offset:1024
  ds_read_b64_tr_b16 a[26:27], v205 offset:5120
  ds_read_b64_tr_b16 a[28:29], v206 offset:1024
  ds_read_b64_tr_b16 a[30:31], v206 offset:5120
  s_waitcnt lgkmcnt(0)
  v_mfma_f32_16x16x32_bf16 v[0:3], a[0:3], v[144:147], v[0:3]
  v_mfma_f32_16x16x32_bf16 v[32:35], a[0:3], v[152:155], v[32:35]
  v_mfma_f32_16x16x32_bf16 v[64:67], a[0:3], v[160:163], v[64:67]
  v_mfma_f32_16x16x32_bf16 v[4:7], a[4:7], v[144:147], v[4:7]
  v_mfma_f32_16x16x32_bf16 v[36:39], a[4:7], v[152:155], v[36:39]
  v_mfma_f32_16x16x32_bf16 v[68:71], a[4:7], v[160:163], v[68:71]
  v_mfma_f32_16x16x32_bf16 v[8:11], a[8:11], v[144:147], v[8:11]
  v_mfma_f32_16x16x32_bf16 v[40:43], a[8:11], v[152:155], v[40:43]
  v_mfma_f32_16x16x32_bf16 v[72:75], a[8:11], v[160:163], v[72:75]
  v_mfma_f32_16x16x32_bf16 v[12:15], a[12:15], v[144:147], v[12:15]
  v_mfma_f32_16x16x32_bf16 v[44:47], a[12:15], v[152:155], v[44:47]
  v_mfma_f32_16x16x32_bf16 v[76:79], a[12:15], v[160:163], v[76:79]
  v_mfma_f32_16x16x32_bf16 v[16:19], a[16:19], v[144:147], v[16:19]
  v_mfma_f32_16x16x32_bf16 v[48:51], a[16:19], v[152:155], v[48:51]
  v_mfma_f32_16x16x32_bf16 v[80:83], a[16:19], v[160:163], v[80:83]
  v_mfma_f32_16x16x32_bf16 v[20:23], a[20:23], v[144:147], v[20:23]
  v_mfma_f32_16x16x32_bf16 v[52:55], a[20:23], v[152:155], v[52:55]
  v_mfma_f32_16x16x32_bf16 v[84:87], a[20:23], v[160:163], v[84:87]
  v_mfma_f32_16x16x32_bf16 v[24:27], a[24:27], v[144:147], v[24:27]
  v_mfma_f32_16x16x32_bf16 v[56:59], a[24:27], v[152:155], v[56:59]
  v_mfma_f32_16x16x32_bf16 v[88:91], a[24:27], v[160:163], v[88:91]
  v_mfma_f32_16x16x32_bf16 v[28:31], a[28:31], v[144:147], v[28:31]
  v_mfma_f32_16x16x32_bf16 v[60:63], a[28:31], v[152:155], v[60:63]
  v_mfma_f32_16x16x32_bf16 v[92:95], a[28:31], v[160:163], v[92:95]
  s_nop 7
  s_nop 7
  s_barrier
  s_add_u32 s60, s60, 8192
  s_add_u32 s61, s61, 1
  s_cmp_lt_u32 s61, 16
  s_cbranch_scc1 K1T3_slow_p1
  v_mov_b32 v215, v192
  v_mov_b32 v216, v192
  s_nop 1
  v_permlane16_swap_b32 v215, v216
  v_add_f32 v192, v215, v216
  v_mov_b32 v215, v192
  v_mov_b32 v216, v192
  s_nop 1
  v_permlane32_swap_b32 v215, v216
  v_add_f32 v192, v215, v216
  v_mov_b32 v215, v193
  v_mov_b32 v216, v193
  s_nop 1
  v_permlane16_swap_b32 v215, v216
  v_add_f32 v193, v215, v216
  v_mov_b32 v215, v193
  v_mov_b32 v216, v193
  s_nop 1
  v_permlane32_swap_b32 v215, v216
  v_add_f32 v193, v215, v216
  v_mov_b32 v215, v194
  v_mov_b32 v216, v194
  s_nop 1
  v_permlane16_swap_b32 v215, v216
  v_add_f32 v194, v215, v216
  v_mov_b32 v215, v194
  v_mov_b32 v216, v194
  s_nop 1
  v_permlane32_swap_b32 v215, v216
  v_add_f32 v194, v215, v216
K1T3_noslow:
  s_cmp_eq_u32 s41, 0
  s_cbranch_scc0 K1T3_j1
  s_xor_b32 s72, s57, s70
  s_add_u32 m0, s59, s44
  s_nop 0
  buffer_load_dwordx4 v207, s[28:31], s72 offen nt lds
  s_add_u32 m0, m0, 896
  s_nop 0
  buffer_load_dwordx4 v207, s[28:31], s72 offen offset:128 nt lds
  s_add_u32 s57, s57, 8192
  s_add_u32 s59, s59, 8192
  s_cmp_eq_u32 s59, 49152
  s_cselect_b32 s59, 0, s59
  s_barrier
  s_xor_b32 s72, s57, s70
  s_add_u32 m0, s59, s44
  s_nop 0
  buffer_load_dwordx4 v207, s[28:31], s72 offen nt lds
  s_add_u32 m0, m0, 896
  s_nop 0
  buffer_load_dwordx4 v207, s[28:31], s72 offen offset:128 nt lds
  s_add_u32 s57, s57, 8192
  s_add_u32 s59, s59, 8192
  s_cmp_eq_u32 s59, 49152
  s_cselect_b32 s59, 0, s59
  s_xor_b32 s72, s56, s70
  s_add_u32 m0, s58, s43
  s_nop 0
  buffer_load_dwordx4 v207, s[24:27], s72 offen nt lds
  s_add_u32 m0, m0, 896
  s_nop 0
  buffer_load_dwordx4 v207, s[24:27], s72 offen offset:128 nt lds
  s_add_u32 s56, s56, 8192
  s_add_u32 s58, s58, 8192
  s_and_b32 s58, s58, 32767
  v_rcp_f32 v216, v192
  s_nop 0
  v_mul_f32 v0, v0, v216
  v_mul_f32 v1, v1, v216
  v_mul_f32 v2, v2, v216
  v_mul_f32 v3, v3, v216
  v_mul_f32 v4, v4, v216
  v_mul_f32 v5, v5, v216
  v_mul_f32 v6, v6, v216
  v_mul_f32 v7, v7, v216
  v_cvt_pk_bf16_f32 v96, v0, v1
  v_cvt_pk_bf16_f32 v97, v2, v3
  v_cvt_pk_bf16_f32 v98, v4, v5
  v_cvt_pk_bf16_f32 v99, v6, v7
  s_barrier
  s_xor_b32 s72, s57, s70
  s_add_u32 m0, s59, s44
  s_nop 0
  buffer_load_dwordx4 v207, s[28:31], s72 offen nt lds
  s_add_u32 m0, m0, 896
  s_nop 0
  buffer_load_dwordx4 v207, s[28:31], s72 offen offset:128 nt lds
  s_add_u32 s57, s57, 8192
  s_add_u32 s59, s59, 8192
  s_cmp_eq_u32 s59, 49152
  s_cselect_b32 s59, 0, s59
  s_xor_b32 s72, s56, s70
  s_add_u32 m0, s58, s43
  s_nop 0
  buffer_load_dwordx4 v207, s[24:27], s72 offen nt lds
  s_add_u32 m0, m0, 896
  s_nop 0
  buffer_load_dwordx4 v207, s[24:27], s72 offen offset:128 nt lds
  s_add_u32 s56, s56, 8192
  s_add_u32 s58, s58, 8192
  s_and_b32 s58, s58, 32767
  v_mul_f32 v8, v8, v216
  v_mul_f32 v9, v9, v216
  v_mul_f32 v10, v10, v216
  v_mul_f32 v11, v11, v216
  v_mul_f32 v12, v12, v216
  v_mul_f32 v13, v13, v216
  v_mul_f32 v14, v14, v216
  v_mul_f32 v15, v15, v216
  v_cvt_pk_bf16_f32 v100, v8, v9
  v_cvt_pk_bf16_f32 v101, v10, v11
  v_cvt_pk_bf16_f32 v102, v12, v13
  v_cvt_pk_bf16_f32 v103, v14, v15
  s_barrier
  s_xor_b32 s72, s57, s70
  s_add_u32 m0, s59, s44
  s_nop 0
  buffer_load_dwordx4 v207, s[28:31], s72 offen nt lds
  s_add_u32 m0, m0, 896
  s_nop 0
  buffer_load_dwordx4 v207, s[28:31], s72 offen offset:128 nt lds
  s_add_u32 s57, s57, 8192
  s_add_u32 s59, s59, 8192
  s_cmp_eq_u32 s59, 49152
  s_cselect_b32 s59, 0, s59
  s_xor_b32 s72, s56, s70
  s_add_u32 m0, s58, s43
  s_nop 0
  buffer_load_dwordx4 v207, s[24:27], s72 offen nt lds
  s_add_u32 m0, m0, 896
  s_nop 0
  buffer_load_dwordx4 v207, s[24:27], s72 offen offset:128 nt lds
  s_add_u32 s56, s56, 8192
  s_add_u32 s58, s58, 8192
  s_and_b32 s58, s58, 32767
  v_mul_f32 v16, v16, v216
  v_mul_f32 v17, v17, v216
  v_mul_f32 v18, v18, v216
  v_mul_f32 v19, v19, v216
  v_mul_f32 v20, v20, v216
  v_mul_f32 v21, v21, v216
  v_mul_f32 v22, v22, v216
  v_mul_f32 v23, v23, v216
  v_cvt_pk_bf16_f32 v104, v16, v17
  v_cvt_pk_bf16_f32 v105, v18, v19
  v_cvt_pk_bf16_f32 v106, v20, v21
  v_cvt_pk_bf16_f32 v107, v22, v23
  s_waitcnt vmcnt(8)
  s_barrier
  s_xor_b32 s72, s57, s70
  s_add_u32 m0, s59, s44
  s_nop 0
  buffer_load_dwordx4 v207, s[28:31], s72 offen nt lds
  s_add_u32 m0, m0, 896
  s_nop 0
  buffer_load_dwordx4 v207, s[28:31], s72 offen offset:128 nt lds
  s_add_u32 s57, s57, 8192
  s_add_u32 s59, s59, 8192
  s_cmp_eq_u32 s59, 49152
  s_cselect_b32 s59, 0, s59
  s_xor_b32 s72, s56, s70
  s_add_u32 m0, s58, s43
  s_nop 0
  buffer_load_dwordx4 v207, s[24:27], s72 offen nt lds
  s_add_u32 m0, m0, 896
  s_nop 0
  buffer_load_dwordx4 v207, s[24:27], s72 offen offset:128 nt lds
  s_add_u32 s56, s56, 8192
  s_add_u32 s58, s58, 8192
  s_and_b32 s58, s58, 32767
  v_mul_f32 v24, v24, v216
  v_mul_f32 v25, v25, v216
  v_mul_f32 v26, v26, v216
  v_mul_f32 v27, v27, v216
  v_mul_f32 v28, v28, v216
  v_mul_f32 v29, v29, v216
  v_mul_f32 v30, v30, v216
  v_mul_f32 v31, v31, v216
  v_cvt_pk_bf16_f32 v108, v24, v25
  v_cvt_pk_bf16_f32 v109, v26, v27
  v_cvt_pk_bf16_f32 v110, v28, v29
  v_cvt_pk_bf16_f32 v111, v30, v31
  s_waitcnt vmcnt(8)
  s_barrier
  s_xor_b32 s72, s57, s70
  s_add_u32 m0, s59, s44
  s_nop 0
  buffer_load_dwordx4 v207, s[28:31], s72 offen nt lds
  s_add_u32 m0, m0, 896
  s_nop 0
  buffer_load_dwordx4 v207, s[28:31], s72 offen offset:128 nt lds
  s_add_u32 s57, s57, 8192
  s_add_u32 s59, s59, 8192
  s_cmp_eq_u32 s59, 49152
  s_cselect_b32 s59, 0, s59
  s_xor_b32 s72, s56, s70
  s_add_u32 m0, s58, s43
  s_nop 0
  buffer_load_dwordx4 v207, s[24:27], s72 offen nt lds
  s_add_u32 m0, m0, 896
  s_nop 0
  buffer_load_dwordx4 v207, s[24:27], s72 offen offset:128 nt lds
  s_add_u32 s56, s56, 8192
  s_add_u32 s58, s58, 8192
  s_and_b32 s58, s58, 32767
  v_rcp_f32 v216, v193
  s_nop 0
  v_mul_f32 v32, v32, v216
  v_mul_f32 v33, v33, v216
  v_mul_f32 v34, v34, v216
  v_mul_f32 v35, v35, v216
  v_mul_f32 v36, v36, v216
  v_mul_f32 v37, v37, v216
  v_mul_f32 v38, v38, v216
  v_mul_f32 v39, v39, v216
  v_cvt_pk_bf16_f32 v112, v32, v33
  v_cvt_pk_bf16_f32 v113, v34, v35
  v_cvt_pk_bf16_f32 v114, v36, v37
  v_cvt_pk_bf16_f32 v115, v38, v39
  s_waitcnt vmcnt(8)
  s_barrier
  s_xor_b32 s72, s57, s70
  s_add_u32 m0, s59, s44
  s_nop 0
  buffer_load_dwordx4 v207, s[28:31], s72 offen nt lds
  s_add_u32 m0, m0, 896
  s_nop 0
  buffer_load_dwordx4 v207, s[28:31], s72 offen offset:128 nt lds
  s_add_u32 s57, s57, 8192
  s_add_u32 s59, s59, 8192
  s_cmp_eq_u32 s59, 49152
  s_cselect_b32 s59, 0, s59
  s_xor_b32 s72, s56, s70
  s_add_u32 m0, s58, s43
  s_nop 0
  buffer_load_dwordx4 v207, s[24:27], s72 offen nt lds
  s_add_u32 m0, m0, 896
  s_nop 0
  buffer_load_dwordx4 v207, s[24:27], s72 offen offset:128 nt lds
  s_add_u32 s56, s56, 8192
  s_add_u32 s58, s58, 8192
  s_and_b32 s58, s58, 32767
  v_mul_f32 v40, v40, v216
  v_mul_f32 v41, v41, v216
  v_mul_f32 v42, v42, v216
  v_mul_f32 v43, v43, v216
  v_mul_f32 v44, v44, v216
  v_mul_f32 v45, v45, v216
  v_mul_f32 v46, v46, v216
  v_mul_f32 v47, v47, v216
  v_cvt_pk_bf16_f32 v116, v40, v41
  v_cvt_pk_bf16_f32 v117, v42, v43
  v_cvt_pk_bf16_f32 v118, v44, v45
  v_cvt_pk_bf16_f32 v119, v46, v47
  s_waitcnt vmcnt(8)
  s_barrier
  s_xor_b32 s72, s57, s70
  s_add_u32 m0, s59, s44
  s_nop 0
  buffer_load_dwordx4 v207, s[28:31], s72 offen nt lds
  s_add_u32 m0, m0, 896
  s_nop 0
  buffer_load_dwordx4 v207, s[28:31], s72 offen offset:128 nt lds
  s_add_u32 s57, s57, 8192
  s_add_u32 s59, s59, 8192
  s_cmp_eq_u32 s59, 49152
  s_cselect_b32 s59, 0, s59
  s_xor_b32 s72, s56, s70
  s_add_u32 m0, s58, s43
  s_nop 0
  buffer_load_dwordx4 v207, s[24:27], s72 offen nt lds
  s_add_u32 m0, m0, 896
  s_nop 0
  buffer_load_dwordx4 v207, s[24:27], s72 offen offset:128 nt lds
  s_add_u32 s56, s56, 8192
  s_add_u32 s58, s58, 8192
  s_and_b32 s58, s58, 32767
  v_mul_f32 v48, v48, v216
  v_mul_f32 v49, v49, v216
  v_mul_f32 v50, v50, v216
  v_mul_f32 v51, v51, v216
  v_mul_f32 v52, v52, v216
  v_mul_f32 v53, v53, v216
  v_mul_f32 v54, v54, v216
  v_mul_f32 v55, v55, v216
  v_cvt_pk_bf16_f32 v120, v48, v49
  v_cvt_pk_bf16_f32 v121, v50, v51
  v_cvt_pk_bf16_f32 v122, v52, v53
  v_cvt_pk_bf16_f32 v123, v54, v55
  s_waitcnt vmcnt(8)
  s_barrier
  s_xor_b32 s72, s57, s70
  s_add_u32 m0, s59, s44
  s_nop 0
  buffer_load_dwordx4 v207, s[28:31], s72 offen nt lds
  s_add_u32 m0, m0, 896
  s_nop 0
  buffer_load_dwordx4 v207, s[28:31], s72 offen offset:128 nt lds
  s_add_u32 s57, s57, 8192
  s_add_u32 s59, s59, 8192
  s_cmp_eq_u32 s59, 49152
  s_cselect_b32 s59, 0, s59
  s_xor_b32 s72, s56, s70
  s_add_u32 m0, s58, s43
  s_nop 0
  buffer_load_dwordx4 v207, s[24:27], s72 offen nt lds
  s_add_u32 m0, m0, 896
  s_nop 0
  buffer_load_dwordx4 v207, s[24:27], s72 offen offset:128 nt lds
  s_add_u32 s56, s56, 8192
  s_add_u32 s58, s58, 8192
  s_and_b32 s58, s58, 32767
  v_mul_f32 v56, v56, v216
  v_mul_f32 v57, v57, v216
  v_mul_f32 v58, v58, v216
  v_mul_f32 v59, v59, v216
  v_mul_f32 v60, v60, v216
  v_mul_f32 v61, v61, v216
  v_mul_f32 v62, v62, v216
  v_mul_f32 v63, v63, v216
  v_cvt_pk_bf16_f32 v124, v56, v57
  v_cvt_pk_bf16_f32 v125, v58, v59
  v_cvt_pk_bf16_f32 v126, v60, v61
  v_cvt_pk_bf16_f32 v127, v62, v63
  s_waitcnt vmcnt(8)
  s_barrier
  s_xor_b32 s72, s57, s70
  s_add_u32 m0, s59, s44
  s_nop 0
  buffer_load_dwordx4 v207, s[28:31], s72 offen nt lds
  s_add_u32 m0, m0, 896
  s_nop 0
  buffer_load_dwordx4 v207, s[28:31], s72 offen offset:128 nt lds
  s_add_u32 s57, s57, 8192
  s_add_u32 s59, s59, 8192
  s_cmp_eq_u32 s59, 49152
  s_cselect_b32 s59, 0, s59
  s_xor_b32 s72, s56, s70
  s_add_u32 m0, s58, s43
  s_nop 0
  buffer_load_dwordx4 v207, s[24:27], s72 offen nt lds
  s_add_u32 m0, m0, 896
  s_nop 0
  buffer_load_dwordx4 v207, s[24:27], s72 offen offset:128 nt lds
  s_add_u32 s56, s56, 8192
  s_add_u32 s58, s58, 8192
  s_and_b32 s58, s58, 32767
  v_rcp_f32 v216, v194
  s_nop 0
  v_mul_f32 v64, v64, v216
  v_mul_f32 v65, v65, v216
  v_mul_f32 v66, v66, v216
  v_mul_f32 v67, v67, v216
  v_mul_f32 v68, v68, v216
  v_mul_f32 v69, v69, v216
  v_mul_f32 v70, v70, v216
  v_mul_f32 v71, v71, v216
  v_cvt_pk_bf16_f32 v128, v64, v65
  v_cvt_pk_bf16_f32 v129, v66, v67
  v_cvt_pk_bf16_f32 v130, v68, v69
  v_cvt_pk_bf16_f32 v131, v70, v71
  s_waitcnt vmcnt(8)
  s_barrier
  s_xor_b32 s72, s57, s70
  s_add_u32 m0, s59, s44
  s_nop 0
  buffer_load_dwordx4 v207, s[28:31], s72 offen nt lds
  s_add_u32 m0, m0, 896
  s_nop 0
  buffer_load_dwordx4 v207, s[28:31], s72 offen offset:128 nt lds
  s_add_u32 s57, s57, 8192
  s_add_u32 s59, s59, 8192
  s_cmp_eq_u32 s59, 49152
  s_cselect_b32 s59, 0, s59
  s_xor_b32 s72, s56, s70
  s_add_u32 m0, s58, s43
  s_nop 0
  buffer_load_dwordx4 v207, s[24:27], s72 offen nt lds
  s_add_u32 m0, m0, 896
  s_nop 0
  buffer_load_dwordx4 v207, s[24:27], s72 offen offset:128 nt lds
  s_add_u32 s56, s56, 8192
  s_add_u32 s58, s58, 8192
  s_and_b32 s58, s58, 32767
  v_mul_f32 v72, v72, v216
  v_mul_f32 v73, v73, v216
  v_mul_f32 v74, v74, v216
  v_mul_f32 v75, v75, v216
  v_mul_f32 v76, v76, v216
  v_mul_f32 v77, v77, v216
  v_mul_f32 v78, v78, v216
  v_mul_f32 v79, v79, v216
  v_cvt_pk_bf16_f32 v132, v72, v73
  v_cvt_pk_bf16_f32 v133, v74, v75
  v_cvt_pk_bf16_f32 v134, v76, v77
  v_cvt_pk_bf16_f32 v135, v78, v79
  s_waitcnt vmcnt(8)
  s_barrier
  s_xor_b32 s72, s57, s70
  s_add_u32 m0, s59, s44
  s_nop 0
  buffer_load_dwordx4 v207, s[28:31], s72 offen nt lds
  s_add_u32 m0, m0, 896
  s_nop 0
  buffer_load_dwordx4 v207, s[28:31], s72 offen offset:128 nt lds
  s_add_u32 s57, s57, 8192
  s_add_u32 s59, s59, 8192
  s_cmp_eq_u32 s59, 49152
  s_cselect_b32 s59, 0, s59
  s_xor_b32 s72, s56, s70
  s_add_u32 m0, s58, s43
  s_nop 0
  buffer_load_dwordx4 v207, s[24:27], s72 offen nt lds
  s_add_u32 m0, m0, 896
  s_nop 0
  buffer_load_dwordx4 v207, s[24:27], s72 offen offset:128 nt lds
  s_add_u32 s56, s56, 8192
  s_add_u32 s58, s58, 8192
  s_and_b32 s58, s58, 32767
  v_mul_f32 v80, v80, v216
  v_mul_f32 v81, v81, v216
  v_mul_f32 v82, v82, v216
  v_mul_f32 v83, v83, v216
  v_mul_f32 v84, v84, v216
  v_mul_f32 v85, v85, v216
  v_mul_f32 v86, v86, v216
  v_mul_f32 v87, v87, v216
  v_cvt_pk_bf16_f32 v136, v80, v81
  v_cvt_pk_bf16_f32 v137, v82, v83
  v_cvt_pk_bf16_f32 v138, v84, v85
  v_cvt_pk_bf16_f32 v139, v86, v87
  s_waitcnt vmcnt(8)
  s_barrier
  s_xor_b32 s72, s57, s70
  s_add_u32 m0, s59, s44
  s_nop 0
  buffer_load_dwordx4 v207, s[28:31], s72 offen nt lds
  s_add_u32 m0, m0, 896
  s_nop 0
  buffer_load_dwordx4 v207, s[28:31], s72 offen offset:128 nt lds
  s_add_u32 s57, s57, 8192
  s_add_u32 s59, s59, 8192
  s_cmp_eq_u32 s59, 49152
  s_cselect_b32 s59, 0, s59
  s_xor_b32 s72, s56, s70
  s_add_u32 m0, s58, s43
  s_nop 0
  buffer_load_dwordx4 v207, s[24:27], s72 offen nt lds
  s_add_u32 m0, m0, 896
  s_nop 0
  buffer_load_dwordx4 v207, s[24:27], s72 offen offset:128 nt lds
  s_add_u32 s56, s56, 8192
  s_add_u32 s58, s58, 8192
  s_and_b32 s58, s58, 32767
  v_mul_f32 v88, v88, v216
  v_mul_f32 v89, v89, v216
  v_mul_f32 v90, v90, v216
  v_mul_f32 v91, v91, v216
  v_mul_f32 v92, v92, v216
  v_mul_f32 v93, v93, v216
  v_mul_f32 v94, v94, v216
  v_mul_f32 v95, v95, v216
  v_cvt_pk_bf16_f32 v140, v88, v89
  v_cvt_pk_bf16_f32 v141, v90, v91
  v_cvt_pk_bf16_f32 v142, v92, v93
  v_cvt_pk_bf16_f32 v143, v94, v95
  v_lshrrev_b32 v220, 4, v214
  s_lshr_b32 s67, s74, 2
  s_lshr_b32 s63, s2, 3
  s_lshl_b32 s63, s63, 15
  s_lshl_b32 s66, s42, 13
  s_add_u32 s63, s63, s66
  s_lshl_b32 s66, s67, 20
  s_add_u32 s63, s63, s66
  v_lshrrev_b32 v221, 3, v220
  v_and_b32 v220, 7, v220
  v_lshlrev_b32 v220, 7, v220
  v_lshl_add_u32 v221, v221, 10, v220
  v_add_u32 v221, s63, v221
  global_load_dword v222, v221, s[12:13]
  s_waitcnt vmcnt(9)
  s_barrier
  s_lshl_b32 s63, s42, 11
  v_add_u32 v218, s63, v214
  v_add_u32 v219, 124928, v218
  v_add_u32 v218, 90112, v218
  v_lshrrev_b32 v144, 4, v214
  v_mov_b32 v146, v214
  s_lshr_b32 s45, s74, 2
  s_and_b32 s46, s74, 3
  v_lshrrev_b32 v154, 3, v144
  v_and_b32 v155, 7, v144
  v_and_b32 v156, 6, v154
  v_xor_b32 v155, v155, v156
  v_lshlrev_b32 v155, 4, v155
  v_lshl_add_u32 v145, v154, 10, v155
  v_bfe_u32 v154, v144, 2, 3
  v_bfe_u32 v155, v144, 1, 1
  v_and_b32 v156, 6, v154
  v_xor_b32 v155, v155, v156
  v_lshlrev_b32 v155, 4, v155
  v_lshl_add_u32 v155, v154, 7, v155
  v_and_b32 v156, 1, v144
  v_lshl_add_u32 v155, v156, 3, v155
  v_lshrrev_b32 v156, 5, v144
  v_lshl_add_u32 v155, v156, 11, v155
  s_and_b32 s63, s42, 1
  s_lshl_b32 s63, s63, 6
  v_xor_b32 v148, s63, v155
  v_xor_b32 v149, 32, v148
  s_lshr_b32 s63, s42, 1
  s_lshl_b32 s63, s63, 10
  v_add_u32 v148, s63, v148
  v_add_u32 v149, s63, v149
  s_mul_i32 s63, s41, 5120
  s_add_u32 s63, s63, 8192
  v_add_u32 v152, s63, v146
  s_mul_i32 s63, s41, 17408
  s_lshl_b32 s66, s42, 11
  s_add_u32 s47, s63, s66
  s_lshl_b32 s63, s41, 15
  s_lshl_b32 s66, s42, 13
  s_add_u32 s51, s63, s66
  s_lshl_b32 s63, s40, 10
  s_add_u32 s3, s63, 8192
  s_add_u32 s100, s3, 17408
  s_lshl_b32 s52, s40, 12
  s_add_u32 s53, s52, 1024
  s_mul_i32 s63, s41, 17408
  s_add_u32 s101, s63, 16384
  s_lshl_b32 s63, s41, 10
  s_add_u32 s54, s63, 32768
  s_lshl_b32 s63, s73, 5
  s_lshl_b32 s66, s45, 3
  s_add_u32 s63, s63, s66
  s_mul_i32 s63, s63, 36864
  s_add_u32 s63, s63, 1048576
  s_add_u32 s20, s18, s63
  s_addc_u32 s21, s19, 0
  s_mov_b32 s22, 294912
  s_mov_b32 s23, 0x20000
  s_lshl_b32 s63, s45, 20
  s_lshl_b32 s66, s46, 8
  s_add_u32 s63, s63, s66
  s_add_u32 s24, s12, s63
  s_addc_u32 s25, s13, 0
  s_sub_u32 s26, 4194304, s63
  s_mov_b32 s27, 0x20000
  s_mul_i32 s66, s73, 147456
  s_lshl_b32 s63, s46, 8
  s_add_u32 s66, s66, s63
  s_add_u32 s28, s14, s66
  s_addc_u32 s29, s15, 0
  s_sub_u32 s30, 147456, s63
  s_mov_b32 s31, 0x20000
  s_lshl_b32 s63, s73, 2
  s_add_u32 s63, s63, s46
  s_mul_i32 s63, s63, 393216
  s_add_u32 s63, s63, 33554432
  s_add_u32 s32, s18, s63
  s_addc_u32 s33, s19, 0
  s_mov_b32 s34, 393216
  s_mov_b32 s35, 0x20000
  s_add_u32 s68, s18, 524288
  s_addc_u32 s69, s19, 0
  s_lshl_b32 s61, s73, 4
  s_add_u32 s61, s61, s74
  s_mov_b32 s58, 81920
  s_lshr_b32 s63, s73, 1
  s_lshl_b32 s63, s63, 2
  v_mov_b32 v158, s63
  global_load_dword v159, v158, s[16:17] sc1
  ds_write_b128 v218, v[96:99] offset:0
  buffer_store_dwordx4 v[96:99], v214, s[36:39], s48 offen offset:0 sc1
  ds_write_b128 v218, v[100:103] offset:17408
  buffer_store_dwordx4 v[100:103], v214, s[36:39], s48 offen offset:1024 sc1
  ds_write_b128 v219, v[104:107] offset:0
  buffer_store_dwordx4 v[104:107], v214, s[36:39], s48 offen offset:2048 sc1
  ds_write_b128 v219, v[108:111] offset:17408
  buffer_store_dwordx4 v[108:111], v214, s[36:39], s48 offen offset:3072 sc1
  s_waitcnt vmcnt(10)
  s_barrier
  ds_write_b128 v218, v[112:115] offset:1024
  buffer_store_dwordx4 v[112:115], v214, s[36:39], s49 offen offset:0 sc1
  ds_write_b128 v218, v[116:119] offset:18432
  buffer_store_dwordx4 v[116:119], v214, s[36:39], s49 offen offset:1024 sc1
  ds_write_b128 v219, v[120:123] offset:1024
  buffer_store_dwordx4 v[120:123], v214, s[36:39], s49 offen offset:2048 sc1
  ds_write_b128 v219, v[124:127] offset:18432
  buffer_store_dwordx4 v[124:127], v214, s[36:39], s49 offen offset:3072 sc1
  s_lshl_b32 s67, s46, 18
  s_add_u32 s67, s67, 0
  s_lshl_b32 s63, s42, 11
  s_add_u32 m0, s63, 81920
  s_lshl_b32 s66, s42, 13
  s_add_u32 s66, s66, s67
  s_add_u32 s66, s66, 0
  buffer_load_dwordx4 v145, s[24:27], s66 offen  lds
  s_add_u32 m0, m0, 896
  s_nop 0
  buffer_load_dwordx4 v145, s[24:27], s66 offen offset:128  lds
  s_lshl_b32 s63, s42, 11
  s_add_u32 m0, s63, 99328
  s_lshl_b32 s66, s42, 13
  s_add_u32 s66, s66, s67
  s_add_u32 s66, s66, 32768
  buffer_load_dwordx4 v145, s[24:27], s66 offen  lds
  s_add_u32 m0, m0, 896
  s_nop 0
  buffer_load_dwordx4 v145, s[24:27], s66 offen offset:128  lds
  s_waitcnt vmcnt(14)
  s_barrier
  ds_write_b128 v218, v[128:131] offset:8192
  buffer_store_dwordx4 v[128:131], v214, s[36:39], s50 offen offset:0 sc1
  ds_write_b128 v218, v[132:135] offset:25600
  buffer_store_dwordx4 v[132:135], v214, s[36:39], s50 offen offset:1024 sc1
  ds_write_b128 v219, v[136:139] offset:8192
  buffer_store_dwordx4 v[136:139], v214, s[36:39], s50 offen offset:2048 sc1
  ds_write_b128 v219, v[140:143] offset:25600
  buffer_store_dwordx4 v[140:143], v214, s[36:39], s50 offen offset:3072 sc1
  s_lshl_b32 s67, s46, 18
  s_add_u32 s67, s67, 65536
  s_lshl_b32 s63, s42, 11
  s_add_u32 m0, s63, 116736
  s_lshl_b32 s66, s42, 13
  s_add_u32 s66, s66, s67
  s_add_u32 s66, s66, 0
  buffer_load_dwordx4 v145, s[24:27], s66 offen  lds
  s_add_u32 m0, m0, 896
  s_nop 0
  buffer_load_dwordx4 v145, s[24:27], s66 offen offset:128  lds
  s_lshl_b32 s63, s42, 11
  s_add_u32 m0, s63, 134144
  s_lshl_b32 s66, s42, 13
  s_add_u32 s66, s66, s67
  s_add_u32 s66, s66, 32768
  buffer_load_dwordx4 v145, s[24:27], s66 offen  lds
  s_add_u32 m0, m0, 896
  s_nop 0
  buffer_load_dwordx4 v145, s[24:27], s66 offen offset:128  lds
  s_barrier
  s_barrier
  s_waitcnt vmcnt(4) lgkmcnt(0)
  s_barrier
  v_mov_b32 v215, 151556
  ds_read_b32 v216, v215
  s_waitcnt lgkmcnt(0)
  v_readfirstlane_b32 s63, v216
  s_cmp_eq_u32 s63, 0
  s_cbranch_scc1 FT3_hB_ok
  s_mov_b32 s63, 0
FT3_hB_loop:
  s_barrier
  s_add_u32 s63, s63, 1
  s_cmp_lt_u32 s63, 64
  s_cbranch_scc1 FT3_hB_loop
FT3_hB_ok:
  s_lshl_b32 s66, s61, 7
  s_add_u32 s66, s66, 0
  v_mov_b32 v154, s66
  v_mov_b32 v155, 1
  s_mov_b64 exec, 1
  global_store_dword v154, v155, s[68:69] sc1
  s_mov_b64 exec, -1
  s_lshl_b32 s67, s46, 18
  s_add_u32 s67, s67, 131072
  s_lshl_b32 s63, s42, 11
  s_add_u32 m0, s63, 12288
  s_lshl_b32 s66, s42, 13
  s_add_u32 s66, s66, s67
  s_add_u32 s66, s66, 0
  buffer_load_dwordx4 v145, s[24:27], s66 offen  lds
  s_add_u32 m0, m0, 896
  s_nop 0
  buffer_load_dwordx4 v145, s[24:27], s66 offen offset:128  lds
  s_lshl_b32 s63, s42, 11
  s_add_u32 m0, s63, 29696
  s_lshl_b32 s66, s42, 13
  s_add_u32 s66, s66, s67
  s_add_u32 s66, s66, 32768
  buffer_load_dwordx4 v145, s[24:27], s66 offen  lds
  s_add_u32 m0, m0, 896
  s_nop 0
  buffer_load_dwordx4 v145, s[24:27], s66 offen offset:128  lds
  s_and_b32 s63, s73, 1
  s_lshl_b32 s63, s63, 4
  s_lshl_b32 s67, 0xffff, s63
  v_readfirstlane_b32 s63, v159
  s_and_b32 s63, s63, s67
  s_cmp_eq_u32 s63, s67
  s_cbranch_scc1 FT3_initok
  s_mov_b32 s60, 0
FT3_init:
  global_load_dword v159, v158, s[16:17] sc1
  s_waitcnt vmcnt(0)
  v_readfirstlane_b32 s63, v159
  s_and_b32 s63, s63, s67
  s_cmp_eq_u32 s63, s67
  s_cbranch_scc1 FT3_initok
  s_add_u32 s60, s60, 1
  s_cmp_gt_u32 s60, 1000000
  s_cbranch_scc1 FT3_initok
  s_sleep 1
  s_branch FT3_init
FT3_initok:
  s_branch F_q0
K1T3_j1:
  s_lshl_b32 s63, s42, 11
  v_add_u32 v218, s63, v214
  v_add_u32 v219, 55296, v218
  v_add_u32 v218, 20480, v218
  v_rcp_f32 v216, v192
  s_nop 0
  v_pk_mul_f32 v[0:1], v[0:1], v[216:217] op_sel_hi:[1,0]
  v_pk_mul_f32 v[2:3], v[2:3], v[216:217] op_sel_hi:[1,0]
  v_pk_mul_f32 v[4:5], v[4:5], v[216:217] op_sel_hi:[1,0]
  v_pk_mul_f32 v[6:7], v[6:7], v[216:217] op_sel_hi:[1,0]
  v_cvt_pk_bf16_f32 v96, v0, v1
  v_cvt_pk_bf16_f32 v97, v2, v3
  v_cvt_pk_bf16_f32 v98, v4, v5
  v_cvt_pk_bf16_f32 v99, v6, v7
  ds_write_b128 v218, v[96:99] offset:0
  buffer_store_dwordx4 v[96:99], v214, s[36:39], s48 offen offset:0 sc1
  v_pk_mul_f32 v[8:9], v[8:9], v[216:217] op_sel_hi:[1,0]
  v_pk_mul_f32 v[10:11], v[10:11], v[216:217] op_sel_hi:[1,0]
  v_pk_mul_f32 v[12:13], v[12:13], v[216:217] op_sel_hi:[1,0]
  v_pk_mul_f32 v[14:15], v[14:15], v[216:217] op_sel_hi:[1,0]
  v_cvt_pk_bf16_f32 v100, v8, v9
  v_cvt_pk_bf16_f32 v101, v10, v11
  v_cvt_pk_bf16_f32 v102, v12, v13
  v_cvt_pk_bf16_f32 v103, v14, v15
  ds_write_b128 v218, v[100:103] offset:17408
  buffer_store_dwordx4 v[100:103], v214, s[36:39], s48 offen offset:1024 sc1
  v_pk_mul_f32 v[16:17], v[16:17], v[216:217] op_sel_hi:[1,0]
  v_pk_mul_f32 v[18:19], v[18:19], v[216:217] op_sel_hi:[1,0]
  v_pk_mul_f32 v[20:21], v[20:21], v[216:217] op_sel_hi:[1,0]
  v_pk_mul_f32 v[22:23], v[22:23], v[216:217] op_sel_hi:[1,0]
  v_cvt_pk_bf16_f32 v104, v16, v17
  v_cvt_pk_bf16_f32 v105, v18, v19
  v_cvt_pk_bf16_f32 v106, v20, v21
  v_cvt_pk_bf16_f32 v107, v22, v23
  ds_write_b128 v219, v[104:107] offset:0
  buffer_store_dwordx4 v[104:107], v214, s[36:39], s48 offen offset:2048 sc1
  v_pk_mul_f32 v[24:25], v[24:25], v[216:217] op_sel_hi:[1,0]
  v_pk_mul_f32 v[26:27], v[26:27], v[216:217] op_sel_hi:[1,0]
  v_pk_mul_f32 v[28:29], v[28:29], v[216:217] op_sel_hi:[1,0]
  v_pk_mul_f32 v[30:31], v[30:31], v[216:217] op_sel_hi:[1,0]
  v_cvt_pk_bf16_f32 v108, v24, v25
  v_cvt_pk_bf16_f32 v109, v26, v27
  v_cvt_pk_bf16_f32 v110, v28, v29
  v_cvt_pk_bf16_f32 v111, v30, v31
  ds_write_b128 v219, v[108:111] offset:17408
  buffer_store_dwordx4 v[108:111], v214, s[36:39], s48 offen offset:3072 sc1
  v_rcp_f32 v216, v193
  s_nop 0
  v_pk_mul_f32 v[32:33], v[32:33], v[216:217] op_sel_hi:[1,0]
  v_pk_mul_f32 v[34:35], v[34:35], v[216:217] op_sel_hi:[1,0]
  v_pk_mul_f32 v[36:37], v[36:37], v[216:217] op_sel_hi:[1,0]
  v_pk_mul_f32 v[38:39], v[38:39], v[216:217] op_sel_hi:[1,0]
  v_cvt_pk_bf16_f32 v112, v32, v33
  v_cvt_pk_bf16_f32 v113, v34, v35
  v_cvt_pk_bf16_f32 v114, v36, v37
  v_cvt_pk_bf16_f32 v115, v38, v39
  ds_write_b128 v218, v[112:115] offset:1024
  buffer_store_dwordx4 v[112:115], v214, s[36:39], s49 offen offset:0 sc1
  v_pk_mul_f32 v[40:41], v[40:41], v[216:217] op_sel_hi:[1,0]
  v_pk_mul_f32 v[42:43], v[42:43], v[216:217] op_sel_hi:[1,0]
  v_pk_mul_f32 v[44:45], v[44:45], v[216:217] op_sel_hi:[1,0]
  v_pk_mul_f32 v[46:47], v[46:47], v[216:217] op_sel_hi:[1,0]
  v_cvt_pk_bf16_f32 v116, v40, v41
  v_cvt_pk_bf16_f32 v117, v42, v43
  v_cvt_pk_bf16_f32 v118, v44, v45
  v_cvt_pk_bf16_f32 v119, v46, v47
  ds_write_b128 v218, v[116:119] offset:18432
  buffer_store_dwordx4 v[116:119], v214, s[36:39], s49 offen offset:1024 sc1
  v_pk_mul_f32 v[48:49], v[48:49], v[216:217] op_sel_hi:[1,0]
  v_pk_mul_f32 v[50:51], v[50:51], v[216:217] op_sel_hi:[1,0]
  v_pk_mul_f32 v[52:53], v[52:53], v[216:217] op_sel_hi:[1,0]
  v_pk_mul_f32 v[54:55], v[54:55], v[216:217] op_sel_hi:[1,0]
  v_cvt_pk_bf16_f32 v120, v48, v49
  v_cvt_pk_bf16_f32 v121, v50, v51
  v_cvt_pk_bf16_f32 v122, v52, v53
  v_cvt_pk_bf16_f32 v123, v54, v55
  ds_write_b128 v219, v[120:123] offset:1024
  buffer_store_dwordx4 v[120:123], v214, s[36:39], s49 offen offset:2048 sc1
  v_pk_mul_f32 v[56:57], v[56:57], v[216:217] op_sel_hi:[1,0]
  v_pk_mul_f32 v[58:59], v[58:59], v[216:217] op_sel_hi:[1,0]
  v_pk_mul_f32 v[60:61], v[60:61], v[216:217] op_sel_hi:[1,0]
  v_pk_mul_f32 v[62:63], v[62:63], v[216:217] op_sel_hi:[1,0]
  v_cvt_pk_bf16_f32 v124, v56, v57
  v_cvt_pk_bf16_f32 v125, v58, v59
  v_cvt_pk_bf16_f32 v126, v60, v61
  v_cvt_pk_bf16_f32 v127, v62, v63
  ds_write_b128 v219, v[124:127] offset:18432
  buffer_store_dwordx4 v[124:127], v214, s[36:39], s49 offen offset:3072 sc1
  v_rcp_f32 v216, v194
  s_nop 0
  v_pk_mul_f32 v[64:65], v[64:65], v[216:217] op_sel_hi:[1,0]
  v_pk_mul_f32 v[66:67], v[66:67], v[216:217] op_sel_hi:[1,0]
  v_pk_mul_f32 v[68:69], v[68:69], v[216:217] op_sel_hi:[1,0]
  v_pk_mul_f32 v[70:71], v[70:71], v[216:217] op_sel_hi:[1,0]
  v_cvt_pk_bf16_f32 v128, v64, v65
  v_cvt_pk_bf16_f32 v129, v66, v67
  v_cvt_pk_bf16_f32 v130, v68, v69
  v_cvt_pk_bf16_f32 v131, v70, v71
  ds_write_b128 v218, v[128:131] offset:2048
  buffer_store_dwordx4 v[128:131], v214, s[36:39], s50 offen offset:0 sc1
  v_pk_mul_f32 v[72:73], v[72:73], v[216:217] op_sel_hi:[1,0]
  v_pk_mul_f32 v[74:75], v[74:75], v[216:217] op_sel_hi:[1,0]
  v_pk_mul_f32 v[76:77], v[76:77], v[216:217] op_sel_hi:[1,0]
  v_pk_mul_f32 v[78:79], v[78:79], v[216:217] op_sel_hi:[1,0]
  v_cvt_pk_bf16_f32 v132, v72, v73
  v_cvt_pk_bf16_f32 v133, v74, v75
  v_cvt_pk_bf16_f32 v134, v76, v77
  v_cvt_pk_bf16_f32 v135, v78, v79
  ds_write_b128 v218, v[132:135] offset:19456
  buffer_store_dwordx4 v[132:135], v214, s[36:39], s50 offen offset:1024 sc1
  v_pk_mul_f32 v[80:81], v[80:81], v[216:217] op_sel_hi:[1,0]
  v_pk_mul_f32 v[82:83], v[82:83], v[216:217] op_sel_hi:[1,0]
  v_pk_mul_f32 v[84:85], v[84:85], v[216:217] op_sel_hi:[1,0]
  v_pk_mul_f32 v[86:87], v[86:87], v[216:217] op_sel_hi:[1,0]
  v_cvt_pk_bf16_f32 v136, v80, v81
  v_cvt_pk_bf16_f32 v137, v82, v83
  v_cvt_pk_bf16_f32 v138, v84, v85
  v_cvt_pk_bf16_f32 v139, v86, v87
  ds_write_b128 v219, v[136:139] offset:2048
  buffer_store_dwordx4 v[136:139], v214, s[36:39], s50 offen offset:2048 sc1
  v_pk_mul_f32 v[88:89], v[88:89], v[216:217] op_sel_hi:[1,0]
  v_pk_mul_f32 v[90:91], v[90:91], v[216:217] op_sel_hi:[1,0]
  v_pk_mul_f32 v[92:93], v[92:93], v[216:217] op_sel_hi:[1,0]
  v_pk_mul_f32 v[94:95], v[94:95], v[216:217] op_sel_hi:[1,0]
  v_cvt_pk_bf16_f32 v140, v88, v89
  v_cvt_pk_bf16_f32 v141, v90, v91
  v_cvt_pk_bf16_f32 v142, v92, v93
  v_cvt_pk_bf16_f32 v143, v94, v95
  ds_write_b128 v219, v[140:143] offset:19456
  buffer_store_dwordx4 v[140:143], v214, s[36:39], s50 offen offset:3072 sc1
  v_lshrrev_b32 v144, 4, v214
  v_mov_b32 v146, v214
  s_lshr_b32 s45, s74, 2
  s_and_b32 s46, s74, 3
  v_lshrrev_b32 v154, 3, v144
  v_and_b32 v155, 7, v144
  v_and_b32 v156, 6, v154
  v_xor_b32 v155, v155, v156
  v_lshlrev_b32 v155, 4, v155
  v_lshl_add_u32 v145, v154, 10, v155
  v_bfe_u32 v154, v144, 2, 3
  v_bfe_u32 v155, v144, 1, 1
  v_and_b32 v156, 6, v154
  v_xor_b32 v155, v155, v156
  v_lshlrev_b32 v155, 4, v155
  v_lshl_add_u32 v155, v154, 7, v155
  v_and_b32 v156, 1, v144
  v_lshl_add_u32 v155, v156, 3, v155
  v_lshrrev_b32 v156, 5, v144
  v_lshl_add_u32 v155, v156, 11, v155
  s_and_b32 s63, s42, 1
  s_lshl_b32 s63, s63, 6
  v_xor_b32 v148, s63, v155
  v_xor_b32 v149, 32, v148
  s_lshr_b32 s63, s42, 1
  s_lshl_b32 s63, s63, 10
  v_add_u32 v148, s63, v148
  v_add_u32 v149, s63, v149
  s_mul_i32 s63, s41, 5120
  s_add_u32 s63, s63, 8192
  v_add_u32 v152, s63, v146
  s_mul_i32 s63, s41, 17408
  s_lshl_b32 s66, s42, 11
  s_add_u32 s47, s63, s66
  s_lshl_b32 s63, s41, 15
  s_lshl_b32 s66, s42, 13
  s_add_u32 s51, s63, s66
  s_lshl_b32 s63, s40, 10
  s_add_u32 s3, s63, 8192
  s_add_u32 s100, s3, 17408
  s_lshl_b32 s52, s40, 12
  s_add_u32 s53, s52, 1024
  s_mul_i32 s63, s41, 17408
  s_add_u32 s101, s63, 16384
  s_lshl_b32 s63, s41, 10
  s_add_u32 s54, s63, 32768
  s_lshl_b32 s63, s73, 5
  s_lshl_b32 s66, s45, 3
  s_add_u32 s63, s63, s66
  s_mul_i32 s63, s63, 36864
  s_add_u32 s63, s63, 1048576
  s_add_u32 s20, s18, s63
  s_addc_u32 s21, s19, 0
  s_mov_b32 s22, 294912
  s_mov_b32 s23, 0x20000
  s_lshl_b32 s63, s45, 20
  s_lshl_b32 s66, s46, 8
  s_add_u32 s63, s63, s66
  s_add_u32 s24, s12, s63
  s_addc_u32 s25, s13, 0
  s_sub_u32 s26, 4194304, s63
  s_mov_b32 s27, 0x20000
  s_mul_i32 s66, s73, 147456
  s_lshl_b32 s63, s46, 8
  s_add_u32 s66, s66, s63
  s_add_u32 s28, s14, s66
  s_addc_u32 s29, s15, 0
  s_sub_u32 s30, 147456, s63
  s_mov_b32 s31, 0x20000
  s_lshl_b32 s63, s73, 2
  s_add_u32 s63, s63, s46
  s_mul_i32 s63, s63, 393216
  s_add_u32 s63, s63, 33554432
  s_add_u32 s32, s18, s63
  s_addc_u32 s33, s19, 0
  s_mov_b32 s34, 393216
  s_mov_b32 s35, 0x20000
  s_add_u32 s68, s18, 524288
  s_addc_u32 s69, s19, 0
  s_lshl_b32 s61, s73, 4
  s_add_u32 s61, s61, s74
  s_mov_b32 s58, 81920
  s_branch F_q1
F_q0:
  v_mov_b64 v[0:1], 0
  v_mov_b64 v[2:3], 0
  v_mov_b64 v[4:5], 0
  v_mov_b64 v[6:7], 0
  v_mov_b64 v[8:9], 0
  v_mov_b64 v[10:11], 0
  v_mov_b64 v[12:13], 0
  v_mov_b64 v[14:15], 0
  v_mov_b64 v[16:17], 0
  v_mov_b64 v[18:19], 0
  v_mov_b64 v[20:21], 0
  v_mov_b64 v[22:23], 0
  v_mov_b64 v[24:25], 0
  v_mov_b64 v[26:27], 0
  v_mov_b64 v[28:29], 0
  v_mov_b64 v[30:31], 0
  v_mov_b64 v[32:33], 0
  v_mov_b64 v[34:35], 0
  v_mov_b64 v[36:37], 0
  v_mov_b64 v[38:39], 0
  v_add_u32 v150, s58, v148
  v_add_u32 v151, s58, v149
  v_add_u32 v153, s58, v152
  s_add_u32 s63, s46, 1
  s_and_b32 s63, s63, 3
  s_mul_i32 s55, s63, 73728
  s_lshl_b32 s56, s63, 18
  s_add_u32 s76, s55, 36864
  s_add_u32 s77, s56, 131072
  s_setprio 1
  s_mov_b32 s57, 81920
  s_waitcnt vmcnt(8)
  s_barrier
  ds_read_b64_tr_b16 a[0:1], v150 offset:0
  ds_read_b64_tr_b16 a[2:3], v150 offset:4096
  ds_read_b64_tr_b16 a[4:5], v151 offset:0
  ds_read_b64_tr_b16 a[6:7], v151 offset:4096
  ds_read_b128 v[40:43], v153 offset:0
  ds_read_b128 v[44:47], v153 offset:1024
  ds_read_b128 v[48:51], v153 offset:2048
  ds_read_b128 v[52:55], v153 offset:3072
  ds_read_b128 v[56:59], v153 offset:4096
  s_waitcnt vmcnt(4)
  s_barrier
  s_waitcnt lgkmcnt(0)
  v_mfma_f32_16x16x32_bf16 v[0:3], a[0:3], v[40:43], v[0:3]
  ds_read_b128 v[60:63], v153 offset:17408
  s_lshl_b32 s67, s46, 18
  s_add_u32 s67, s67, 196608
  s_add_u32 m0, s47, 47104
  s_add_u32 s66, s67, s51
  buffer_load_dwordx4 v145, s[24:27], s66 offen  lds
  v_mfma_f32_16x16x32_bf16 v[4:7], a[4:7], v[40:43], v[4:7]
  ds_read_b64_tr_b16 a[8:9], v150 offset:17408
  v_mfma_f32_16x16x32_bf16 v[8:11], a[0:3], v[44:47], v[8:11]
  ds_read_b64_tr_b16 a[10:11], v150 offset:21504
  v_mfma_f32_16x16x32_bf16 v[12:15], a[4:7], v[44:47], v[12:15]
  ds_read_b64_tr_b16 a[12:13], v151 offset:17408
  v_mfma_f32_16x16x32_bf16 v[16:19], a[0:3], v[48:51], v[16:19]
  ds_read_b64_tr_b16 a[14:15], v151 offset:21504
  s_add_u32 m0, m0, 896
  s_nop 0
  buffer_load_dwordx4 v145, s[24:27], s66 offen offset:128  lds
  v_mfma_f32_16x16x32_bf16 v[20:23], a[4:7], v[48:51], v[20:23]
  ds_read_b128 v[64:67], v153 offset:18432
  v_mfma_f32_16x16x32_bf16 v[24:27], a[0:3], v[52:55], v[24:27]
  ds_read_b128 v[68:71], v153 offset:19456
  v_mfma_f32_16x16x32_bf16 v[28:31], a[4:7], v[52:55], v[28:31]
  ds_read_b128 v[72:75], v153 offset:20480
  v_mfma_f32_16x16x32_bf16 v[32:35], a[0:3], v[56:59], v[32:35]
  ds_read_b128 v[76:79], v153 offset:21504
  v_mfma_f32_16x16x32_bf16 v[36:39], a[4:7], v[56:59], v[36:39]
  s_waitcnt lgkmcnt(0)
  v_mfma_f32_16x16x32_bf16 v[0:3], a[8:11], v[60:63], v[0:3]
  s_add_u32 s58, s58, 34816
  s_cmp_eq_u32 s58, 151552
  s_cselect_b32 s58, 12288, s58
  v_add_u32 v150, s58, v148
  v_add_u32 v151, s58, v149
  v_add_u32 v153, s58, v152
  ds_read_b128 v[40:43], v153 offset:0
  v_mfma_f32_16x16x32_bf16 v[4:7], a[12:15], v[60:63], v[4:7]
  ds_read_b64_tr_b16 a[0:1], v150 offset:0
  v_mfma_f32_16x16x32_bf16 v[8:11], a[8:11], v[64:67], v[8:11]
  ds_read_b64_tr_b16 a[2:3], v150 offset:4096
  v_mfma_f32_16x16x32_bf16 v[12:15], a[12:15], v[64:67], v[12:15]
  ds_read_b64_tr_b16 a[4:5], v151 offset:0
  v_mfma_f32_16x16x32_bf16 v[16:19], a[8:11], v[68:71], v[16:19]
  ds_read_b64_tr_b16 a[6:7], v151 offset:4096
  v_mfma_f32_16x16x32_bf16 v[20:23], a[12:15], v[68:71], v[20:23]
  ds_read_b128 v[44:47], v153 offset:1024
  v_mfma_f32_16x16x32_bf16 v[24:27], a[8:11], v[72:75], v[24:27]
  ds_read_b128 v[48:51], v153 offset:2048
  v_mfma_f32_16x16x32_bf16 v[28:31], a[12:15], v[72:75], v[28:31]
  ds_read_b128 v[52:55], v153 offset:3072
  v_mfma_f32_16x16x32_bf16 v[32:35], a[8:11], v[76:79], v[32:35]
  ds_read_b128 v[56:59], v153 offset:4096
  v_mfma_f32_16x16x32_bf16 v[36:39], a[12:15], v[76:79], v[36:39]
  s_cmp_eq_u32 s42, 0
  s_cbranch_scc0 F_q0_nopollA
  s_and_b32 s72, s61, 4294967292
  v_mul_u32_u24 v154, 128, v144
  s_lshl_b32 s66, s72, 7
  s_add_u32 s66, s66, 0
  v_add_u32 v154, s66, v154
  s_mov_b64 exec, 15
  s_mov_b32 s60, 0
F_pollA:
  global_load_dword v155, v154, s[68:69] sc1
  s_waitcnt vmcnt(0)
  v_cmp_eq_u32 vcc, 1, v155
  s_nop 1
  s_cmp_eq_u64 vcc, 15
  s_cbranch_scc1 F_pollA_ok
  s_add_u32 s60, s60, 1
  s_cmp_gt_u32 s60, 1000000
  s_cbranch_scc1 F_pollA_ok
  s_sleep 1
  s_branch F_pollA
F_pollA_ok:
  s_mov_b64 exec, -1
F_q0_nopollA:
  s_waitcnt vmcnt(2)
  s_barrier
  s_waitcnt lgkmcnt(0)
  v_mfma_f32_16x16x32_bf16 v[0:3], a[0:3], v[40:43], v[0:3]
  ds_read_b128 v[60:63], v153 offset:17408
  s_add_u32 m0, s57, s47
  s_add_u32 s66, s56, s51
  buffer_load_dwordx4 v145, s[24:27], s66 offen  lds
  v_mfma_f32_16x16x32_bf16 v[4:7], a[4:7], v[40:43], v[4:7]
  ds_read_b64_tr_b16 a[8:9], v150 offset:17408
  v_mfma_f32_16x16x32_bf16 v[8:11], a[0:3], v[44:47], v[8:11]
  ds_read_b64_tr_b16 a[10:11], v150 offset:21504
  s_add_u32 m0, m0, 896
  s_nop 0
  buffer_load_dwordx4 v145, s[24:27], s66 offen offset:128  lds
  v_mfma_f32_16x16x32_bf16 v[12:15], a[4:7], v[44:47], v[12:15]
  ds_read_b64_tr_b16 a[12:13], v151 offset:17408
  v_mfma_f32_16x16x32_bf16 v[16:19], a[0:3], v[48:51], v[16:19]
  ds_read_b64_tr_b16 a[14:15], v151 offset:21504
  s_add_u32 m0, s57, s3
  s_add_u32 s66, s55, s52
  buffer_load_dwordx4 v146, s[20:23], s66 offen  lds
  v_mfma_f32_16x16x32_bf16 v[20:23], a[4:7], v[48:51], v[20:23]
  ds_read_b128 v[64:67], v153 offset:18432
  v_mfma_f32_16x16x32_bf16 v[24:27], a[0:3], v[52:55], v[24:27]
  ds_read_b128 v[68:71], v153 offset:19456
  v_mfma_f32_16x16x32_bf16 v[28:31], a[4:7], v[52:55], v[28:31]
  ds_read_b128 v[72:75], v153 offset:20480
  s_add_u32 m0, s57, s100
  s_add_u32 s66, s55, s53
  buffer_load_dwordx4 v146, s[20:23], s66 offen  lds
  v_mfma_f32_16x16x32_bf16 v[32:35], a[0:3], v[56:59], v[32:35]
  ds_read_b128 v[76:79], v153 offset:21504
  v_mfma_f32_16x16x32_bf16 v[36:39], a[4:7], v[56:59], v[36:39]
  s_cmp_eq_u32 s42, 0
  s_cbranch_scc0 F_q0_a1_x8
  s_add_u32 m0, s57, s101
  s_add_u32 s66, s55, s54
  buffer_load_dwordx4 v146, s[20:23], s66 offen  lds
F_q0_a1_x8:
  s_add_u32 s55, s55, 2048
  s_add_u32 s56, s56, 65536
  s_add_u32 s57, s57, 34816
  s_cmp_eq_u32 s57, 151552
  s_cselect_b32 s57, 12288, s57
  s_waitcnt lgkmcnt(0)
  v_mfma_f32_16x16x32_bf16 v[0:3], a[8:11], v[60:63], v[0:3]
  s_add_u32 s58, s58, 34816
  s_cmp_eq_u32 s58, 151552
  s_cselect_b32 s58, 12288, s58
  v_add_u32 v150, s58, v148
  v_add_u32 v151, s58, v149
  v_add_u32 v153, s58, v152
  ds_read_b128 v[40:43], v153 offset:0
  v_mfma_f32_16x16x32_bf16 v[4:7], a[12:15], v[60:63], v[4:7]
  ds_read_b64_tr_b16 a[0:1], v150 offset:0
  v_mfma_f32_16x16x32_bf16 v[8:11], a[8:11], v[64:67], v[8:11]
  ds_read_b64_tr_b16 a[2:3], v150 offset:4096
  v_mfma_f32_16x16x32_bf16 v[12:15], a[12:15], v[64:67], v[12:15]
  ds_read_b64_tr_b16 a[4:5], v151 offset:0
  v_mfma_f32_16x16x32_bf16 v[16:19], a[8:11], v[68:71], v[16:19]
  ds_read_b64_tr_b16 a[6:7], v151 offset:4096
  v_mfma_f32_16x16x32_bf16 v[20:23], a[12:15], v[68:71], v[20:23]
  ds_read_b128 v[44:47], v153 offset:1024
  v_mfma_f32_16x16x32_bf16 v[24:27], a[8:11], v[72:75], v[24:27]
  ds_read_b128 v[48:51], v153 offset:2048
  v_mfma_f32_16x16x32_bf16 v[28:31], a[12:15], v[72:75], v[28:31]
  ds_read_b128 v[52:55], v153 offset:3072
  v_mfma_f32_16x16x32_bf16 v[32:35], a[8:11], v[76:79], v[32:35]
  ds_read_b128 v[56:59], v153 offset:4096
  v_mfma_f32_16x16x32_bf16 v[36:39], a[12:15], v[76:79], v[36:39]
  s_mov_b32 s62, 0
F_q0_loop:
  s_waitcnt vmcnt(4)
  s_barrier
  s_waitcnt lgkmcnt(0)
  v_mfma_f32_16x16x32_bf16 v[0:3], a[0:3], v[40:43], v[0:3]
  ds_read_b128 v[60:63], v153 offset:17408
  s_add_u32 m0, s57, s47
  s_add_u32 s66, s56, s51
  buffer_load_dwordx4 v145, s[24:27], s66 offen  lds
  v_mfma_f32_16x16x32_bf16 v[4:7], a[4:7], v[40:43], v[4:7]
  ds_read_b64_tr_b16 a[8:9], v150 offset:17408
  v_mfma_f32_16x16x32_bf16 v[8:11], a[0:3], v[44:47], v[8:11]
  ds_read_b64_tr_b16 a[10:11], v150 offset:21504
  s_add_u32 m0, m0, 896
  s_nop 0
  buffer_load_dwordx4 v145, s[24:27], s66 offen offset:128  lds
  v_mfma_f32_16x16x32_bf16 v[12:15], a[4:7], v[44:47], v[12:15]
  ds_read_b64_tr_b16 a[12:13], v151 offset:17408
  v_mfma_f32_16x16x32_bf16 v[16:19], a[0:3], v[48:51], v[16:19]
  ds_read_b64_tr_b16 a[14:15], v151 offset:21504
  s_add_u32 m0, s57, s3
  s_add_u32 s66, s55, s52
  buffer_load_dwordx4 v146, s[20:23], s66 offen  lds
  v_mfma_f32_16x16x32_bf16 v[20:23], a[4:7], v[48:51], v[20:23]
  ds_read_b128 v[64:67], v153 offset:18432
  v_mfma_f32_16x16x32_bf16 v[24:27], a[0:3], v[52:55], v[24:27]
  ds_read_b128 v[68:71], v153 offset:19456
  v_mfma_f32_16x16x32_bf16 v[28:31], a[4:7], v[52:55], v[28:31]
  ds_read_b128 v[72:75], v153 offset:20480
  s_add_u32 m0, s57, s100
  s_add_u32 s66, s55, s53
  buffer_load_dwordx4 v146, s[20:23], s66 offen  lds
  v_mfma_f32_16x16x32_bf16 v[32:35], a[0:3], v[56:59], v[32:35]
  ds_read_b128 v[76:79], v153 offset:21504
  v_mfma_f32_16x16x32_bf16 v[36:39], a[4:7], v[56:59], v[36:39]
  s_cmp_eq_u32 s42, 0
  s_cbranch_scc0 F_q0_s0_x8
  s_add_u32 m0, s57, s101
  s_add_u32 s66, s55, s54
  buffer_load_dwordx4 v146, s[20:23], s66 offen  lds
F_q0_s0_x8:
  s_add_u32 s55, s55, 71680
  s_sub_u32 s63, s55, 294912
  s_cmp_ge_u32 s55, 294912
  s_cselect_b32 s55, s63, s55
  s_add_u32 s56, s56, 196608
  s_and_b32 s56, s56, 1048575
  s_cmp_eq_u32 s62, 2
  s_cselect_b32 s55, s76, s55
  s_cselect_b32 s56, s77, s56
  s_add_u32 s57, s57, 34816
  s_cmp_eq_u32 s57, 151552
  s_cselect_b32 s57, 12288, s57
  s_waitcnt lgkmcnt(0)
  v_mfma_f32_16x16x32_bf16 v[0:3], a[8:11], v[60:63], v[0:3]
  s_add_u32 s58, s58, 34816
  s_cmp_eq_u32 s58, 151552
  s_cselect_b32 s58, 12288, s58
  v_add_u32 v150, s58, v148
  v_add_u32 v151, s58, v149
  v_add_u32 v153, s58, v152
  ds_read_b128 v[40:43], v153 offset:0
  v_mfma_f32_16x16x32_bf16 v[4:7], a[12:15], v[60:63], v[4:7]
  ds_read_b64_tr_b16 a[0:1], v150 offset:0
  v_mfma_f32_16x16x32_bf16 v[8:11], a[8:11], v[64:67], v[8:11]
  ds_read_b64_tr_b16 a[2:3], v150 offset:4096
  v_mfma_f32_16x16x32_bf16 v[12:15], a[12:15], v[64:67], v[12:15]
  ds_read_b64_tr_b16 a[4:5], v151 offset:0
  v_mfma_f32_16x16x32_bf16 v[16:19], a[8:11], v[68:71], v[16:19]
  ds_read_b64_tr_b16 a[6:7], v151 offset:4096
  v_mfma_f32_16x16x32_bf16 v[20:23], a[12:15], v[68:71], v[20:23]
  ds_read_b128 v[44:47], v153 offset:1024
  v_mfma_f32_16x16x32_bf16 v[24:27], a[8:11], v[72:75], v[24:27]
  ds_read_b128 v[48:51], v153 offset:2048
  v_mfma_f32_16x16x32_bf16 v[28:31], a[12:15], v[72:75], v[28:31]
  ds_read_b128 v[52:55], v153 offset:3072
  v_mfma_f32_16x16x32_bf16 v[32:35], a[8:11], v[76:79], v[32:35]
  ds_read_b128 v[56:59], v153 offset:4096
  v_mfma_f32_16x16x32_bf16 v[36:39], a[12:15], v[76:79], v[36:39]
  s_cmp_eq_u32 s62, 2
  s_cselect_b32 s63, s42, 1
  s_cmp_eq_u32 s63, 0
  s_cbranch_scc0 F_q0_nopoll
  s_and_b32 s72, s61, 4294967292
  v_mul_u32_u24 v154, 128, v144
  s_lshl_b32 s66, s72, 7
  s_add_u32 s66, s66, 4
  v_add_u32 v154, s66, v154
  s_mov_b64 exec, 15
  s_mov_b32 s60, 0
F_pollB:
  global_load_dword v155, v154, s[68:69] sc1
  s_waitcnt vmcnt(0)
  v_cmp_eq_u32 vcc, 1, v155
  s_nop 1
  s_cmp_eq_u64 vcc, 15
  s_cbranch_scc1 F_pollB_ok
  s_add_u32 s60, s60, 1
  s_cmp_gt_u32 s60, 1000000
  s_cbranch_scc1 F_pollB_ok
  s_sleep 1
  s_branch F_pollB
F_pollB_ok:
  s_mov_b64 exec, -1
F_q0_nopoll:
  s_waitcnt vmcnt(4)
  s_barrier
  s_waitcnt lgkmcnt(0)
  v_mfma_f32_16x16x32_bf16 v[0:3], a[0:3], v[40:43], v[0:3]
  ds_read_b128 v[60:63], v153 offset:17408
  s_add_u32 m0, s57, s47
  s_add_u32 s66, s56, s51
  buffer_load_dwordx4 v145, s[24:27], s66 offen  lds
  v_mfma_f32_16x16x32_bf16 v[4:7], a[4:7], v[40:43], v[4:7]
  ds_read_b64_tr_b16 a[8:9], v150 offset:17408
  v_mfma_f32_16x16x32_bf16 v[8:11], a[0:3], v[44:47], v[8:11]
  ds_read_b64_tr_b16 a[10:11], v150 offset:21504
  s_add_u32 m0, m0, 896
  s_nop 0
  buffer_load_dwordx4 v145, s[24:27], s66 offen offset:128  lds
  v_mfma_f32_16x16x32_bf16 v[12:15], a[4:7], v[44:47], v[12:15]
  ds_read_b64_tr_b16 a[12:13], v151 offset:17408
  v_mfma_f32_16x16x32_bf16 v[16:19], a[0:3], v[48:51], v[16:19]
  ds_read_b64_tr_b16 a[14:15], v151 offset:21504
  s_add_u32 m0, s57, s3
  s_add_u32 s66, s55, s52
  buffer_load_dwordx4 v146, s[20:23], s66 offen  lds
  v_mfma_f32_16x16x32_bf16 v[20:23], a[4:7], v[48:51], v[20:23]
  ds_read_b128 v[64:67], v153 offset:18432
  v_mfma_f32_16x16x32_bf16 v[24:27], a[0:3], v[52:55], v[24:27]
  ds_read_b128 v[68:71], v153 offset:19456
  v_mfma_f32_16x16x32_bf16 v[28:31], a[4:7], v[52:55], v[28:31]
  ds_read_b128 v[72:75], v153 offset:20480
  s_add_u32 m0, s57, s100
  s_add_u32 s66, s55, s53
  buffer_load_dwordx4 v146, s[20:23], s66 offen  lds
  v_mfma_f32_16x16x32_bf16 v[32:35], a[0:3], v[56:59], v[32:35]
  ds_read_b128 v[76:79], v153 offset:21504
  v_mfma_f32_16x16x32_bf16 v[36:39], a[4:7], v[56:59], v[36:39]
  s_cmp_eq_u32 s42, 0
  s_cbranch_scc0 F_q0_s1_x8
  s_add_u32 m0, s57, s101
  s_add_u32 s66, s55, s54
  buffer_load_dwordx4 v146, s[20:23], s66 offen  lds
F_q0_s1_x8:
  s_add_u32 s55, s55, 2048
  s_add_u32 s56, s56, 65536
  s_add_u32 s57, s57, 34816
  s_cmp_eq_u32 s57, 151552
  s_cselect_b32 s57, 12288, s57
  s_waitcnt lgkmcnt(0)
  v_mfma_f32_16x16x32_bf16 v[0:3], a[8:11], v[60:63], v[0:3]
  s_add_u32 s58, s58, 34816
  s_cmp_eq_u32 s58, 151552
  s_cselect_b32 s58, 12288, s58
  v_add_u32 v150, s58, v148
  v_add_u32 v151, s58, v149
  v_add_u32 v153, s58, v152
  ds_read_b128 v[40:43], v153 offset:0
  v_mfma_f32_16x16x32_bf16 v[4:7], a[12:15], v[60:63], v[4:7]
  ds_read_b64_tr_b16 a[0:1], v150 offset:0
  v_mfma_f32_16x16x32_bf16 v[8:11], a[8:11], v[64:67], v[8:11]
  ds_read_b64_tr_b16 a[2:3], v150 offset:4096
  v_mfma_f32_16x16x32_bf16 v[12:15], a[12:15], v[64:67], v[12:15]
  ds_read_b64_tr_b16 a[4:5], v151 offset:0
  v_mfma_f32_16x16x32_bf16 v[16:19], a[8:11], v[68:71], v[16:19]
  ds_read_b64_tr_b16 a[6:7], v151 offset:4096
  v_mfma_f32_16x16x32_bf16 v[20:23], a[12:15], v[68:71], v[20:23]
  ds_read_b128 v[44:47], v153 offset:1024
  v_mfma_f32_16x16x32_bf16 v[24:27], a[8:11], v[72:75], v[24:27]
  ds_read_b128 v[48:51], v153 offset:2048
  v_mfma_f32_16x16x32_bf16 v[28:31], a[12:15], v[72:75], v[28:31]
  ds_read_b128 v[52:55], v153 offset:3072
  v_mfma_f32_16x16x32_bf16 v[32:35], a[8:11], v[76:79], v[32:35]
  ds_read_b128 v[56:59], v153 offset:4096
  v_mfma_f32_16x16x32_bf16 v[36:39], a[12:15], v[76:79], v[36:39]
  s_add_u32 s62, s62, 1
  s_cmp_lt_u32 s62, 5
  s_cbranch_scc1 F_q0_loop
  s_waitcnt vmcnt(4)
  s_barrier
  s_waitcnt lgkmcnt(0)
  v_mfma_f32_16x16x32_bf16 v[0:3], a[0:3], v[40:43], v[0:3]
  ds_read_b128 v[60:63], v153 offset:17408
  s_add_u32 m0, s57, s47
  s_add_u32 s66, s56, s51
  buffer_load_dwordx4 v145, s[24:27], s66 offen  lds
  v_mfma_f32_16x16x32_bf16 v[4:7], a[4:7], v[40:43], v[4:7]
  ds_read_b64_tr_b16 a[8:9], v150 offset:17408
  v_mfma_f32_16x16x32_bf16 v[8:11], a[0:3], v[44:47], v[8:11]
  ds_read_b64_tr_b16 a[10:11], v150 offset:21504
  s_add_u32 m0, m0, 896
  s_nop 0
  buffer_load_dwordx4 v145, s[24:27], s66 offen offset:128  lds
  v_mfma_f32_16x16x32_bf16 v[12:15], a[4:7], v[44:47], v[12:15]
  ds_read_b64_tr_b16 a[12:13], v151 offset:17408
  v_mfma_f32_16x16x32_bf16 v[16:19], a[0:3], v[48:51], v[16:19]
  ds_read_b64_tr_b16 a[14:15], v151 offset:21504
  s_add_u32 m0, s57, s3
  s_add_u32 s66, s55, s52
  buffer_load_dwordx4 v146, s[20:23], s66 offen  lds
  v_mfma_f32_16x16x32_bf16 v[20:23], a[4:7], v[48:51], v[20:23]
  ds_read_b128 v[64:67], v153 offset:18432
  v_mfma_f32_16x16x32_bf16 v[24:27], a[0:3], v[52:55], v[24:27]
  ds_read_b128 v[68:71], v153 offset:19456
  v_mfma_f32_16x16x32_bf16 v[28:31], a[4:7], v[52:55], v[28:31]
  ds_read_b128 v[72:75], v153 offset:20480
  s_add_u32 m0, s57, s100
  s_add_u32 s66, s55, s53
  buffer_load_dwordx4 v146, s[20:23], s66 offen  lds
  v_mfma_f32_16x16x32_bf16 v[32:35], a[0:3], v[56:59], v[32:35]
  ds_read_b128 v[76:79], v153 offset:21504
  v_mfma_f32_16x16x32_bf16 v[36:39], a[4:7], v[56:59], v[36:39]
  s_cmp_eq_u32 s42, 0
  s_cbranch_scc0 F_q0_p12_x8
  s_add_u32 m0, s57, s101
  s_add_u32 s66, s55, s54
  buffer_load_dwordx4 v146, s[20:23], s66 offen  lds
F_q0_p12_x8:
  s_add_u32 s55, s55, 71680
  s_sub_u32 s63, s55, 294912
  s_cmp_ge_u32 s55, 294912
  s_cselect_b32 s55, s63, s55
  s_add_u32 s56, s56, 196608
  s_and_b32 s56, s56, 1048575
  s_add_u32 s57, s57, 34816
  s_cmp_eq_u32 s57, 151552
  s_cselect_b32 s57, 12288, s57
  s_waitcnt lgkmcnt(0)
  v_mfma_f32_16x16x32_bf16 v[0:3], a[8:11], v[60:63], v[0:3]
  s_add_u32 s58, s58, 34816
  s_cmp_eq_u32 s58, 151552
  s_cselect_b32 s58, 12288, s58
  v_add_u32 v150, s58, v148
  v_add_u32 v151, s58, v149
  v_add_u32 v153, s58, v152
  ds_read_b128 v[40:43], v153 offset:0
  v_mfma_f32_16x16x32_bf16 v[4:7], a[12:15], v[60:63], v[4:7]
  ds_read_b64_tr_b16 a[0:1], v150 offset:0
  v_mfma_f32_16x16x32_bf16 v[8:11], a[8:11], v[64:67], v[8:11]
  ds_read_b64_tr_b16 a[2:3], v150 offset:4096
  v_mfma_f32_16x16x32_bf16 v[12:15], a[12:15], v[64:67], v[12:15]
  ds_read_b64_tr_b16 a[4:5], v151 offset:0
  v_mfma_f32_16x16x32_bf16 v[16:19], a[8:11], v[68:71], v[16:19]
  ds_read_b64_tr_b16 a[6:7], v151 offset:4096
  v_mfma_f32_16x16x32_bf16 v[20:23], a[12:15], v[68:71], v[20:23]
  ds_read_b128 v[44:47], v153 offset:1024
  v_mfma_f32_16x16x32_bf16 v[24:27], a[8:11], v[72:75], v[24:27]
  ds_read_b128 v[48:51], v153 offset:2048
  v_mfma_f32_16x16x32_bf16 v[28:31], a[12:15], v[72:75], v[28:31]
  ds_read_b128 v[52:55], v153 offset:3072
  v_mfma_f32_16x16x32_bf16 v[32:35], a[8:11], v[76:79], v[32:35]
  ds_read_b128 v[56:59], v153 offset:4096
  v_mfma_f32_16x16x32_bf16 v[36:39], a[12:15], v[76:79], v[36:39]
  s_waitcnt vmcnt(4)
  s_barrier
  s_waitcnt lgkmcnt(0)
  v_mfma_f32_16x16x32_bf16 v[0:3], a[0:3], v[40:43], v[0:3]
  ds_read_b128 v[60:63], v153 offset:17408
  v_mfma_f32_16x16x32_bf16 v[4:7], a[4:7], v[40:43], v[4:7]
  ds_read_b64_tr_b16 a[8:9], v150 offset:17408
  v_mfma_f32_16x16x32_bf16 v[8:11], a[0:3], v[44:47], v[8:11]
  ds_read_b64_tr_b16 a[10:11], v150 offset:21504
  v_mfma_f32_16x16x32_bf16 v[12:15], a[4:7], v[44:47], v[12:15]
  ds_read_b64_tr_b16 a[12:13], v151 offset:17408
  v_mfma_f32_16x16x32_bf16 v[16:19], a[0:3], v[48:51], v[16:19]
  ds_read_b64_tr_b16 a[14:15], v151 offset:21504
  v_mfma_f32_16x16x32_bf16 v[20:23], a[4:7], v[48:51], v[20:23]
  ds_read_b128 v[64:67], v153 offset:18432
  v_mfma_f32_16x16x32_bf16 v[24:27], a[0:3], v[52:55], v[24:27]
  ds_read_b128 v[68:71], v153 offset:19456
  v_mfma_f32_16x16x32_bf16 v[28:31], a[4:7], v[52:55], v[28:31]
  ds_read_b128 v[72:75], v153 offset:20480
  v_mfma_f32_16x16x32_bf16 v[32:35], a[0:3], v[56:59], v[32:35]
  ds_read_b128 v[76:79], v153 offset:21504
  v_mfma_f32_16x16x32_bf16 v[36:39], a[4:7], v[56:59], v[36:39]
  s_waitcnt lgkmcnt(0)
  v_mfma_f32_16x16x32_bf16 v[0:3], a[8:11], v[60:63], v[0:3]
  s_add_u32 s58, s58, 34816
  s_cmp_eq_u32 s58, 151552
  s_cselect_b32 s58, 12288, s58
  v_add_u32 v150, s58, v148
  v_add_u32 v151, s58, v149
  v_add_u32 v153, s58, v152
  ds_read_b128 v[40:43], v153 offset:0
  v_mfma_f32_16x16x32_bf16 v[4:7], a[12:15], v[60:63], v[4:7]
  ds_read_b64_tr_b16 a[0:1], v150 offset:0
  v_mfma_f32_16x16x32_bf16 v[8:11], a[8:11], v[64:67], v[8:11]
  ds_read_b64_tr_b16 a[2:3], v150 offset:4096
  v_mfma_f32_16x16x32_bf16 v[12:15], a[12:15], v[64:67], v[12:15]
  ds_read_b64_tr_b16 a[4:5], v151 offset:0
  v_mfma_f32_16x16x32_bf16 v[16:19], a[8:11], v[68:71], v[16:19]
  ds_read_b64_tr_b16 a[6:7], v151 offset:4096
  v_mfma_f32_16x16x32_bf16 v[20:23], a[12:15], v[68:71], v[20:23]
  ds_read_b128 v[44:47], v153 offset:1024
  v_mfma_f32_16x16x32_bf16 v[24:27], a[8:11], v[72:75], v[24:27]
  ds_read_b128 v[48:51], v153 offset:2048
  v_mfma_f32_16x16x32_bf16 v[28:31], a[12:15], v[72:75], v[28:31]
  ds_read_b128 v[52:55], v153 offset:3072
  v_mfma_f32_16x16x32_bf16 v[32:35], a[8:11], v[76:79], v[32:35]
  ds_read_b128 v[56:59], v153 offset:4096
  v_mfma_f32_16x16x32_bf16 v[36:39], a[12:15], v[76:79], v[36:39]
  s_waitcnt vmcnt(0)
  s_barrier
  s_waitcnt lgkmcnt(0)
  v_mfma_f32_16x16x32_bf16 v[0:3], a[0:3], v[40:43], v[0:3]
  ds_read_b128 v[60:63], v153 offset:17408
  v_mfma_f32_16x16x32_bf16 v[4:7], a[4:7], v[40:43], v[4:7]
  ds_read_b64_tr_b16 a[8:9], v150 offset:17408
  v_mfma_f32_16x16x32_bf16 v[8:11], a[0:3], v[44:47], v[8:11]
  ds_read_b64_tr_b16 a[10:11], v150 offset:21504
  v_mfma_f32_16x16x32_bf16 v[12:15], a[4:7], v[44:47], v[12:15]
  ds_read_b64_tr_b16 a[12:13], v151 offset:17408
  v_mfma_f32_16x16x32_bf16 v[16:19], a[0:3], v[48:51], v[16:19]
  ds_read_b64_tr_b16 a[14:15], v151 offset:21504
  v_mfma_f32_16x16x32_bf16 v[20:23], a[4:7], v[48:51], v[20:23]
  ds_read_b128 v[64:67], v153 offset:18432
  v_mfma_f32_16x16x32_bf16 v[24:27], a[0:3], v[52:55], v[24:27]
  ds_read_b128 v[68:71], v153 offset:19456
  v_mfma_f32_16x16x32_bf16 v[28:31], a[4:7], v[52:55], v[28:31]
  ds_read_b128 v[72:75], v153 offset:20480
  v_mfma_f32_16x16x32_bf16 v[32:35], a[0:3], v[56:59], v[32:35]
  ds_read_b128 v[76:79], v153 offset:21504
  v_mfma_f32_16x16x32_bf16 v[36:39], a[4:7], v[56:59], v[36:39]
  s_waitcnt lgkmcnt(0)
  v_mfma_f32_16x16x32_bf16 v[0:3], a[8:11], v[60:63], v[0:3]
  s_add_u32 s58, s58, 34816
  s_cmp_eq_u32 s58, 151552
  s_cselect_b32 s58, 12288, s58
  v_add_u32 v150, s58, v148
  v_add_u32 v151, s58, v149
  v_add_u32 v153, s58, v152
  ds_read_b128 v[40:43], v153 offset:0
  v_mfma_f32_16x16x32_bf16 v[4:7], a[12:15], v[60:63], v[4:7]
  ds_read_b64_tr_b16 a[0:1], v150 offset:0
  v_mfma_f32_16x16x32_bf16 v[8:11], a[8:11], v[64:67], v[8:11]
  ds_read_b64_tr_b16 a[2:3], v150 offset:4096
  v_mfma_f32_16x16x32_bf16 v[12:15], a[12:15], v[64:67], v[12:15]
  ds_read_b64_tr_b16 a[4:5], v151 offset:0
  v_mfma_f32_16x16x32_bf16 v[16:19], a[8:11], v[68:71], v[16:19]
  ds_read_b64_tr_b16 a[6:7], v151 offset:4096
  v_mfma_f32_16x16x32_bf16 v[20:23], a[12:15], v[68:71], v[20:23]
  ds_read_b128 v[44:47], v153 offset:1024
  v_mfma_f32_16x16x32_bf16 v[24:27], a[8:11], v[72:75], v[24:27]
  ds_read_b128 v[48:51], v153 offset:2048
  v_mfma_f32_16x16x32_bf16 v[28:31], a[12:15], v[72:75], v[28:31]
  ds_read_b128 v[52:55], v153 offset:3072
  v_mfma_f32_16x16x32_bf16 v[32:35], a[8:11], v[76:79], v[32:35]
  ds_read_b128 v[56:59], v153 offset:4096
  v_mfma_f32_16x16x32_bf16 v[36:39], a[12:15], v[76:79], v[36:39]
  s_barrier
  s_waitcnt lgkmcnt(0)
  v_mfma_f32_16x16x32_bf16 v[0:3], a[0:3], v[40:43], v[0:3]
  ds_read_b128 v[60:63], v153 offset:17408
  v_mfma_f32_16x16x32_bf16 v[4:7], a[4:7], v[40:43], v[4:7]
  ds_read_b64_tr_b16 a[8:9], v150 offset:17408
  v_mfma_f32_16x16x32_bf16 v[8:11], a[0:3], v[44:47], v[8:11]
  ds_read_b64_tr_b16 a[10:11], v150 offset:21504
  v_mfma_f32_16x16x32_bf16 v[12:15], a[4:7], v[44:47], v[12:15]
  ds_read_b64_tr_b16 a[12:13], v151 offset:17408
  v_mfma_f32_16x16x32_bf16 v[16:19], a[0:3], v[48:51], v[16:19]
  ds_read_b64_tr_b16 a[14:15], v151 offset:21504
  v_mfma_f32_16x16x32_bf16 v[20:23], a[4:7], v[48:51], v[20:23]
  ds_read_b128 v[64:67], v153 offset:18432
  v_mfma_f32_16x16x32_bf16 v[24:27], a[0:3], v[52:55], v[24:27]
  ds_read_b128 v[68:71], v153 offset:19456
  v_mfma_f32_16x16x32_bf16 v[28:31], a[4:7], v[52:55], v[28:31]
  ds_read_b128 v[72:75], v153 offset:20480
  v_mfma_f32_16x16x32_bf16 v[32:35], a[0:3], v[56:59], v[32:35]
  ds_read_b128 v[76:79], v153 offset:21504
  v_mfma_f32_16x16x32_bf16 v[36:39], a[4:7], v[56:59], v[36:39]
  s_waitcnt lgkmcnt(0)
  v_mfma_f32_16x16x32_bf16 v[0:3], a[8:11], v[60:63], v[0:3]
  v_mfma_f32_16x16x32_bf16 v[4:7], a[12:15], v[60:63], v[4:7]
  v_mfma_f32_16x16x32_bf16 v[8:11], a[8:11], v[64:67], v[8:11]
  v_mfma_f32_16x16x32_bf16 v[12:15], a[12:15], v[64:67], v[12:15]
  v_mfma_f32_16x16x32_bf16 v[16:19], a[8:11], v[68:71], v[16:19]
  v_mfma_f32_16x16x32_bf16 v[20:23], a[12:15], v[68:71], v[20:23]
  v_mfma_f32_16x16x32_bf16 v[24:27], a[8:11], v[72:75], v[24:27]
  v_mfma_f32_16x16x32_bf16 v[28:31], a[12:15], v[72:75], v[28:31]
  v_mfma_f32_16x16x32_bf16 v[32:35], a[8:11], v[76:79], v[32:35]
  v_mfma_f32_16x16x32_bf16 v[36:39], a[12:15], v[76:79], v[36:39]
  s_nop 7
  v_lshrrev_b32 v157, 1, v146
  s_mul_i32 s67, s45, 12288
  s_mul_i32 s66, s40, 1536
  s_add_u32 s67, s67, s66
  s_cmp_eq_u32 s45, 1
  s_cbranch_scc1 F_q0_kk1
  s_cmp_eq_u32 s45, 2
  s_cbranch_scc1 F_q0_kk2
  s_cmp_eq_u32 s45, 3
  s_cbranch_scc1 F_q0_kk3
F_q0_kk0:
  s_add_u32 s66, s67, 49152
  v_cvt_pk_bf16_f32 v96, v4, v5
  v_cvt_pk_bf16_f32 v97, v6, v7
  buffer_store_dwordx2 v[96:97], v157, s[32:35], s66 offen sc1
  s_add_u32 s66, s67, 98304
  v_cvt_pk_bf16_f32 v98, v8, v9
  v_cvt_pk_bf16_f32 v99, v10, v11
  buffer_store_dwordx2 v[98:99], v157, s[32:35], s66 offen sc1
  s_add_u32 s66, s67, 147456
  v_cvt_pk_bf16_f32 v100, v12, v13
  v_cvt_pk_bf16_f32 v101, v14, v15
  buffer_store_dwordx2 v[100:101], v157, s[32:35], s66 offen sc1
  s_add_u32 s66, s67, 49664
  v_cvt_pk_bf16_f32 v102, v20, v21
  v_cvt_pk_bf16_f32 v103, v22, v23
  buffer_store_dwordx2 v[102:103], v157, s[32:35], s66 offen sc1
  s_add_u32 s66, s67, 98816
  v_cvt_pk_bf16_f32 v104, v24, v25
  v_cvt_pk_bf16_f32 v105, v26, v27
  buffer_store_dwordx2 v[104:105], v157, s[32:35], s66 offen sc1
  s_add_u32 s66, s67, 147968
  v_cvt_pk_bf16_f32 v106, v28, v29
  v_cvt_pk_bf16_f32 v107, v30, v31
  buffer_store_dwordx2 v[106:107], v157, s[32:35], s66 offen sc1
  s_add_u32 s66, s67, 50176
  v_cvt_pk_bf16_f32 v108, v36, v37
  v_cvt_pk_bf16_f32 v109, v38, v39
  buffer_store_dwordx2 v[108:109], v157, s[32:35], s66 offen sc1
  s_waitcnt vmcnt(0)
  s_barrier
  s_cmp_eq_u32 s42, 0
  s_cbranch_scc0 F_q0_kk0_ns
  s_lshl_b32 s66, s61, 7
  s_add_u32 s66, s66, 8
  v_mov_b32 v154, s66
  v_mov_b32 v155, 1
  s_mov_b64 exec, 1
  global_store_dword v154, v155, s[68:69] sc1
  s_mov_b64 exec, -1
F_q0_kk0_ns:
  s_cmp_eq_u32 s42, 0
  s_cbranch_scc0 F_q0_kk0_np
  s_lshl_b32 s72, s73, 4
  s_add_u32 s72, s72, s46
  v_mul_u32_u24 v154, 512, v144
  s_lshl_b32 s66, s72, 7
  s_add_u32 s66, s66, 8
  v_add_u32 v154, s66, v154
  s_mov_b64 exec, 15
  s_mov_b32 s60, 0
F_q0_kk0_pollE:
  global_load_dword v155, v154, s[68:69] sc1
  s_waitcnt vmcnt(0)
  v_cmp_eq_u32 vcc, 1, v155
  s_nop 1
  s_cmp_eq_u64 vcc, 15
  s_cbranch_scc1 F_q0_kk0_pollE_ok
  s_add_u32 s60, s60, 1
  s_cmp_gt_u32 s60, 1000000
  s_cbranch_scc1 F_q0_kk0_pollE_ok
  s_sleep 1
  s_branch F_q0_kk0_pollE
F_q0_kk0_pollE_ok:
  s_mov_b64 exec, -1
F_q0_kk0_np:
  s_barrier
  s_mul_i32 s66, s40, 1536
  s_add_u32 s67, s66, 0
  s_add_u32 s66, s67, 12288
  buffer_load_dwordx2 v[96:97], v157, s[32:35], s66 offen sc1
  s_add_u32 s66, s67, 24576
  buffer_load_dwordx2 v[98:99], v157, s[32:35], s66 offen sc1
  s_add_u32 s66, s67, 36864
  buffer_load_dwordx2 v[100:101], v157, s[32:35], s66 offen sc1
  s_add_u32 s66, s67, 12800
  buffer_load_dwordx2 v[102:103], v157, s[32:35], s66 offen sc1
  s_add_u32 s66, s67, 25088
  buffer_load_dwordx2 v[104:105], v157, s[32:35], s66 offen sc1
  s_add_u32 s66, s67, 37376
  buffer_load_dwordx2 v[106:107], v157, s[32:35], s66 offen sc1
  s_add_u32 s66, s67, 13312
  buffer_load_dwordx2 v[108:109], v157, s[32:35], s66 offen sc1
  s_add_u32 s66, s67, 25600
  buffer_load_dwordx2 v[110:111], v157, s[32:35], s66 offen sc1
  s_add_u32 s66, s67, 37888
  buffer_load_dwordx2 v[112:113], v157, s[32:35], s66 offen sc1
  v_and_b32 v154, 15, v144
  v_lshrrev_b32 v155, 4, v144
  v_lshlrev_b32 v155, 3, v155
  v_lshl_add_u32 v156, v154, 10, v155
  s_lshl_b32 s66, s42, 6
  v_add_u32 v156, s66, v156
  s_waitcnt vmcnt(8)
  v_lshlrev_b32 v154, 16, v96
  v_and_b32 v155, 0xffff0000, v96
  v_add_f32 v0, v0, v154
  v_add_f32 v1, v1, v155
  v_lshlrev_b32 v154, 16, v97
  v_and_b32 v155, 0xffff0000, v97
  v_add_f32 v2, v2, v154
  v_add_f32 v3, v3, v155
  s_waitcnt vmcnt(7)
  v_lshlrev_b32 v154, 16, v98
  v_and_b32 v155, 0xffff0000, v98
  v_add_f32 v0, v0, v154
  v_add_f32 v1, v1, v155
  v_lshlrev_b32 v154, 16, v99
  v_and_b32 v155, 0xffff0000, v99
  v_add_f32 v2, v2, v154
  v_add_f32 v3, v3, v155
  s_waitcnt vmcnt(6)
  v_lshlrev_b32 v154, 16, v100
  v_and_b32 v155, 0xffff0000, v100
  v_add_f32 v0, v0, v154
  v_add_f32 v1, v1, v155
  v_lshlrev_b32 v154, 16, v101
  v_and_b32 v155, 0xffff0000, v101
  v_add_f32 v2, v2, v154
  v_add_f32 v3, v3, v155
  v_cvt_pk_bf16_f32 v0, v0, v1
  v_cvt_pk_bf16_f32 v1, v2, v3
  s_mov_b32 s66, 0
  buffer_store_dwordx2 v[0:1], v156, s[28:31], s66 offen offset:0
  s_waitcnt vmcnt(6)
  v_lshlrev_b32 v154, 16, v102
  v_and_b32 v155, 0xffff0000, v102
  v_add_f32 v16, v16, v154
  v_add_f32 v17, v17, v155
  v_lshlrev_b32 v154, 16, v103
  v_and_b32 v155, 0xffff0000, v103
  v_add_f32 v18, v18, v154
  v_add_f32 v19, v19, v155
  s_waitcnt vmcnt(5)
  v_lshlrev_b32 v154, 16, v104
  v_and_b32 v155, 0xffff0000, v104
  v_add_f32 v16, v16, v154
  v_add_f32 v17, v17, v155
  v_lshlrev_b32 v154, 16, v105
  v_and_b32 v155, 0xffff0000, v105
  v_add_f32 v18, v18, v154
  v_add_f32 v19, v19, v155
  s_waitcnt vmcnt(4)
  v_lshlrev_b32 v154, 16, v106
  v_and_b32 v155, 0xffff0000, v106
  v_add_f32 v16, v16, v154
  v_add_f32 v17, v17, v155
  v_lshlrev_b32 v154, 16, v107
  v_and_b32 v155, 0xffff0000, v107
  v_add_f32 v18, v18, v154
  v_add_f32 v19, v19, v155
  v_cvt_pk_bf16_f32 v16, v16, v17
  v_cvt_pk_bf16_f32 v17, v18, v19
  s_mov_b32 s66, 32768
  buffer_store_dwordx2 v[16:17], v156, s[28:31], s66 offen offset:0
  s_waitcnt vmcnt(4)
  v_lshlrev_b32 v154, 16, v108
  v_and_b32 v155, 0xffff0000, v108
  v_add_f32 v32, v32, v154
  v_add_f32 v33, v33, v155
  v_lshlrev_b32 v154, 16, v109
  v_and_b32 v155, 0xffff0000, v109
  v_add_f32 v34, v34, v154
  v_add_f32 v35, v35, v155
  s_waitcnt vmcnt(3)
  v_lshlrev_b32 v154, 16, v110
  v_and_b32 v155, 0xffff0000, v110
  v_add_f32 v32, v32, v154
  v_add_f32 v33, v33, v155
  v_lshlrev_b32 v154, 16, v111
  v_and_b32 v155, 0xffff0000, v111
  v_add_f32 v34, v34, v154
  v_add_f32 v35, v35, v155
  s_waitcnt vmcnt(2)
  v_lshlrev_b32 v154, 16, v112
  v_and_b32 v155, 0xffff0000, v112
  v_add_f32 v32, v32, v154
  v_add_f32 v33, v33, v155
  v_lshlrev_b32 v154, 16, v113
  v_and_b32 v155, 0xffff0000, v113
  v_add_f32 v34, v34, v154
  v_add_f32 v35, v35, v155
  v_cvt_pk_bf16_f32 v32, v32, v33
  v_cvt_pk_bf16_f32 v33, v34, v35
  s_mov_b32 s66, 65536
  buffer_store_dwordx2 v[32:33], v156, s[28:31], s66 offen offset:0
  s_endpgm
F_q0_kk1:
  s_add_u32 s66, s67, 0
  v_cvt_pk_bf16_f32 v96, v0, v1
  v_cvt_pk_bf16_f32 v97, v2, v3
  buffer_store_dwordx2 v[96:97], v157, s[32:35], s66 offen sc1
  s_add_u32 s66, s67, 98304
  v_cvt_pk_bf16_f32 v98, v8, v9
  v_cvt_pk_bf16_f32 v99, v10, v11
  buffer_store_dwordx2 v[98:99], v157, s[32:35], s66 offen sc1
  s_add_u32 s66, s67, 147456
  v_cvt_pk_bf16_f32 v100, v12, v13
  v_cvt_pk_bf16_f32 v101, v14, v15
  buffer_store_dwordx2 v[100:101], v157, s[32:35], s66 offen sc1
  s_add_u32 s66, s67, 512
  v_cvt_pk_bf16_f32 v102, v16, v17
  v_cvt_pk_bf16_f32 v103, v18, v19
  buffer_store_dwordx2 v[102:103], v157, s[32:35], s66 offen sc1
  s_add_u32 s66, s67, 98816
  v_cvt_pk_bf16_f32 v104, v24, v25
  v_cvt_pk_bf16_f32 v105, v26, v27
  buffer_store_dwordx2 v[104:105], v157, s[32:35], s66 offen sc1
  s_add_u32 s66, s67, 147968
  v_cvt_pk_bf16_f32 v106, v28, v29
  v_cvt_pk_bf16_f32 v107, v30, v31
  buffer_store_dwordx2 v[106:107], v157, s[32:35], s66 offen sc1
  s_add_u32 s66, s67, 1024
  v_cvt_pk_bf16_f32 v108, v32, v33
  v_cvt_pk_bf16_f32 v109, v34, v35
  buffer_store_dwordx2 v[108:109], v157, s[32:35], s66 offen sc1
  s_waitcnt vmcnt(0)
  s_barrier
  s_cmp_eq_u32 s42, 0
  s_cbranch_scc0 F_q0_kk1_ns
  s_lshl_b32 s66, s61, 7
  s_add_u32 s66, s66, 8
  v_mov_b32 v154, s66
  v_mov_b32 v155, 1
  s_mov_b64 exec, 1
  global_store_dword v154, v155, s[68:69] sc1
  s_mov_b64 exec, -1
F_q0_kk1_ns:
  s_cmp_eq_u32 s42, 0
  s_cbranch_scc0 F_q0_kk1_np
  s_lshl_b32 s72, s73, 4
  s_add_u32 s72, s72, s46
  v_mul_u32_u24 v154, 512, v144
  s_lshl_b32 s66, s72, 7
  s_add_u32 s66, s66, 8
  v_add_u32 v154, s66, v154
  s_mov_b64 exec, 15
  s_mov_b32 s60, 0
F_q0_kk1_pollE:
  global_load_dword v155, v154, s[68:69] sc1
  s_waitcnt vmcnt(0)
  v_cmp_eq_u32 vcc, 1, v155
  s_nop 1
  s_cmp_eq_u64 vcc, 15
  s_cbranch_scc1 F_q0_kk1_pollE_ok
  s_add_u32 s60, s60, 1
  s_cmp_gt_u32 s60, 1000000
  s_cbranch_scc1 F_q0_kk1_pollE_ok
  s_sleep 1
  s_branch F_q0_kk1_pollE
F_q0_kk1_pollE_ok:
  s_mov_b64 exec, -1
F_q0_kk1_np:
  s_barrier
  s_mul_i32 s66, s40, 1536
  s_add_u32 s67, s66, 49152
  s_add_u32 s66, s67, 0
  buffer_load_dwordx2 v[96:97], v157, s[32:35], s66 offen sc1
  s_add_u32 s66, s67, 24576
  buffer_load_dwordx2 v[98:99], v157, s[32:35], s66 offen sc1
  s_add_u32 s66, s67, 36864
  buffer_load_dwordx2 v[100:101], v157, s[32:35], s66 offen sc1
  s_add_u32 s66, s67, 512
  buffer_load_dwordx2 v[102:103], v157, s[32:35], s66 offen sc1
  s_add_u32 s66, s67, 25088
  buffer_load_dwordx2 v[104:105], v157, s[32:35], s66 offen sc1
  s_add_u32 s66, s67, 37376
  buffer_load_dwordx2 v[106:107], v157, s[32:35], s66 offen sc1
  s_add_u32 s66, s67, 1024
  buffer_load_dwordx2 v[108:109], v157, s[32:35], s66 offen sc1
  s_add_u32 s66, s67, 25600
  buffer_load_dwordx2 v[110:111], v157, s[32:35], s66 offen sc1
  s_add_u32 s66, s67, 37888
  buffer_load_dwordx2 v[112:113], v157, s[32:35], s66 offen sc1
  v_and_b32 v154, 15, v144
  v_lshrrev_b32 v155, 4, v144
  v_lshlrev_b32 v155, 3, v155
  v_lshl_add_u32 v156, v154, 10, v155
  s_lshl_b32 s66, s42, 6
  v_add_u32 v156, s66, v156
  s_waitcnt vmcnt(8)
  v_lshlrev_b32 v154, 16, v96
  v_and_b32 v155, 0xffff0000, v96
  v_add_f32 v4, v4, v154
  v_add_f32 v5, v5, v155
  v_lshlrev_b32 v154, 16, v97
  v_and_b32 v155, 0xffff0000, v97
  v_add_f32 v6, v6, v154
  v_add_f32 v7, v7, v155
  s_waitcnt vmcnt(7)
  v_lshlrev_b32 v154, 16, v98
  v_and_b32 v155, 0xffff0000, v98
  v_add_f32 v4, v4, v154
  v_add_f32 v5, v5, v155
  v_lshlrev_b32 v154, 16, v99
  v_and_b32 v155, 0xffff0000, v99
  v_add_f32 v6, v6, v154
  v_add_f32 v7, v7, v155
  s_waitcnt vmcnt(6)
  v_lshlrev_b32 v154, 16, v100
  v_and_b32 v155, 0xffff0000, v100
  v_add_f32 v4, v4, v154
  v_add_f32 v5, v5, v155
  v_lshlrev_b32 v154, 16, v101
  v_and_b32 v155, 0xffff0000, v101
  v_add_f32 v6, v6, v154
  v_add_f32 v7, v7, v155
  v_cvt_pk_bf16_f32 v4, v4, v5
  v_cvt_pk_bf16_f32 v5, v6, v7
  s_mov_b32 s66, 0
  buffer_store_dwordx2 v[4:5], v156, s[28:31], s66 offen offset:32
  s_waitcnt vmcnt(6)
  v_lshlrev_b32 v154, 16, v102
  v_and_b32 v155, 0xffff0000, v102
  v_add_f32 v20, v20, v154
  v_add_f32 v21, v21, v155
  v_lshlrev_b32 v154, 16, v103
  v_and_b32 v155, 0xffff0000, v103
  v_add_f32 v22, v22, v154
  v_add_f32 v23, v23, v155
  s_waitcnt vmcnt(5)
  v_lshlrev_b32 v154, 16, v104
  v_and_b32 v155, 0xffff0000, v104
  v_add_f32 v20, v20, v154
  v_add_f32 v21, v21, v155
  v_lshlrev_b32 v154, 16, v105
  v_and_b32 v155, 0xffff0000, v105
  v_add_f32 v22, v22, v154
  v_add_f32 v23, v23, v155
  s_waitcnt vmcnt(4)
  v_lshlrev_b32 v154, 16, v106
  v_and_b32 v155, 0xffff0000, v106
  v_add_f32 v20, v20, v154
  v_add_f32 v21, v21, v155
  v_lshlrev_b32 v154, 16, v107
  v_and_b32 v155, 0xffff0000, v107
  v_add_f32 v22, v22, v154
  v_add_f32 v23, v23, v155
  v_cvt_pk_bf16_f32 v20, v20, v21
  v_cvt_pk_bf16_f32 v21, v22, v23
  s_mov_b32 s66, 32768
  buffer_store_dwordx2 v[20:21], v156, s[28:31], s66 offen offset:32
  s_waitcnt vmcnt(4)
  v_lshlrev_b32 v154, 16, v108
  v_and_b32 v155, 0xffff0000, v108
  v_add_f32 v36, v36, v154
  v_add_f32 v37, v37, v155
  v_lshlrev_b32 v154, 16, v109
  v_and_b32 v155, 0xffff0000, v109
  v_add_f32 v38, v38, v154
  v_add_f32 v39, v39, v155
  s_waitcnt vmcnt(3)
  v_lshlrev_b32 v154, 16, v110
  v_and_b32 v155, 0xffff0000, v110
  v_add_f32 v36, v36, v154
  v_add_f32 v37, v37, v155
  v_lshlrev_b32 v154, 16, v111
  v_and_b32 v155, 0xffff0000, v111
  v_add_f32 v38, v38, v154
  v_add_f32 v39, v39, v155
  s_waitcnt vmcnt(2)
  v_lshlrev_b32 v154, 16, v112
  v_and_b32 v155, 0xffff0000, v112
  v_add_f32 v36, v36, v154
  v_add_f32 v37, v37, v155
  v_lshlrev_b32 v154, 16, v113
  v_and_b32 v155, 0xffff0000, v113
  v_add_f32 v38, v38, v154
  v_add_f32 v39, v39, v155
  v_cvt_pk_bf16_f32 v36, v36, v37
  v_cvt_pk_bf16_f32 v37, v38, v39
  s_mov_b32 s66, 65536
  buffer_store_dwordx2 v[36:37], v156, s[28:31], s66 offen offset:32
  s_endpgm
F_q0_kk2:
  s_add_u32 s66, s67, 0
  v_cvt_pk_bf16_f32 v96, v0, v1
  v_cvt_pk_bf16_f32 v97, v2, v3
  buffer_store_dwordx2 v[96:97], v157, s[32:35], s66 offen sc1
  s_add_u32 s66, s67, 49152
  v_cvt_pk_bf16_f32 v98, v4, v5
  v_cvt_pk_bf16_f32 v99, v6, v7
  buffer_store_dwordx2 v[98:99], v157, s[32:35], s66 offen sc1
  s_add_u32 s66, s67, 147456
  v_cvt_pk_bf16_f32 v100, v12, v13
  v_cvt_pk_bf16_f32 v101, v14, v15
  buffer_store_dwordx2 v[100:101], v157, s[32:35], s66 offen sc1
  s_add_u32 s66, s67, 512
  v_cvt_pk_bf16_f32 v102, v16, v17
  v_cvt_pk_bf16_f32 v103, v18, v19
  buffer_store_dwordx2 v[102:103], v157, s[32:35], s66 offen sc1
  s_add_u32 s66, s67, 49664
  v_cvt_pk_bf16_f32 v104, v20, v21
  v_cvt_pk_bf16_f32 v105, v22, v23
  buffer_store_dwordx2 v[104:105], v157, s[32:35], s66 offen sc1
  s_add_u32 s66, s67, 147968
  v_cvt_pk_bf16_f32 v106, v28, v29
  v_cvt_pk_bf16_f32 v107, v30, v31
  buffer_store_dwordx2 v[106:107], v157, s[32:35], s66 offen sc1
  s_add_u32 s66, s67, 1024
  v_cvt_pk_bf16_f32 v108, v32, v33
  v_cvt_pk_bf16_f32 v109, v34, v35
  buffer_store_dwordx2 v[108:109], v157, s[32:35], s66 offen sc1
  s_add_u32 s66, s67, 50176
  v_cvt_pk_bf16_f32 v110, v36, v37
  v_cvt_pk_bf16_f32 v111, v38, v39
  buffer_store_dwordx2 v[110:111], v157, s[32:35], s66 offen sc1
  s_waitcnt vmcnt(0)
  s_barrier
  s_cmp_eq_u32 s42, 0
  s_cbranch_scc0 F_q0_kk2_ns
  s_lshl_b32 s66, s61, 7
  s_add_u32 s66, s66, 8
  v_mov_b32 v154, s66
  v_mov_b32 v155, 1
  s_mov_b64 exec, 1
  global_store_dword v154, v155, s[68:69] sc1
  s_mov_b64 exec, -1
F_q0_kk2_ns:
  s_cmp_eq_u32 s42, 0
  s_cbranch_scc0 F_q0_kk2_np
  s_lshl_b32 s72, s73, 4
  s_add_u32 s72, s72, s46
  v_mul_u32_u24 v154, 512, v144
  s_lshl_b32 s66, s72, 7
  s_add_u32 s66, s66, 8
  v_add_u32 v154, s66, v154
  s_mov_b64 exec, 15
  s_mov_b32 s60, 0
F_q0_kk2_pollE:
  global_load_dword v155, v154, s[68:69] sc1
  s_waitcnt vmcnt(0)
  v_cmp_eq_u32 vcc, 1, v155
  s_nop 1
  s_cmp_eq_u64 vcc, 15
  s_cbranch_scc1 F_q0_kk2_pollE_ok
  s_add_u32 s60, s60, 1
  s_cmp_gt_u32 s60, 1000000
  s_cbranch_scc1 F_q0_kk2_pollE_ok
  s_sleep 1
  s_branch F_q0_kk2_pollE
F_q0_kk2_pollE_ok:
  s_mov_b64 exec, -1
F_q0_kk2_np:
  s_barrier
  s_mul_i32 s66, s40, 1536
  s_add_u32 s67, s66, 98304
  s_add_u32 s66, s67, 0
  buffer_load_dwordx2 v[96:97], v157, s[32:35], s66 offen sc1
  s_add_u32 s66, s67, 12288
  buffer_load_dwordx2 v[98:99], v157, s[32:35], s66 offen sc1
  s_add_u32 s66, s67, 36864
  buffer_load_dwordx2 v[100:101], v157, s[32:35], s66 offen sc1
  s_add_u32 s66, s67, 512
  buffer_load_dwordx2 v[102:103], v157, s[32:35], s66 offen sc1
  s_add_u32 s66, s67, 12800
  buffer_load_dwordx2 v[104:105], v157, s[32:35], s66 offen sc1
  s_add_u32 s66, s67, 37376
  buffer_load_dwordx2 v[106:107], v157, s[32:35], s66 offen sc1
  v_and_b32 v154, 15, v144
  v_lshrrev_b32 v155, 4, v144
  v_lshlrev_b32 v155, 3, v155
  v_lshl_add_u32 v156, v154, 10, v155
  s_lshl_b32 s66, s42, 6
  v_add_u32 v156, s66, v156
  s_waitcnt vmcnt(5)
  v_lshlrev_b32 v154, 16, v96
  v_and_b32 v155, 0xffff0000, v96
  v_add_f32 v8, v8, v154
  v_add_f32 v9, v9, v155
  v_lshlrev_b32 v154, 16, v97
  v_and_b32 v155, 0xffff0000, v97
  v_add_f32 v10, v10, v154
  v_add_f32 v11, v11, v155
  s_waitcnt vmcnt(4)
  v_lshlrev_b32 v154, 16, v98
  v_and_b32 v155, 0xffff0000, v98
  v_add_f32 v8, v8, v154
  v_add_f32 v9, v9, v155
  v_lshlrev_b32 v154, 16, v99
  v_and_b32 v155, 0xffff0000, v99
  v_add_f32 v10, v10, v154
  v_add_f32 v11, v11, v155
  s_waitcnt vmcnt(3)
  v_lshlrev_b32 v154, 16, v100
  v_and_b32 v155, 0xffff0000, v100
  v_add_f32 v8, v8, v154
  v_add_f32 v9, v9, v155
  v_lshlrev_b32 v154, 16, v101
  v_and_b32 v155, 0xffff0000, v101
  v_add_f32 v10, v10, v154
  v_add_f32 v11, v11, v155
  v_cvt_pk_bf16_f32 v8, v8, v9
  v_cvt_pk_bf16_f32 v9, v10, v11
  s_mov_b32 s66, 16384
  buffer_store_dwordx2 v[8:9], v156, s[28:31], s66 offen offset:0
  s_waitcnt vmcnt(3)
  v_lshlrev_b32 v154, 16, v102
  v_and_b32 v155, 0xffff0000, v102
  v_add_f32 v24, v24, v154
  v_add_f32 v25, v25, v155
  v_lshlrev_b32 v154, 16, v103
  v_and_b32 v155, 0xffff0000, v103
  v_add_f32 v26, v26, v154
  v_add_f32 v27, v27, v155
  s_waitcnt vmcnt(2)
  v_lshlrev_b32 v154, 16, v104
  v_and_b32 v155, 0xffff0000, v104
  v_add_f32 v24, v24, v154
  v_add_f32 v25, v25, v155
  v_lshlrev_b32 v154, 16, v105
  v_and_b32 v155, 0xffff0000, v105
  v_add_f32 v26, v26, v154
  v_add_f32 v27, v27, v155
  s_waitcnt vmcnt(1)
  v_lshlrev_b32 v154, 16, v106
  v_and_b32 v155, 0xffff0000, v106
  v_add_f32 v24, v24, v154
  v_add_f32 v25, v25, v155
  v_lshlrev_b32 v154, 16, v107
  v_and_b32 v155, 0xffff0000, v107
  v_add_f32 v26, v26, v154
  v_add_f32 v27, v27, v155
  v_cvt_pk_bf16_f32 v24, v24, v25
  v_cvt_pk_bf16_f32 v25, v26, v27
  s_mov_b32 s66, 49152
  buffer_store_dwordx2 v[24:25], v156, s[28:31], s66 offen offset:0
  s_endpgm
F_q0_kk3:
  s_add_u32 s66, s67, 0
  v_cvt_pk_bf16_f32 v96, v0, v1
  v_cvt_pk_bf16_f32 v97, v2, v3
  buffer_store_dwordx2 v[96:97], v157, s[32:35], s66 offen sc1
  s_add_u32 s66, s67, 49152
  v_cvt_pk_bf16_f32 v98, v4, v5
  v_cvt_pk_bf16_f32 v99, v6, v7
  buffer_store_dwordx2 v[98:99], v157, s[32:35], s66 offen sc1
  s_add_u32 s66, s67, 98304
  v_cvt_pk_bf16_f32 v100, v8, v9
  v_cvt_pk_bf16_f32 v101, v10, v11
  buffer_store_dwordx2 v[100:101], v157, s[32:35], s66 offen sc1
  s_add_u32 s66, s67, 512
  v_cvt_pk_bf16_f32 v102, v16, v17
  v_cvt_pk_bf16_f32 v103, v18, v19
  buffer_store_dwordx2 v[102:103], v157, s[32:35], s66 offen sc1
  s_add_u32 s66, s67, 49664
  v_cvt_pk_bf16_f32 v104, v20, v21
  v_cvt_pk_bf16_f32 v105, v22, v23
  buffer_store_dwordx2 v[104:105], v157, s[32:35], s66 offen sc1
  s_add_u32 s66, s67, 98816
  v_cvt_pk_bf16_f32 v106, v24, v25
  v_cvt_pk_bf16_f32 v107, v26, v27
  buffer_store_dwordx2 v[106:107], v157, s[32:35], s66 offen sc1
  s_add_u32 s66, s67, 1024
  v_cvt_pk_bf16_f32 v108, v32, v33
  v_cvt_pk_bf16_f32 v109, v34, v35
  buffer_store_dwordx2 v[108:109], v157, s[32:35], s66 offen sc1
  s_add_u32 s66, s67, 50176
  v_cvt_pk_bf16_f32 v110, v36, v37
  v_cvt_pk_bf16_f32 v111, v38, v39
  buffer_store_dwordx2 v[110:111], v157, s[32:35], s66 offen sc1
  s_waitcnt vmcnt(0)
  s_barrier
  s_cmp_eq_u32 s42, 0
  s_cbranch_scc0 F_q0_kk3_ns
  s_lshl_b32 s66, s61, 7
  s_add_u32 s66, s66, 8
  v_mov_b32 v154, s66
  v_mov_b32 v155, 1
  s_mov_b64 exec, 1
  global_store_dword v154, v155, s[68:69] sc1
  s_mov_b64 exec, -1
F_q0_kk3_ns:
  s_cmp_eq_u32 s42, 0
  s_cbranch_scc0 F_q0_kk3_np
  s_lshl_b32 s72, s73, 4
  s_add_u32 s72, s72, s46
  v_mul_u32_u24 v154, 512, v144
  s_lshl_b32 s66, s72, 7
  s_add_u32 s66, s66, 8
  v_add_u32 v154, s66, v154
  s_mov_b64 exec, 15
  s_mov_b32 s60, 0
F_q0_kk3_pollE:
  global_load_dword v155, v154, s[68:69] sc1
  s_waitcnt vmcnt(0)
  v_cmp_eq_u32 vcc, 1, v155
  s_nop 1
  s_cmp_eq_u64 vcc, 15
  s_cbranch_scc1 F_q0_kk3_pollE_ok
  s_add_u32 s60, s60, 1
  s_cmp_gt_u32 s60, 1000000
  s_cbranch_scc1 F_q0_kk3_pollE_ok
  s_sleep 1
  s_branch F_q0_kk3_pollE
F_q0_kk3_pollE_ok:
  s_mov_b64 exec, -1
F_q0_kk3_np:
  s_barrier
  s_mul_i32 s66, s40, 1536
  s_add_u32 s67, s66, 147456
  s_add_u32 s66, s67, 0
  buffer_load_dwordx2 v[96:97], v157, s[32:35], s66 offen sc1
  s_add_u32 s66, s67, 12288
  buffer_load_dwordx2 v[98:99], v157, s[32:35], s66 offen sc1
  s_add_u32 s66, s67, 24576
  buffer_load_dwordx2 v[100:101], v157, s[32:35], s66 offen sc1
  s_add_u32 s66, s67, 512
  buffer_load_dwordx2 v[102:103], v157, s[32:35], s66 offen sc1
  s_add_u32 s66, s67, 12800
  buffer_load_dwordx2 v[104:105], v157, s[32:35], s66 offen sc1
  s_add_u32 s66, s67, 25088
  buffer_load_dwordx2 v[106:107], v157, s[32:35], s66 offen sc1
  v_and_b32 v154, 15, v144
  v_lshrrev_b32 v155, 4, v144
  v_lshlrev_b32 v155, 3, v155
  v_lshl_add_u32 v156, v154, 10, v155
  s_lshl_b32 s66, s42, 6
  v_add_u32 v156, s66, v156
  s_waitcnt vmcnt(5)
  v_lshlrev_b32 v154, 16, v96
  v_and_b32 v155, 0xffff0000, v96
  v_add_f32 v12, v12, v154
  v_add_f32 v13, v13, v155
  v_lshlrev_b32 v154, 16, v97
  v_and_b32 v155, 0xffff0000, v97
  v_add_f32 v14, v14, v154
  v_add_f32 v15, v15, v155
  s_waitcnt vmcnt(4)
  v_lshlrev_b32 v154, 16, v98
  v_and_b32 v155, 0xffff0000, v98
  v_add_f32 v12, v12, v154
  v_add_f32 v13, v13, v155
  v_lshlrev_b32 v154, 16, v99
  v_and_b32 v155, 0xffff0000, v99
  v_add_f32 v14, v14, v154
  v_add_f32 v15, v15, v155
  s_waitcnt vmcnt(3)
  v_lshlrev_b32 v154, 16, v100
  v_and_b32 v155, 0xffff0000, v100
  v_add_f32 v12, v12, v154
  v_add_f32 v13, v13, v155
  v_lshlrev_b32 v154, 16, v101
  v_and_b32 v155, 0xffff0000, v101
  v_add_f32 v14, v14, v154
  v_add_f32 v15, v15, v155
  v_cvt_pk_bf16_f32 v12, v12, v13
  v_cvt_pk_bf16_f32 v13, v14, v15
  s_mov_b32 s66, 16384
  buffer_store_dwordx2 v[12:13], v156, s[28:31], s66 offen offset:32
  s_waitcnt vmcnt(3)
  v_lshlrev_b32 v154, 16, v102
  v_and_b32 v155, 0xffff0000, v102
  v_add_f32 v28, v28, v154
  v_add_f32 v29, v29, v155
  v_lshlrev_b32 v154, 16, v103
  v_and_b32 v155, 0xffff0000, v103
  v_add_f32 v30, v30, v154
  v_add_f32 v31, v31, v155
  s_waitcnt vmcnt(2)
  v_lshlrev_b32 v154, 16, v104
  v_and_b32 v155, 0xffff0000, v104
  v_add_f32 v28, v28, v154
  v_add_f32 v29, v29, v155
  v_lshlrev_b32 v154, 16, v105
  v_and_b32 v155, 0xffff0000, v105
  v_add_f32 v30, v30, v154
  v_add_f32 v31, v31, v155
  s_waitcnt vmcnt(1)
  v_lshlrev_b32 v154, 16, v106
  v_and_b32 v155, 0xffff0000, v106
  v_add_f32 v28, v28, v154
  v_add_f32 v29, v29, v155
  v_lshlrev_b32 v154, 16, v107
  v_and_b32 v155, 0xffff0000, v107
  v_add_f32 v30, v30, v154
  v_add_f32 v31, v31, v155
  v_cvt_pk_bf16_f32 v28, v28, v29
  v_cvt_pk_bf16_f32 v29, v30, v31
  s_mov_b32 s66, 49152
  buffer_store_dwordx2 v[28:29], v156, s[28:31], s66 offen offset:32
  s_endpgm
F_q1:
  v_mov_b64 v[0:1], 0
  v_mov_b64 v[2:3], 0
  v_mov_b64 v[4:5], 0
  v_mov_b64 v[6:7], 0
  v_mov_b64 v[8:9], 0
  v_mov_b64 v[10:11], 0
  v_mov_b64 v[12:13], 0
  v_mov_b64 v[14:15], 0
  v_mov_b64 v[16:17], 0
  v_mov_b64 v[18:19], 0
  v_mov_b64 v[20:21], 0
  v_mov_b64 v[22:23], 0
  v_mov_b64 v[24:25], 0
  v_mov_b64 v[26:27], 0
  v_mov_b64 v[28:29], 0
  v_mov_b64 v[30:31], 0
  v_mov_b64 v[32:33], 0
  v_mov_b64 v[34:35], 0
  v_mov_b64 v[36:37], 0
  v_mov_b64 v[38:39], 0
  v_add_u32 v150, s58, v148
  v_add_u32 v151, s58, v149
  v_add_u32 v153, s58, v152
  s_add_u32 s63, s46, 1
  s_and_b32 s63, s63, 3
  s_mul_i32 s55, s63, 73728
  s_lshl_b32 s56, s63, 18
  s_add_u32 s76, s55, 36864
  s_add_u32 s77, s56, 131072
  s_mov_b32 s57, 81920
  s_waitcnt lgkmcnt(0)
  s_barrier
  ds_read_b64_tr_b16 a[0:1], v150 offset:0
  ds_read_b64_tr_b16 a[2:3], v150 offset:4096
  ds_read_b64_tr_b16 a[4:5], v151 offset:0
  ds_read_b64_tr_b16 a[6:7], v151 offset:4096
  ds_read_b128 v[40:43], v153 offset:0
  ds_read_b128 v[44:47], v153 offset:1024
  ds_read_b128 v[48:51], v153 offset:2048
  ds_read_b128 v[52:55], v153 offset:3072
  s_barrier
  s_waitcnt lgkmcnt(0)
  v_mfma_f32_16x16x32_bf16 v[0:3], a[0:3], v[40:43], v[0:3]
  ds_read_b128 v[60:63], v153 offset:17408
  ds_read_b64_tr_b16 a[8:9], v150 offset:17408
  s_lshl_b32 s67, s46, 18
  s_add_u32 s67, s67, 196608
  s_add_u32 m0, s47, 47104
  s_add_u32 s66, s67, s51
  buffer_load_dwordx4 v145, s[24:27], s66 offen  lds
  v_mfma_f32_16x16x32_bf16 v[4:7], a[4:7], v[40:43], v[4:7]
  ds_read_b64_tr_b16 a[10:11], v150 offset:21504
  ds_read_b64_tr_b16 a[12:13], v151 offset:17408
  v_mfma_f32_16x16x32_bf16 v[8:11], a[0:3], v[44:47], v[8:11]
  ds_read_b64_tr_b16 a[14:15], v151 offset:21504
  ds_read_b128 v[64:67], v153 offset:18432
  v_mfma_f32_16x16x32_bf16 v[12:15], a[4:7], v[44:47], v[12:15]
  ds_read_b128 v[68:71], v153 offset:19456
  ds_read_b128 v[72:75], v153 offset:20480
  s_add_u32 m0, m0, 896
  s_nop 0
  buffer_load_dwordx4 v145, s[24:27], s66 offen offset:128  lds
  v_mfma_f32_16x16x32_bf16 v[16:19], a[0:3], v[48:51], v[16:19]
  v_mfma_f32_16x16x32_bf16 v[20:23], a[4:7], v[48:51], v[20:23]
  v_mfma_f32_16x16x32_bf16 v[24:27], a[0:3], v[52:55], v[24:27]
  v_mfma_f32_16x16x32_bf16 v[28:31], a[4:7], v[52:55], v[28:31]
  s_waitcnt lgkmcnt(0)
  v_mfma_f32_16x16x32_bf16 v[0:3], a[8:11], v[60:63], v[0:3]
  s_add_u32 s58, s58, 34816
  s_cmp_eq_u32 s58, 151552
  s_cselect_b32 s58, 12288, s58
  v_add_u32 v150, s58, v148
  v_add_u32 v151, s58, v149
  v_add_u32 v153, s58, v152
  ds_read_b128 v[40:43], v153 offset:0
  ds_read_b64_tr_b16 a[0:1], v150 offset:0
  v_mfma_f32_16x16x32_bf16 v[4:7], a[12:15], v[60:63], v[4:7]
  ds_read_b64_tr_b16 a[2:3], v150 offset:4096
  ds_read_b64_tr_b16 a[4:5], v151 offset:0
  v_mfma_f32_16x16x32_bf16 v[8:11], a[8:11], v[64:67], v[8:11]
  ds_read_b64_tr_b16 a[6:7], v151 offset:4096
  ds_read_b128 v[44:47], v153 offset:1024
  v_mfma_f32_16x16x32_bf16 v[12:15], a[12:15], v[64:67], v[12:15]
  ds_read_b128 v[48:51], v153 offset:2048
  ds_read_b128 v[52:55], v153 offset:3072
  v_mfma_f32_16x16x32_bf16 v[16:19], a[8:11], v[68:71], v[16:19]
  v_mfma_f32_16x16x32_bf16 v[20:23], a[12:15], v[68:71], v[20:23]
  v_mfma_f32_16x16x32_bf16 v[24:27], a[8:11], v[72:75], v[24:27]
  v_mfma_f32_16x16x32_bf16 v[28:31], a[12:15], v[72:75], v[28:31]
  s_barrier
  s_waitcnt lgkmcnt(0)
  v_mfma_f32_16x16x32_bf16 v[0:3], a[0:3], v[40:43], v[0:3]
  ds_read_b128 v[60:63], v153 offset:17408
  ds_read_b64_tr_b16 a[8:9], v150 offset:17408
  s_add_u32 m0, s57, s47
  s_add_u32 s66, s56, s51
  buffer_load_dwordx4 v145, s[24:27], s66 offen  lds
  v_mfma_f32_16x16x32_bf16 v[4:7], a[4:7], v[40:43], v[4:7]
  ds_read_b64_tr_b16 a[10:11], v150 offset:21504
  ds_read_b64_tr_b16 a[12:13], v151 offset:17408
  s_add_u32 m0, m0, 896
  s_nop 0
  buffer_load_dwordx4 v145, s[24:27], s66 offen offset:128  lds
  v_mfma_f32_16x16x32_bf16 v[8:11], a[0:3], v[44:47], v[8:11]
  ds_read_b64_tr_b16 a[14:15], v151 offset:21504
  ds_read_b128 v[64:67], v153 offset:18432
  v_mfma_f32_16x16x32_bf16 v[12:15], a[4:7], v[44:47], v[12:15]
  ds_read_b128 v[68:71], v153 offset:19456
  ds_read_b128 v[72:75], v153 offset:20480
  s_add_u32 m0, s57, s3
  s_add_u32 s66, s55, s52
  buffer_load_dwordx4 v146, s[20:23], s66 offen  lds
  v_mfma_f32_16x16x32_bf16 v[16:19], a[0:3], v[48:51], v[16:19]
  v_mfma_f32_16x16x32_bf16 v[20:23], a[4:7], v[48:51], v[20:23]
  s_add_u32 m0, s57, s100
  s_add_u32 s66, s55, s53
  buffer_load_dwordx4 v146, s[20:23], s66 offen  lds
  v_mfma_f32_16x16x32_bf16 v[24:27], a[0:3], v[52:55], v[24:27]
  v_mfma_f32_16x16x32_bf16 v[28:31], a[4:7], v[52:55], v[28:31]
  s_cmp_eq_u32 s42, 0
  s_cbranch_scc0 F_q1_a1_x8
  s_add_u32 m0, s57, s101
  s_add_u32 s66, s55, s54
  buffer_load_dwordx4 v146, s[20:23], s66 offen  lds
F_q1_a1_x8:
  s_add_u32 s55, s55, 2048
  s_add_u32 s56, s56, 65536
  s_add_u32 s57, s57, 34816
  s_cmp_eq_u32 s57, 151552
  s_cselect_b32 s57, 12288, s57
  s_waitcnt lgkmcnt(0)
  v_mfma_f32_16x16x32_bf16 v[0:3], a[8:11], v[60:63], v[0:3]
  s_add_u32 s58, s58, 34816
  s_cmp_eq_u32 s58, 151552
  s_cselect_b32 s58, 12288, s58
  v_add_u32 v150, s58, v148
  v_add_u32 v151, s58, v149
  v_add_u32 v153, s58, v152
  ds_read_b128 v[40:43], v153 offset:0
  ds_read_b64_tr_b16 a[0:1], v150 offset:0
  v_mfma_f32_16x16x32_bf16 v[4:7], a[12:15], v[60:63], v[4:7]
  ds_read_b64_tr_b16 a[2:3], v150 offset:4096
  ds_read_b64_tr_b16 a[4:5], v151 offset:0
  v_mfma_f32_16x16x32_bf16 v[8:11], a[8:11], v[64:67], v[8:11]
  ds_read_b64_tr_b16 a[6:7], v151 offset:4096
  ds_read_b128 v[44:47], v153 offset:1024
  v_mfma_f32_16x16x32_bf16 v[12:15], a[12:15], v[64:67], v[12:15]
  ds_read_b128 v[48:51], v153 offset:2048
  ds_read_b128 v[52:55], v153 offset:3072
  v_mfma_f32_16x16x32_bf16 v[16:19], a[8:11], v[68:71], v[16:19]
  v_mfma_f32_16x16x32_bf16 v[20:23], a[12:15], v[68:71], v[20:23]
  v_mfma_f32_16x16x32_bf16 v[24:27], a[8:11], v[72:75], v[24:27]
  v_mfma_f32_16x16x32_bf16 v[28:31], a[12:15], v[72:75], v[28:31]
  s_mov_b32 s62, 0
F_q1_loop:
  s_waitcnt vmcnt(4)
  s_barrier
  s_cmp_eq_u32 s62, 0
  s_cselect_b32 s63, s42, 1
  s_cmp_eq_u32 s63, 0
  s_cbranch_scc0 F_q1_nosig
  s_lshl_b32 s66, s61, 7
  s_add_u32 s66, s66, 4
  v_mov_b32 v154, s66
  v_mov_b32 v155, 1
  s_mov_b64 exec, 1
  global_store_dword v154, v155, s[68:69] sc1
  s_mov_b64 exec, -1
F_q1_nosig:
  s_waitcnt lgkmcnt(0)
  v_mfma_f32_16x16x32_bf16 v[0:3], a[0:3], v[40:43], v[0:3]
  ds_read_b128 v[60:63], v153 offset:17408
  ds_read_b64_tr_b16 a[8:9], v150 offset:17408
  s_add_u32 m0, s57, s47
  s_add_u32 s66, s56, s51
  buffer_load_dwordx4 v145, s[24:27], s66 offen  lds
  v_mfma_f32_16x16x32_bf16 v[4:7], a[4:7], v[40:43], v[4:7]
  ds_read_b64_tr_b16 a[10:11], v150 offset:21504
  ds_read_b64_tr_b16 a[12:13], v151 offset:17408
  s_add_u32 m0, m0, 896
  s_nop 0
  buffer_load_dwordx4 v145, s[24:27], s66 offen offset:128  lds
  v_mfma_f32_16x16x32_bf16 v[8:11], a[0:3], v[44:47], v[8:11]
  ds_read_b64_tr_b16 a[14:15], v151 offset:21504
  ds_read_b128 v[64:67], v153 offset:18432
  v_mfma_f32_16x16x32_bf16 v[12:15], a[4:7], v[44:47], v[12:15]
  ds_read_b128 v[68:71], v153 offset:19456
  ds_read_b128 v[72:75], v153 offset:20480
  s_add_u32 m0, s57, s3
  s_add_u32 s66, s55, s52
  buffer_load_dwordx4 v146, s[20:23], s66 offen  lds
  v_mfma_f32_16x16x32_bf16 v[16:19], a[0:3], v[48:51], v[16:19]
  v_mfma_f32_16x16x32_bf16 v[20:23], a[4:7], v[48:51], v[20:23]
  s_add_u32 m0, s57, s100
  s_add_u32 s66, s55, s53
  buffer_load_dwordx4 v146, s[20:23], s66 offen  lds
  v_mfma_f32_16x16x32_bf16 v[24:27], a[0:3], v[52:55], v[24:27]
  v_mfma_f32_16x16x32_bf16 v[28:31], a[4:7], v[52:55], v[28:31]
  s_cmp_eq_u32 s42, 0
  s_cbranch_scc0 F_q1_s0_x8
  s_add_u32 m0, s57, s101
  s_add_u32 s66, s55, s54
  buffer_load_dwordx4 v146, s[20:23], s66 offen  lds
F_q1_s0_x8:
  s_add_u32 s55, s55, 71680
  s_sub_u32 s63, s55, 294912
  s_cmp_ge_u32 s55, 294912
  s_cselect_b32 s55, s63, s55
  s_add_u32 s56, s56, 196608
  s_and_b32 s56, s56, 1048575
  s_cmp_eq_u32 s62, 2
  s_cselect_b32 s55, s76, s55
  s_cselect_b32 s56, s77, s56
  s_add_u32 s57, s57, 34816
  s_cmp_eq_u32 s57, 151552
  s_cselect_b32 s57, 12288, s57
  s_waitcnt lgkmcnt(0)
  v_mfma_f32_16x16x32_bf16 v[0:3], a[8:11], v[60:63], v[0:3]
  s_add_u32 s58, s58, 34816
  s_cmp_eq_u32 s58, 151552
  s_cselect_b32 s58, 12288, s58
  v_add_u32 v150, s58, v148
  v_add_u32 v151, s58, v149
  v_add_u32 v153, s58, v152
  ds_read_b128 v[40:43], v153 offset:0
  ds_read_b64_tr_b16 a[0:1], v150 offset:0
  v_mfma_f32_16x16x32_bf16 v[4:7], a[12:15], v[60:63], v[4:7]
  ds_read_b64_tr_b16 a[2:3], v150 offset:4096
  ds_read_b64_tr_b16 a[4:5], v151 offset:0
  v_mfma_f32_16x16x32_bf16 v[8:11], a[8:11], v[64:67], v[8:11]
  ds_read_b64_tr_b16 a[6:7], v151 offset:4096
  ds_read_b128 v[44:47], v153 offset:1024
  v_mfma_f32_16x16x32_bf16 v[12:15], a[12:15], v[64:67], v[12:15]
  ds_read_b128 v[48:51], v153 offset:2048
  ds_read_b128 v[52:55], v153 offset:3072
  v_mfma_f32_16x16x32_bf16 v[16:19], a[8:11], v[68:71], v[16:19]
  v_mfma_f32_16x16x32_bf16 v[20:23], a[12:15], v[68:71], v[20:23]
  v_mfma_f32_16x16x32_bf16 v[24:27], a[8:11], v[72:75], v[24:27]
  v_mfma_f32_16x16x32_bf16 v[28:31], a[12:15], v[72:75], v[28:31]
  s_waitcnt vmcnt(4)
  s_barrier
  s_waitcnt lgkmcnt(0)
  v_mfma_f32_16x16x32_bf16 v[0:3], a[0:3], v[40:43], v[0:3]
  ds_read_b128 v[60:63], v153 offset:17408
  ds_read_b64_tr_b16 a[8:9], v150 offset:17408
  s_add_u32 m0, s57, s47
  s_add_u32 s66, s56, s51
  buffer_load_dwordx4 v145, s[24:27], s66 offen  lds
  v_mfma_f32_16x16x32_bf16 v[4:7], a[4:7], v[40:43], v[4:7]
  ds_read_b64_tr_b16 a[10:11], v150 offset:21504
  ds_read_b64_tr_b16 a[12:13], v151 offset:17408
  s_add_u32 m0, m0, 896
  s_nop 0
  buffer_load_dwordx4 v145, s[24:27], s66 offen offset:128  lds
  v_mfma_f32_16x16x32_bf16 v[8:11], a[0:3], v[44:47], v[8:11]
  ds_read_b64_tr_b16 a[14:15], v151 offset:21504
  ds_read_b128 v[64:67], v153 offset:18432
  v_mfma_f32_16x16x32_bf16 v[12:15], a[4:7], v[44:47], v[12:15]
  ds_read_b128 v[68:71], v153 offset:19456
  ds_read_b128 v[72:75], v153 offset:20480
  s_add_u32 m0, s57, s3
  s_add_u32 s66, s55, s52
  buffer_load_dwordx4 v146, s[20:23], s66 offen  lds
  v_mfma_f32_16x16x32_bf16 v[16:19], a[0:3], v[48:51], v[16:19]
  v_mfma_f32_16x16x32_bf16 v[20:23], a[4:7], v[48:51], v[20:23]
  s_add_u32 m0, s57, s100
  s_add_u32 s66, s55, s53
  buffer_load_dwordx4 v146, s[20:23], s66 offen  lds
  v_mfma_f32_16x16x32_bf16 v[24:27], a[0:3], v[52:55], v[24:27]
  v_mfma_f32_16x16x32_bf16 v[28:31], a[4:7], v[52:55], v[28:31]
  s_cmp_eq_u32 s42, 0
  s_cbranch_scc0 F_q1_s1_x8
  s_add_u32 m0, s57, s101
  s_add_u32 s66, s55, s54
  buffer_load_dwordx4 v146, s[20:23], s66 offen  lds
F_q1_s1_x8:
  s_add_u32 s55, s55, 2048
  s_add_u32 s56, s56, 65536
  s_add_u32 s57, s57, 34816
  s_cmp_eq_u32 s57, 151552
  s_cselect_b32 s57, 12288, s57
  s_waitcnt lgkmcnt(0)
  v_mfma_f32_16x16x32_bf16 v[0:3], a[8:11], v[60:63], v[0:3]
  s_add_u32 s58, s58, 34816
  s_cmp_eq_u32 s58, 151552
  s_cselect_b32 s58, 12288, s58
  v_add_u32 v150, s58, v148
  v_add_u32 v151, s58, v149
  v_add_u32 v153, s58, v152
  ds_read_b128 v[40:43], v153 offset:0
  ds_read_b64_tr_b16 a[0:1], v150 offset:0
  v_mfma_f32_16x16x32_bf16 v[4:7], a[12:15], v[60:63], v[4:7]
  ds_read_b64_tr_b16 a[2:3], v150 offset:4096
  ds_read_b64_tr_b16 a[4:5], v151 offset:0
  v_mfma_f32_16x16x32_bf16 v[8:11], a[8:11], v[64:67], v[8:11]
  ds_read_b64_tr_b16 a[6:7], v151 offset:4096
  ds_read_b128 v[44:47], v153 offset:1024
  v_mfma_f32_16x16x32_bf16 v[12:15], a[12:15], v[64:67], v[12:15]
  ds_read_b128 v[48:51], v153 offset:2048
  ds_read_b128 v[52:55], v153 offset:3072
  v_mfma_f32_16x16x32_bf16 v[16:19], a[8:11], v[68:71], v[16:19]
  v_mfma_f32_16x16x32_bf16 v[20:23], a[12:15], v[68:71], v[20:23]
  v_mfma_f32_16x16x32_bf16 v[24:27], a[8:11], v[72:75], v[24:27]
  v_mfma_f32_16x16x32_bf16 v[28:31], a[12:15], v[72:75], v[28:31]
  s_add_u32 s62, s62, 1
  s_cmp_lt_u32 s62, 5
  s_cbranch_scc1 F_q1_loop
  s_waitcnt vmcnt(4)
  s_barrier
  s_waitcnt lgkmcnt(0)
  v_mfma_f32_16x16x32_bf16 v[0:3], a[0:3], v[40:43], v[0:3]
  ds_read_b128 v[60:63], v153 offset:17408
  ds_read_b64_tr_b16 a[8:9], v150 offset:17408
  s_add_u32 m0, s57, s47
  s_add_u32 s66, s56, s51
  buffer_load_dwordx4 v145, s[24:27], s66 offen  lds
  v_mfma_f32_16x16x32_bf16 v[4:7], a[4:7], v[40:43], v[4:7]
  ds_read_b64_tr_b16 a[10:11], v150 offset:21504
  ds_read_b64_tr_b16 a[12:13], v151 offset:17408
  s_add_u32 m0, m0, 896
  s_nop 0
  buffer_load_dwordx4 v145, s[24:27], s66 offen offset:128  lds
  v_mfma_f32_16x16x32_bf16 v[8:11], a[0:3], v[44:47], v[8:11]
  ds_read_b64_tr_b16 a[14:15], v151 offset:21504
  ds_read_b128 v[64:67], v153 offset:18432
  v_mfma_f32_16x16x32_bf16 v[12:15], a[4:7], v[44:47], v[12:15]
  ds_read_b128 v[68:71], v153 offset:19456
  ds_read_b128 v[72:75], v153 offset:20480
  s_add_u32 m0, s57, s3
  s_add_u32 s66, s55, s52
  buffer_load_dwordx4 v146, s[20:23], s66 offen  lds
  v_mfma_f32_16x16x32_bf16 v[16:19], a[0:3], v[48:51], v[16:19]
  v_mfma_f32_16x16x32_bf16 v[20:23], a[4:7], v[48:51], v[20:23]
  s_add_u32 m0, s57, s100
  s_add_u32 s66, s55, s53
  buffer_load_dwordx4 v146, s[20:23], s66 offen  lds
  v_mfma_f32_16x16x32_bf16 v[24:27], a[0:3], v[52:55], v[24:27]
  v_mfma_f32_16x16x32_bf16 v[28:31], a[4:7], v[52:55], v[28:31]
  s_cmp_eq_u32 s42, 0
  s_cbranch_scc0 F_q1_p12_x8
  s_add_u32 m0, s57, s101
  s_add_u32 s66, s55, s54
  buffer_load_dwordx4 v146, s[20:23], s66 offen  lds
F_q1_p12_x8:
  s_add_u32 s55, s55, 71680
  s_sub_u32 s63, s55, 294912
  s_cmp_ge_u32 s55, 294912
  s_cselect_b32 s55, s63, s55
  s_add_u32 s56, s56, 196608
  s_and_b32 s56, s56, 1048575
  s_add_u32 s57, s57, 34816
  s_cmp_eq_u32 s57, 151552
  s_cselect_b32 s57, 12288, s57
  s_waitcnt lgkmcnt(0)
  v_mfma_f32_16x16x32_bf16 v[0:3], a[8:11], v[60:63], v[0:3]
  s_add_u32 s58, s58, 34816
  s_cmp_eq_u32 s58, 151552
  s_cselect_b32 s58, 12288, s58
  v_add_u32 v150, s58, v148
  v_add_u32 v151, s58, v149
  v_add_u32 v153, s58, v152
  ds_read_b128 v[40:43], v153 offset:0
  ds_read_b64_tr_b16 a[0:1], v150 offset:0
  v_mfma_f32_16x16x32_bf16 v[4:7], a[12:15], v[60:63], v[4:7]
  ds_read_b64_tr_b16 a[2:3], v150 offset:4096
  ds_read_b64_tr_b16 a[4:5], v151 offset:0
  v_mfma_f32_16x16x32_bf16 v[8:11], a[8:11], v[64:67], v[8:11]
  ds_read_b64_tr_b16 a[6:7], v151 offset:4096
  ds_read_b128 v[44:47], v153 offset:1024
  v_mfma_f32_16x16x32_bf16 v[12:15], a[12:15], v[64:67], v[12:15]
  ds_read_b128 v[48:51], v153 offset:2048
  ds_read_b128 v[52:55], v153 offset:3072
  v_mfma_f32_16x16x32_bf16 v[16:19], a[8:11], v[68:71], v[16:19]
  v_mfma_f32_16x16x32_bf16 v[20:23], a[12:15], v[68:71], v[20:23]
  v_mfma_f32_16x16x32_bf16 v[24:27], a[8:11], v[72:75], v[24:27]
  v_mfma_f32_16x16x32_bf16 v[28:31], a[12:15], v[72:75], v[28:31]
  s_waitcnt vmcnt(4)
  s_barrier
  s_waitcnt lgkmcnt(0)
  v_mfma_f32_16x16x32_bf16 v[0:3], a[0:3], v[40:43], v[0:3]
  ds_read_b128 v[60:63], v153 offset:17408
  ds_read_b64_tr_b16 a[8:9], v150 offset:17408
  v_mfma_f32_16x16x32_bf16 v[4:7], a[4:7], v[40:43], v[4:7]
  ds_read_b64_tr_b16 a[10:11], v150 offset:21504
  ds_read_b64_tr_b16 a[12:13], v151 offset:17408
  v_mfma_f32_16x16x32_bf16 v[8:11], a[0:3], v[44:47], v[8:11]
  ds_read_b64_tr_b16 a[14:15], v151 offset:21504
  ds_read_b128 v[64:67], v153 offset:18432
  v_mfma_f32_16x16x32_bf16 v[12:15], a[4:7], v[44:47], v[12:15]
  ds_read_b128 v[68:71], v153 offset:19456
  ds_read_b128 v[72:75], v153 offset:20480
  v_mfma_f32_16x16x32_bf16 v[16:19], a[0:3], v[48:51], v[16:19]
  v_mfma_f32_16x16x32_bf16 v[20:23], a[4:7], v[48:51], v[20:23]
  v_mfma_f32_16x16x32_bf16 v[24:27], a[0:3], v[52:55], v[24:27]
  v_mfma_f32_16x16x32_bf16 v[28:31], a[4:7], v[52:55], v[28:31]
  s_waitcnt lgkmcnt(0)
  v_mfma_f32_16x16x32_bf16 v[0:3], a[8:11], v[60:63], v[0:3]
  s_add_u32 s58, s58, 34816
  s_cmp_eq_u32 s58, 151552
  s_cselect_b32 s58, 12288, s58
  v_add_u32 v150, s58, v148
  v_add_u32 v151, s58, v149
  v_add_u32 v153, s58, v152
  ds_read_b128 v[40:43], v153 offset:0
  ds_read_b64_tr_b16 a[0:1], v150 offset:0
  v_mfma_f32_16x16x32_bf16 v[4:7], a[12:15], v[60:63], v[4:7]
  ds_read_b64_tr_b16 a[2:3], v150 offset:4096
  ds_read_b64_tr_b16 a[4:5], v151 offset:0
  v_mfma_f32_16x16x32_bf16 v[8:11], a[8:11], v[64:67], v[8:11]
  ds_read_b64_tr_b16 a[6:7], v151 offset:4096
  ds_read_b128 v[44:47], v153 offset:1024
  v_mfma_f32_16x16x32_bf16 v[12:15], a[12:15], v[64:67], v[12:15]
  ds_read_b128 v[48:51], v153 offset:2048
  ds_read_b128 v[52:55], v153 offset:3072
  v_mfma_f32_16x16x32_bf16 v[16:19], a[8:11], v[68:71], v[16:19]
  v_mfma_f32_16x16x32_bf16 v[20:23], a[12:15], v[68:71], v[20:23]
  v_mfma_f32_16x16x32_bf16 v[24:27], a[8:11], v[72:75], v[24:27]
  v_mfma_f32_16x16x32_bf16 v[28:31], a[12:15], v[72:75], v[28:31]
  s_waitcnt vmcnt(0)
  s_barrier
  s_waitcnt lgkmcnt(0)
  v_mfma_f32_16x16x32_bf16 v[0:3], a[0:3], v[40:43], v[0:3]
  ds_read_b128 v[60:63], v153 offset:17408
  ds_read_b64_tr_b16 a[8:9], v150 offset:17408
  v_mfma_f32_16x16x32_bf16 v[4:7], a[4:7], v[40:43], v[4:7]
  ds_read_b64_tr_b16 a[10:11], v150 offset:21504
  ds_read_b64_tr_b16 a[12:13], v151 offset:17408
  v_mfma_f32_16x16x32_bf16 v[8:11], a[0:3], v[44:47], v[8:11]
  ds_read_b64_tr_b16 a[14:15], v151 offset:21504
  ds_read_b128 v[64:67], v153 offset:18432
  v_mfma_f32_16x16x32_bf16 v[12:15], a[4:7], v[44:47], v[12:15]
  ds_read_b128 v[68:71], v153 offset:19456
  ds_read_b128 v[72:75], v153 offset:20480
  v_mfma_f32_16x16x32_bf16 v[16:19], a[0:3], v[48:51], v[16:19]
  v_mfma_f32_16x16x32_bf16 v[20:23], a[4:7], v[48:51], v[20:23]
  v_mfma_f32_16x16x32_bf16 v[24:27], a[0:3], v[52:55], v[24:27]
  v_mfma_f32_16x16x32_bf16 v[28:31], a[4:7], v[52:55], v[28:31]
  s_waitcnt lgkmcnt(0)
  v_mfma_f32_16x16x32_bf16 v[0:3], a[8:11], v[60:63], v[0:3]
  s_add_u32 s58, s58, 34816
  s_cmp_eq_u32 s58, 151552
  s_cselect_b32 s58, 12288, s58
  v_add_u32 v150, s58, v148
  v_add_u32 v151, s58, v149
  v_add_u32 v153, s58, v152
  ds_read_b128 v[40:43], v153 offset:0
  ds_read_b64_tr_b16 a[0:1], v150 offset:0
  v_mfma_f32_16x16x32_bf16 v[4:7], a[12:15], v[60:63], v[4:7]
  ds_read_b64_tr_b16 a[2:3], v150 offset:4096
  ds_read_b64_tr_b16 a[4:5], v151 offset:0
  v_mfma_f32_16x16x32_bf16 v[8:11], a[8:11], v[64:67], v[8:11]
  ds_read_b64_tr_b16 a[6:7], v151 offset:4096
  ds_read_b128 v[44:47], v153 offset:1024
  v_mfma_f32_16x16x32_bf16 v[12:15], a[12:15], v[64:67], v[12:15]
  ds_read_b128 v[48:51], v153 offset:2048
  ds_read_b128 v[52:55], v153 offset:3072
  v_mfma_f32_16x16x32_bf16 v[16:19], a[8:11], v[68:71], v[16:19]
  v_mfma_f32_16x16x32_bf16 v[20:23], a[12:15], v[68:71], v[20:23]
  v_mfma_f32_16x16x32_bf16 v[24:27], a[8:11], v[72:75], v[24:27]
  v_mfma_f32_16x16x32_bf16 v[28:31], a[12:15], v[72:75], v[28:31]
  s_barrier
  s_waitcnt lgkmcnt(0)
  v_mfma_f32_16x16x32_bf16 v[0:3], a[0:3], v[40:43], v[0:3]
  ds_read_b128 v[60:63], v153 offset:17408
  ds_read_b64_tr_b16 a[8:9], v150 offset:17408
  v_mfma_f32_16x16x32_bf16 v[4:7], a[4:7], v[40:43], v[4:7]
  ds_read_b64_tr_b16 a[10:11], v150 offset:21504
  ds_read_b64_tr_b16 a[12:13], v151 offset:17408
  v_mfma_f32_16x16x32_bf16 v[8:11], a[0:3], v[44:47], v[8:11]
  ds_read_b64_tr_b16 a[14:15], v151 offset:21504
  ds_read_b128 v[64:67], v153 offset:18432
  v_mfma_f32_16x16x32_bf16 v[12:15], a[4:7], v[44:47], v[12:15]
  ds_read_b128 v[68:71], v153 offset:19456
  ds_read_b128 v[72:75], v153 offset:20480
  v_mfma_f32_16x16x32_bf16 v[16:19], a[0:3], v[48:51], v[16:19]
  v_mfma_f32_16x16x32_bf16 v[20:23], a[4:7], v[48:51], v[20:23]
  v_mfma_f32_16x16x32_bf16 v[24:27], a[0:3], v[52:55], v[24:27]
  v_mfma_f32_16x16x32_bf16 v[28:31], a[4:7], v[52:55], v[28:31]
  s_waitcnt lgkmcnt(0)
  v_mfma_f32_16x16x32_bf16 v[0:3], a[8:11], v[60:63], v[0:3]
  v_mfma_f32_16x16x32_bf16 v[4:7], a[12:15], v[60:63], v[4:7]
  v_mfma_f32_16x16x32_bf16 v[8:11], a[8:11], v[64:67], v[8:11]
  v_mfma_f32_16x16x32_bf16 v[12:15], a[12:15], v[64:67], v[12:15]
  v_mfma_f32_16x16x32_bf16 v[16:19], a[8:11], v[68:71], v[16:19]
  v_mfma_f32_16x16x32_bf16 v[20:23], a[12:15], v[68:71], v[20:23]
  v_mfma_f32_16x16x32_bf16 v[24:27], a[8:11], v[72:75], v[24:27]
  v_mfma_f32_16x16x32_bf16 v[28:31], a[12:15], v[72:75], v[28:31]
  s_nop 7
  v_lshrrev_b32 v157, 1, v146
  s_mul_i32 s67, s45, 12288
  s_mul_i32 s66, s40, 1536
  s_add_u32 s67, s67, s66
  s_cmp_eq_u32 s45, 1
  s_cbranch_scc1 F_q1_kk1
  s_cmp_eq_u32 s45, 2
  s_cbranch_scc1 F_q1_kk2
  s_cmp_eq_u32 s45, 3
  s_cbranch_scc1 F_q1_kk3
F_q1_kk0:
  s_add_u32 s66, s67, 49152
  v_cvt_pk_bf16_f32 v96, v4, v5
  v_cvt_pk_bf16_f32 v97, v6, v7
  buffer_store_dwordx2 v[96:97], v157, s[32:35], s66 offen sc1
  s_add_u32 s66, s67, 98304
  v_cvt_pk_bf16_f32 v98, v8, v9
  v_cvt_pk_bf16_f32 v99, v10, v11
  buffer_store_dwordx2 v[98:99], v157, s[32:35], s66 offen sc1
  s_add_u32 s66, s67, 147456
  v_cvt_pk_bf16_f32 v100, v12, v13
  v_cvt_pk_bf16_f32 v101, v14, v15
  buffer_store_dwordx2 v[100:101], v157, s[32:35], s66 offen sc1
  s_add_u32 s66, s67, 49664
  v_cvt_pk_bf16_f32 v102, v20, v21
  v_cvt_pk_bf16_f32 v103, v22, v23
  buffer_store_dwordx2 v[102:103], v157, s[32:35], s66 offen sc1
  s_add_u32 s66, s67, 98816
  v_cvt_pk_bf16_f32 v104, v24, v25
  v_cvt_pk_bf16_f32 v105, v26, v27
  buffer_store_dwordx2 v[104:105], v157, s[32:35], s66 offen sc1
  s_add_u32 s66, s67, 147968
  v_cvt_pk_bf16_f32 v106, v28, v29
  v_cvt_pk_bf16_f32 v107, v30, v31
  buffer_store_dwordx2 v[106:107], v157, s[32:35], s66 offen sc1
  s_waitcnt vmcnt(0)
  s_barrier
  s_barrier
  s_mul_i32 s66, s40, 1536
  s_add_u32 s67, s66, 0
  s_add_u32 s66, s67, 12288
  buffer_load_dwordx2 v[96:97], v157, s[32:35], s66 offen sc1
  s_add_u32 s66, s67, 24576
  buffer_load_dwordx2 v[98:99], v157, s[32:35], s66 offen sc1
  s_add_u32 s66, s67, 36864
  buffer_load_dwordx2 v[100:101], v157, s[32:35], s66 offen sc1
  s_add_u32 s66, s67, 12800
  buffer_load_dwordx2 v[102:103], v157, s[32:35], s66 offen sc1
  s_add_u32 s66, s67, 25088
  buffer_load_dwordx2 v[104:105], v157, s[32:35], s66 offen sc1
  s_add_u32 s66, s67, 37376
  buffer_load_dwordx2 v[106:107], v157, s[32:35], s66 offen sc1
  v_and_b32 v154, 15, v144
  v_lshrrev_b32 v155, 4, v144
  v_lshlrev_b32 v155, 3, v155
  v_lshl_add_u32 v156, v154, 10, v155
  s_lshl_b32 s66, s42, 6
  v_add_u32 v156, s66, v156
  s_waitcnt vmcnt(5)
  v_lshlrev_b32 v154, 16, v96
  v_and_b32 v155, 0xffff0000, v96
  v_add_f32 v0, v0, v154
  v_add_f32 v1, v1, v155
  v_lshlrev_b32 v154, 16, v97
  v_and_b32 v155, 0xffff0000, v97
  v_add_f32 v2, v2, v154
  v_add_f32 v3, v3, v155
  s_waitcnt vmcnt(4)
  v_lshlrev_b32 v154, 16, v98
  v_and_b32 v155, 0xffff0000, v98
  v_add_f32 v0, v0, v154
  v_add_f32 v1, v1, v155
  v_lshlrev_b32 v154, 16, v99
  v_and_b32 v155, 0xffff0000, v99
  v_add_f32 v2, v2, v154
  v_add_f32 v3, v3, v155
  s_waitcnt vmcnt(3)
  v_lshlrev_b32 v154, 16, v100
  v_and_b32 v155, 0xffff0000, v100
  v_add_f32 v0, v0, v154
  v_add_f32 v1, v1, v155
  v_lshlrev_b32 v154, 16, v101
  v_and_b32 v155, 0xffff0000, v101
  v_add_f32 v2, v2, v154
  v_add_f32 v3, v3, v155
  v_cvt_pk_bf16_f32 v0, v0, v1
  v_cvt_pk_bf16_f32 v1, v2, v3
  s_mov_b32 s66, 81920
  buffer_store_dwordx2 v[0:1], v156, s[28:31], s66 offen offset:0
  s_waitcnt vmcnt(3)
  v_lshlrev_b32 v154, 16, v102
  v_and_b32 v155, 0xffff0000, v102
  v_add_f32 v16, v16, v154
  v_add_f32 v17, v17, v155
  v_lshlrev_b32 v154, 16, v103
  v_and_b32 v155, 0xffff0000, v103
  v_add_f32 v18, v18, v154
  v_add_f32 v19, v19, v155
  s_waitcnt vmcnt(2)
  v_lshlrev_b32 v154, 16, v104
  v_and_b32 v155, 0xffff0000, v104
  v_add_f32 v16, v16, v154
  v_add_f32 v17, v17, v155
  v_lshlrev_b32 v154, 16, v105
  v_and_b32 v155, 0xffff0000, v105
  v_add_f32 v18, v18, v154
  v_add_f32 v19, v19, v155
  s_waitcnt vmcnt(1)
  v_lshlrev_b32 v154, 16, v106
  v_and_b32 v155, 0xffff0000, v106
  v_add_f32 v16, v16, v154
  v_add_f32 v17, v17, v155
  v_lshlrev_b32 v154, 16, v107
  v_and_b32 v155, 0xffff0000, v107
  v_add_f32 v18, v18, v154
  v_add_f32 v19, v19, v155
  v_cvt_pk_bf16_f32 v16, v16, v17
  v_cvt_pk_bf16_f32 v17, v18, v19
  s_mov_b32 s66, 114688
  buffer_store_dwordx2 v[16:17], v156, s[28:31], s66 offen offset:0
  s_endpgm
F_q1_kk1:
  s_add_u32 s66, s67, 0
  v_cvt_pk_bf16_f32 v96, v0, v1
  v_cvt_pk_bf16_f32 v97, v2, v3
  buffer_store_dwordx2 v[96:97], v157, s[32:35], s66 offen sc1
  s_add_u32 s66, s67, 98304
  v_cvt_pk_bf16_f32 v98, v8, v9
  v_cvt_pk_bf16_f32 v99, v10, v11
  buffer_store_dwordx2 v[98:99], v157, s[32:35], s66 offen sc1
  s_add_u32 s66, s67, 147456
  v_cvt_pk_bf16_f32 v100, v12, v13
  v_cvt_pk_bf16_f32 v101, v14, v15
  buffer_store_dwordx2 v[100:101], v157, s[32:35], s66 offen sc1
  s_add_u32 s66, s67, 512
  v_cvt_pk_bf16_f32 v102, v16, v17
  v_cvt_pk_bf16_f32 v103, v18, v19
  buffer_store_dwordx2 v[102:103], v157, s[32:35], s66 offen sc1
  s_add_u32 s66, s67, 98816
  v_cvt_pk_bf16_f32 v104, v24, v25
  v_cvt_pk_bf16_f32 v105, v26, v27
  buffer_store_dwordx2 v[104:105], v157, s[32:35], s66 offen sc1
  s_add_u32 s66, s67, 147968
  v_cvt_pk_bf16_f32 v106, v28, v29
  v_cvt_pk_bf16_f32 v107, v30, v31
  buffer_store_dwordx2 v[106:107], v157, s[32:35], s66 offen sc1
  s_waitcnt vmcnt(0)
  s_barrier
  s_barrier
  s_mul_i32 s66, s40, 1536
  s_add_u32 s67, s66, 49152
  s_add_u32 s66, s67, 0
  buffer_load_dwordx2 v[96:97], v157, s[32:35], s66 offen sc1
  s_add_u32 s66, s67, 24576
  buffer_load_dwordx2 v[98:99], v157, s[32:35], s66 offen sc1
  s_add_u32 s66, s67, 36864
  buffer_load_dwordx2 v[100:101], v157, s[32:35], s66 offen sc1
  s_add_u32 s66, s67, 512
  buffer_load_dwordx2 v[102:103], v157, s[32:35], s66 offen sc1
  s_add_u32 s66, s67, 25088
  buffer_load_dwordx2 v[104:105], v157, s[32:35], s66 offen sc1
  s_add_u32 s66, s67, 37376
  buffer_load_dwordx2 v[106:107], v157, s[32:35], s66 offen sc1
  v_and_b32 v154, 15, v144
  v_lshrrev_b32 v155, 4, v144
  v_lshlrev_b32 v155, 3, v155
  v_lshl_add_u32 v156, v154, 10, v155
  s_lshl_b32 s66, s42, 6
  v_add_u32 v156, s66, v156
  s_waitcnt vmcnt(5)
  v_lshlrev_b32 v154, 16, v96
  v_and_b32 v155, 0xffff0000, v96
  v_add_f32 v4, v4, v154
  v_add_f32 v5, v5, v155
  v_lshlrev_b32 v154, 16, v97
  v_and_b32 v155, 0xffff0000, v97
  v_add_f32 v6, v6, v154
  v_add_f32 v7, v7, v155
  s_waitcnt vmcnt(4)
  v_lshlrev_b32 v154, 16, v98
  v_and_b32 v155, 0xffff0000, v98
  v_add_f32 v4, v4, v154
  v_add_f32 v5, v5, v155
  v_lshlrev_b32 v154, 16, v99
  v_and_b32 v155, 0xffff0000, v99
  v_add_f32 v6, v6, v154
  v_add_f32 v7, v7, v155
  s_waitcnt vmcnt(3)
  v_lshlrev_b32 v154, 16, v100
  v_and_b32 v155, 0xffff0000, v100
  v_add_f32 v4, v4, v154
  v_add_f32 v5, v5, v155
  v_lshlrev_b32 v154, 16, v101
  v_and_b32 v155, 0xffff0000, v101
  v_add_f32 v6, v6, v154
  v_add_f32 v7, v7, v155
  v_cvt_pk_bf16_f32 v4, v4, v5
  v_cvt_pk_bf16_f32 v5, v6, v7
  s_mov_b32 s66, 81920
  buffer_store_dwordx2 v[4:5], v156, s[28:31], s66 offen offset:32
  s_waitcnt vmcnt(3)
  v_lshlrev_b32 v154, 16, v102
  v_and_b32 v155, 0xffff0000, v102
  v_add_f32 v20, v20, v154
  v_add_f32 v21, v21, v155
  v_lshlrev_b32 v154, 16, v103
  v_and_b32 v155, 0xffff0000, v103
  v_add_f32 v22, v22, v154
  v_add_f32 v23, v23, v155
  s_waitcnt vmcnt(2)
  v_lshlrev_b32 v154, 16, v104
  v_and_b32 v155, 0xffff0000, v104
  v_add_f32 v20, v20, v154
  v_add_f32 v21, v21, v155
  v_lshlrev_b32 v154, 16, v105
  v_and_b32 v155, 0xffff0000, v105
  v_add_f32 v22, v22, v154
  v_add_f32 v23, v23, v155
  s_waitcnt vmcnt(1)
  v_lshlrev_b32 v154, 16, v106
  v_and_b32 v155, 0xffff0000, v106
  v_add_f32 v20, v20, v154
  v_add_f32 v21, v21, v155
  v_lshlrev_b32 v154, 16, v107
  v_and_b32 v155, 0xffff0000, v107
  v_add_f32 v22, v22, v154
  v_add_f32 v23, v23, v155
  v_cvt_pk_bf16_f32 v20, v20, v21
  v_cvt_pk_bf16_f32 v21, v22, v23
  s_mov_b32 s66, 114688
  buffer_store_dwordx2 v[20:21], v156, s[28:31], s66 offen offset:32
  s_endpgm
F_q1_kk2:
  s_add_u32 s66, s67, 0
  v_cvt_pk_bf16_f32 v96, v0, v1
  v_cvt_pk_bf16_f32 v97, v2, v3
  buffer_store_dwordx2 v[96:97], v157, s[32:35], s66 offen sc1
  s_add_u32 s66, s67, 49152
  v_cvt_pk_bf16_f32 v98, v4, v5
  v_cvt_pk_bf16_f32 v99, v6, v7
  buffer_store_dwordx2 v[98:99], v157, s[32:35], s66 offen sc1
  s_add_u32 s66, s67, 147456
  v_cvt_pk_bf16_f32 v100, v12, v13
  v_cvt_pk_bf16_f32 v101, v14, v15
  buffer_store_dwordx2 v[100:101], v157, s[32:35], s66 offen sc1
  s_add_u32 s66, s67, 512
  v_cvt_pk_bf16_f32 v102, v16, v17
  v_cvt_pk_bf16_f32 v103, v18, v19
  buffer_store_dwordx2 v[102:103], v157, s[32:35], s66 offen sc1
  s_add_u32 s66, s67, 49664
  v_cvt_pk_bf16_f32 v104, v20, v21
  v_cvt_pk_bf16_f32 v105, v22, v23
  buffer_store_dwordx2 v[104:105], v157, s[32:35], s66 offen sc1
  s_add_u32 s66, s67, 147968
  v_cvt_pk_bf16_f32 v106, v28, v29
  v_cvt_pk_bf16_f32 v107, v30, v31
  buffer_store_dwordx2 v[106:107], v157, s[32:35], s66 offen sc1
  s_waitcnt vmcnt(0)
  s_barrier
  s_barrier
  s_mul_i32 s66, s40, 1536
  s_add_u32 s67, s66, 98304
  s_add_u32 s66, s67, 0
  buffer_load_dwordx2 v[96:97], v157, s[32:35], s66 offen sc1
  s_add_u32 s66, s67, 12288
  buffer_load_dwordx2 v[98:99], v157, s[32:35], s66 offen sc1
  s_add_u32 s66, s67, 36864
  buffer_load_dwordx2 v[100:101], v157, s[32:35], s66 offen sc1
  s_add_u32 s66, s67, 512
  buffer_load_dwordx2 v[102:103], v157, s[32:35], s66 offen sc1
  s_add_u32 s66, s67, 12800
  buffer_load_dwordx2 v[104:105], v157, s[32:35], s66 offen sc1
  s_add_u32 s66, s67, 37376
  buffer_load_dwordx2 v[106:107], v157, s[32:35], s66 offen sc1
  v_and_b32 v154, 15, v144
  v_lshrrev_b32 v155, 4, v144
  v_lshlrev_b32 v155, 3, v155
  v_lshl_add_u32 v156, v154, 10, v155
  s_lshl_b32 s66, s42, 6
  v_add_u32 v156, s66, v156
  s_waitcnt vmcnt(5)
  v_lshlrev_b32 v154, 16, v96
  v_and_b32 v155, 0xffff0000, v96
  v_add_f32 v8, v8, v154
  v_add_f32 v9, v9, v155
  v_lshlrev_b32 v154, 16, v97
  v_and_b32 v155, 0xffff0000, v97
  v_add_f32 v10, v10, v154
  v_add_f32 v11, v11, v155
  s_waitcnt vmcnt(4)
  v_lshlrev_b32 v154, 16, v98
  v_and_b32 v155, 0xffff0000, v98
  v_add_f32 v8, v8, v154
  v_add_f32 v9, v9, v155
  v_lshlrev_b32 v154, 16, v99
  v_and_b32 v155, 0xffff0000, v99
  v_add_f32 v10, v10, v154
  v_add_f32 v11, v11, v155
  s_waitcnt vmcnt(3)
  v_lshlrev_b32 v154, 16, v100
  v_and_b32 v155, 0xffff0000, v100
  v_add_f32 v8, v8, v154
  v_add_f32 v9, v9, v155
  v_lshlrev_b32 v154, 16, v101
  v_and_b32 v155, 0xffff0000, v101
  v_add_f32 v10, v10, v154
  v_add_f32 v11, v11, v155
  v_cvt_pk_bf16_f32 v8, v8, v9
  v_cvt_pk_bf16_f32 v9, v10, v11
  s_mov_b32 s66, 98304
  buffer_store_dwordx2 v[8:9], v156, s[28:31], s66 offen offset:0
  s_waitcnt vmcnt(3)
  v_lshlrev_b32 v154, 16, v102
  v_and_b32 v155, 0xffff0000, v102
  v_add_f32 v24, v24, v154
  v_add_f32 v25, v25, v155
  v_lshlrev_b32 v154, 16, v103
  v_and_b32 v155, 0xffff0000, v103
  v_add_f32 v26, v26, v154
  v_add_f32 v27, v27, v155
  s_waitcnt vmcnt(2)
  v_lshlrev_b32 v154, 16, v104
  v_and_b32 v155, 0xffff0000, v104
  v_add_f32 v24, v24, v154
  v_add_f32 v25, v25, v155
  v_lshlrev_b32 v154, 16, v105
  v_and_b32 v155, 0xffff0000, v105
  v_add_f32 v26, v26, v154
  v_add_f32 v27, v27, v155
  s_waitcnt vmcnt(1)
  v_lshlrev_b32 v154, 16, v106
  v_and_b32 v155, 0xffff0000, v106
  v_add_f32 v24, v24, v154
  v_add_f32 v25, v25, v155
  v_lshlrev_b32 v154, 16, v107
  v_and_b32 v155, 0xffff0000, v107
  v_add_f32 v26, v26, v154
  v_add_f32 v27, v27, v155
  v_cvt_pk_bf16_f32 v24, v24, v25
  v_cvt_pk_bf16_f32 v25, v26, v27
  s_mov_b32 s66, 131072
  buffer_store_dwordx2 v[24:25], v156, s[28:31], s66 offen offset:0
  s_endpgm
F_q1_kk3:
  s_add_u32 s66, s67, 0
  v_cvt_pk_bf16_f32 v96, v0, v1
  v_cvt_pk_bf16_f32 v97, v2, v3
  buffer_store_dwordx2 v[96:97], v157, s[32:35], s66 offen sc1
  s_add_u32 s66, s67, 49152
  v_cvt_pk_bf16_f32 v98, v4, v5
  v_cvt_pk_bf16_f32 v99, v6, v7
  buffer_store_dwordx2 v[98:99], v157, s[32:35], s66 offen sc1
  s_add_u32 s66, s67, 98304
  v_cvt_pk_bf16_f32 v100, v8, v9
  v_cvt_pk_bf16_f32 v101, v10, v11
  buffer_store_dwordx2 v[100:101], v157, s[32:35], s66 offen sc1
  s_add_u32 s66, s67, 512
  v_cvt_pk_bf16_f32 v102, v16, v17
  v_cvt_pk_bf16_f32 v103, v18, v19
  buffer_store_dwordx2 v[102:103], v157, s[32:35], s66 offen sc1
  s_add_u32 s66, s67, 49664
  v_cvt_pk_bf16_f32 v104, v20, v21
  v_cvt_pk_bf16_f32 v105, v22, v23
  buffer_store_dwordx2 v[104:105], v157, s[32:35], s66 offen sc1
  s_add_u32 s66, s67, 98816
  v_cvt_pk_bf16_f32 v106, v24, v25
  v_cvt_pk_bf16_f32 v107, v26, v27
  buffer_store_dwordx2 v[106:107], v157, s[32:35], s66 offen sc1
  s_waitcnt vmcnt(0)
  s_barrier
  s_barrier
  s_mul_i32 s66, s40, 1536
  s_add_u32 s67, s66, 147456
  s_add_u32 s66, s67, 0
  buffer_load_dwordx2 v[96:97], v157, s[32:35], s66 offen sc1
  s_add_u32 s66, s67, 12288
  buffer_load_dwordx2 v[98:99], v157, s[32:35], s66 offen sc1
  s_add_u32 s66, s67, 24576
  buffer_load_dwordx2 v[100:101], v157, s[32:35], s66 offen sc1
  s_add_u32 s66, s67, 512
  buffer_load_dwordx2 v[102:103], v157, s[32:35], s66 offen sc1
  s_add_u32 s66, s67, 12800
  buffer_load_dwordx2 v[104:105], v157, s[32:35], s66 offen sc1
  s_add_u32 s66, s67, 25088
  buffer_load_dwordx2 v[106:107], v157, s[32:35], s66 offen sc1
  v_and_b32 v154, 15, v144
  v_lshrrev_b32 v155, 4, v144
  v_lshlrev_b32 v155, 3, v155
  v_lshl_add_u32 v156, v154, 10, v155
  s_lshl_b32 s66, s42, 6
  v_add_u32 v156, s66, v156
  s_waitcnt vmcnt(5)
  v_lshlrev_b32 v154, 16, v96
  v_and_b32 v155, 0xffff0000, v96
  v_add_f32 v12, v12, v154
  v_add_f32 v13, v13, v155
  v_lshlrev_b32 v154, 16, v97
  v_and_b32 v155, 0xffff0000, v97
  v_add_f32 v14, v14, v154
  v_add_f32 v15, v15, v155
  s_waitcnt vmcnt(4)
  v_lshlrev_b32 v154, 16, v98
  v_and_b32 v155, 0xffff0000, v98
  v_add_f32 v12, v12, v154
  v_add_f32 v13, v13, v155
  v_lshlrev_b32 v154, 16, v99
  v_and_b32 v155, 0xffff0000, v99
  v_add_f32 v14, v14, v154
  v_add_f32 v15, v15, v155
  s_waitcnt vmcnt(3)
  v_lshlrev_b32 v154, 16, v100
  v_and_b32 v155, 0xffff0000, v100
  v_add_f32 v12, v12, v154
  v_add_f32 v13, v13, v155
  v_lshlrev_b32 v154, 16, v101
  v_and_b32 v155, 0xffff0000, v101
  v_add_f32 v14, v14, v154
  v_add_f32 v15, v15, v155
  v_cvt_pk_bf16_f32 v12, v12, v13
  v_cvt_pk_bf16_f32 v13, v14, v15
  s_mov_b32 s66, 98304
  buffer_store_dwordx2 v[12:13], v156, s[28:31], s66 offen offset:32
  s_waitcnt vmcnt(3)
  v_lshlrev_b32 v154, 16, v102
  v_and_b32 v155, 0xffff0000, v102
  v_add_f32 v28, v28, v154
  v_add_f32 v29, v29, v155
  v_lshlrev_b32 v154, 16, v103
  v_and_b32 v155, 0xffff0000, v103
  v_add_f32 v30, v30, v154
  v_add_f32 v31, v31, v155
  s_waitcnt vmcnt(2)
  v_lshlrev_b32 v154, 16, v104
  v_and_b32 v155, 0xffff0000, v104
  v_add_f32 v28, v28, v154
  v_add_f32 v29, v29, v155
  v_lshlrev_b32 v154, 16, v105
  v_and_b32 v155, 0xffff0000, v105
  v_add_f32 v30, v30, v154
  v_add_f32 v31, v31, v155
  s_waitcnt vmcnt(1)
  v_lshlrev_b32 v154, 16, v106
  v_and_b32 v155, 0xffff0000, v106
  v_add_f32 v28, v28, v154
  v_add_f32 v29, v29, v155
  v_lshlrev_b32 v154, 16, v107
  v_and_b32 v155, 0xffff0000, v107
  v_add_f32 v30, v30, v154
  v_add_f32 v31, v31, v155
  v_cvt_pk_bf16_f32 v28, v28, v29
  v_cvt_pk_bf16_f32 v29, v30, v31
  s_mov_b32 s66, 131072
  buffer_store_dwordx2 v[28:29], v156, s[28:31], s66 offen offset:32
  s_endpgm
KEND:
.set CODE_BYTES, KEND - KSTART
.section .rodata,"a"
.p2align 6
.amdhsa_kernel standalone__gqa_block_cached__near_ridge_kernel
  .amdhsa_next_free_vgpr 256
  .amdhsa_next_free_sgpr 102
  .amdhsa_accum_offset 224
  .amdhsa_group_segment_fixed_size 0
  .amdhsa_kernarg_size 64
  .amdhsa_user_sgpr_count 2
  .amdhsa_user_sgpr_kernarg_segment_ptr 1
  .amdhsa_system_sgpr_workgroup_id_x 1
.end_amdhsa_kernel
```
